```python
import torch

def _softmax(x, axis=-1):
    return torch.softmax(x, dim=axis)

def _gelu(x):
    return torch.nn.functional.gelu(x, approximate='tanh')

def _silu(x):
    return torch.nn.functional.silu(x)

def _sigmoid(x):
    return torch.sigmoid(x)

def _layernorm(x, axis=-1, eps=1e-05):
    m = x.mean(dim=axis, keepdim=True)
    v = x.var(dim=axis, keepdim=True, unbiased=False)
    return (x - m) / torch.sqrt(v + eps)

def _scatter_add(tgt, idx, src, axis=0):
    return tgt.clone().index_add_(axis, idx, src)

def _segment_sum(src, seg, n):
    out = torch.zeros((n,) + src.shape[1:], dtype=src.dtype)
    return out.index_add_(0, seg, src)

def _pad(x, pw):
    flat = tuple((v for pair in reversed(pw) for v in pair))
    return torch.nn.functional.pad(x, flat)
kernel_name = 'adaLN_cond__spectral_fnet__geglu_ffn__prompt'

def setup_inputs():

    _w = lambda a: (lambda t: t.to(torch.bfloat16) if t.is_floating_point() else t)(torch.as_tensor(a))

    def _A_setup():
        B, S, D = (1, 2048, 640)
        ns = torch.arange(S)[:, None] * torch.arange(S)[None, :]
        nd = torch.arange(D)[:, None] * torch.arange(D)[None, :]
        Ws_re = torch.cos(-2.0 * torch.pi * ns / S).to(float)
        Ws_im = torch.sin(-2.0 * torch.pi * ns / S).to(float)
        Wd_re = torch.cos(-2.0 * torch.pi * nd / D).to(float)
        Wd_im = torch.sin(-2.0 * torch.pi * nd / D).to(float)
        return {'x': _w((lambda *s: torch.randn(*s, dtype=torch.bfloat16) * 0.05)(B, S, D)), 'dft_seq_re': _w(Ws_re), 'dft_seq_im': _w(Ws_im), 'dft_hid_re': _w(Wd_re), 'dft_hid_im': _w(Wd_im)}
    _A_in = _A_setup()

    def _B_setup():
        B, S, D, F = (1, 2048, 640, 1536)
        return {'x': _w((lambda *s: torch.randn(*s, dtype=torch.bfloat16) * 0.05)(B, S, D)), 'w_gate': _w((lambda *s: torch.randn(*s, dtype=torch.bfloat16) * 0.4)(D, F)), 'w_up': _w((lambda *s: torch.randn(*s, dtype=torch.bfloat16) * 0.4)(D, F)), 'w_down': _w((lambda *s: torch.randn(*s, dtype=torch.bfloat16) * 0.4)(F, D))}
    _B_in = _B_setup()
    return {'A_x': _A_in['x'], 'A_dft_seq_re': _A_in['dft_seq_re'], 'A_dft_seq_im': _A_in['dft_seq_im'], 'A_dft_hid_re': _A_in['dft_hid_re'], 'A_dft_hid_im': _A_in['dft_hid_im'], 'B_x': _B_in['x'], 'B_w_gate': _B_in['w_gate'], 'B_w_up': _B_in['w_up'], 'B_w_down': _B_in['w_down'], 'c': _w((lambda *s: torch.randn(*s, dtype=torch.bfloat16) * 0.4)(1, 640) * 8.0), 'w_mod': _w((lambda *s: torch.randn(*s, dtype=torch.bfloat16) * 0.4)(640, 6 * 640) * 640 ** (-0.5) * 8.0)}

def reference(A_x, A_dft_seq_re, A_dft_seq_im, A_dft_hid_re, A_dft_hid_im, B_x, B_w_gate, B_w_up, B_w_down, c, w_mod):

    def _A_ref(x, dft_seq_re, dft_seq_im, dft_hid_re, dft_hid_im):
        a = torch.einsum('bsd,ed->bse', x, dft_hid_re)
        b = torch.einsum('bsd,ed->bse', x, dft_hid_im)
        y = torch.einsum('ts,bse->bte', dft_seq_re, a) - torch.einsum('ts,bse->bte', dft_seq_im, b)
        return y

    def _B_ref(x, w_gate, w_up, w_down):
        return _gelu(x @ w_gate) * (x @ w_up) @ w_down
    x = A_x
    mod = (_silu(c) @ w_mod).reshape(c.shape[0], 6, 1, -1)
    sa, ca, ga, sb, cb, gb = (mod[:, 0].clone(), mod[:, 1].clone(), mod[:, 2].clone(), mod[:, 3].clone(), mod[:, 4].clone(), mod[:, 5].clone())
    h = _layernorm(x, axis=-1) * (1 + ca) + sa
    x = x + ga * _A_ref(h, A_dft_seq_re, A_dft_seq_im, A_dft_hid_re, A_dft_hid_im)
    h = _layernorm(x, axis=-1) * (1 + cb) + sb
    x = x + gb * _B_ref(h, B_w_gate, B_w_up, B_w_down)
    return x
```

```asm
; @launch grid=(256,1,1) block=(256,1,1) lds=163840
.amdgcn_target "amdgcn-amd-amdhsa--gfx950"
.text
.globl adaLN_cond__spectral_fnet__geglu_ffn__prompt_kernel
.p2align 8
.type adaLN_cond__spectral_fnet__geglu_ffn__prompt_kernel,@function
adaLN_cond__spectral_fnet__geglu_ffn__prompt_kernel:
    s_cmp_ge_u32 s2, 256
    s_cbranch_scc1 K_end
    s_load_dwordx2 s[8:9], s[0:1], 0
    s_load_dwordx16 s[44:59], s[0:1], 48
    s_getpc_b64 s[26:27]
K_pc:
    v_lshrrev_b32 v1, 6, v0
    v_and_b32 v2, 63, v0
    v_lshlrev_b32 v3, 4, v2
    v_readfirstlane_b32 s3, v1
    s_mov_b32 s10, 0x280000
    s_mov_b32 s11, 0x20000
    s_mov_b32 s14, 0x280000
    s_mov_b32 s15, 0x20000
    s_mov_b32 s18, 0x1800000
    s_mov_b32 s19, 0x20000
    v_and_b32 v4, 15, v2
    v_lshrrev_b32 v5, 4, v2
    s_cmp_lt_u32 s2, 128
    s_cbranch_scc1 K_a
    s_cmp_ge_u32 s2, 188
    s_cbranch_scc1 K_pack
    s_sub_u32 s94, s2, 128
    s_lshr_b32 s33, s94, 3
    s_add_u32 s34, s94, s33
    s_and_b32 s34, s34, 7
    s_andn2_b32 s35, s94, 7
    s_or_b32 s34, s34, s35
    s_cmp_lt_u32 s94, 56
    s_cselect_b32 s94, s34, s94
    v_lshrrev_b32 v6, 3, v2
    v_mul_u32_u24 v6, 7680, v6
    v_and_b32 v7, 7, v2
    v_lshlrev_b32 v8, 1, v5
    v_xor_b32 v7, v7, v8
    v_lshl_add_u32 v120, v7, 4, v6
    s_mul_i32 s101, s3, 1228800
    s_lshl_b32 s37, s94, 7
    s_add_u32 s101, s101, s37
    s_mul_i32 s100, s3, 20480
    s_mov_b32 m0, s100
    s_add_u32 s37, s100, 20480
    s_mul_i32 s39, s3, 320
    v_lshlrev_b32 v9, 1, v2
    s_mov_b32 s30, 1280
    s_mov_b32 s31, 0x20000
    s_mov_b32 s62, 0x4b0000
    s_mov_b32 s63, 0x20000
    s_waitcnt lgkmcnt(0)
    s_mov_b32 s60, s52
    s_mov_b32 s61, s53
    s_mov_b32 s28, s50
    s_mov_b32 s29, s51
    buffer_load_ushort v16, v9, s[28:31], s39 offen offset:0
    buffer_load_ushort v17, v9, s[28:31], s39 offen offset:128
    buffer_load_ushort v18, v9, s[28:31], s39 offen offset:256
K_g8:
    buffer_load_dwordx4 v120, s[60:63], s101 offen  lds
    s_add_u32 s101, s101, 61440
    s_add_u32 m0, m0, 1024
    s_cmp_lt_u32 m0, s37
    s_cbranch_scc1 K_g8
    s_branch K_gemv
K_a:
    s_and_b32 s32, s2, 31
    s_lshr_b32 s33, s2, 5
    v_lshl_add_u32 v6, v1, 4, v5
    s_mov_b32 s34, 40960
    v_mul_lo_u32 v6, v6, s34
    s_mul_i32 s35, s33, 20
    v_add_u32 v7, s35, v4
    v_add_u32 v8, 0, v7
    v_subrev_u32 v9, 80, v8
    v_min_u32 v8, v8, v9
    v_lshl_add_u32 v120, v8, 4, v6
    v_add_u32 v8, 16, v7
    v_subrev_u32 v9, 80, v8
    v_min_u32 v8, v8, v9
    v_lshl_add_u32 v121, v8, 4, v6
    v_add_u32 v8, 32, v7
    v_subrev_u32 v9, 80, v8
    v_min_u32 v8, v8, v9
    v_lshl_add_u32 v122, v8, 4, v6
    v_add_u32 v8, 48, v7
    v_subrev_u32 v9, 80, v8
    v_min_u32 v8, v8, v9
    v_lshl_add_u32 v123, v8, 4, v6
    v_add_u32 v8, 64, v7
    v_subrev_u32 v9, 80, v8
    v_min_u32 v8, v8, v9
    v_lshl_add_u32 v124, v8, 4, v6
    s_mul_i32 s60, s32, 1280
    s_add_u32 s61, s60, 163840
    s_add_u32 s62, s60, 327680
    s_add_u32 s63, s60, 491520
    s_mov_b32 s94, s32
    s_mov_b32 s95, s33
    s_waitcnt lgkmcnt(0)
    s_mov_b32 s12, s54
    s_mov_b32 s13, s55
    s_mov_b32 s16, s58
    s_mov_b32 s17, s59
    buffer_load_dwordx4 v[16:19], v120, s[8:11], s60 offen
    buffer_load_dwordx4 v[20:23], v121, s[8:11], s60 offen
    buffer_load_dwordx4 v[36:39], v120, s[8:11], s61 offen
    buffer_load_dwordx4 v[40:43], v121, s[8:11], s61 offen
    buffer_load_dwordx4 v[56:59], v120, s[8:11], s62 offen
    buffer_load_dwordx4 v[60:63], v121, s[8:11], s62 offen
    buffer_load_dwordx4 v[76:79], v120, s[8:11], s63 offen
    buffer_load_dwordx4 v[80:83], v121, s[8:11], s63 offen
    s_and_b32 s40, s2, 7
    s_lshr_b32 s41, s2, 3
    s_and_b32 s25, s41, 7
    s_lshr_b32 s41, s41, 3
    s_and_b32 s42, s40, 1
    s_lshl_b32 s42, s42, 3
    s_add_u32 s25, s25, s42
    s_lshr_b32 s40, s40, 1
    s_lshl_b32 s24, s40, 2
    s_add_u32 s24, s24, s41
    s_lshr_b32 s41, s25, 3
    s_lshl_b32 s22, s24, 1
    s_add_u32 s22, s22, s41
    s_and_b32 s23, s25, 7
    buffer_load_dwordx4 v[24:27], v122, s[8:11], s60 offen
    s_lshl_b32 s31, s23, 2
    v_lshrrev_b32 v7, 5, v2
    v_and_b32 v8, 31, v2
    s_add_u32 s32, s31, s3
    v_mov_b32 v13, s32
    v_lshlrev_b32 v10, 6, v13
    s_cmp_eq_u32 s22, 0
    s_cselect_b32 s40, 0xfffffc20, s22
    v_mov_b32 v14, s22
    v_cmp_le_u32 vcc, 16, v13
    s_nop 0
    v_mov_b32 v15, s40
    v_cndmask_b32 v14, v14, v15, vcc
    v_add_u32 v10, v10, v14
    v_sub_u32 v14, 2048, v10
    buffer_load_dwordx4 v[28:31], v123, s[8:11], s60 offen
    v_cmp_eq_u32 vcc, 0, v10
    v_mov_b32 v15, 1024
    s_nop 0
    v_cndmask_b32 v14, v14, v15, vcc
    v_cmp_eq_u32 vcc, 1, v7
    s_nop 1
    v_cndmask_b32 v10, v10, v14, vcc
    v_mul_u32_u24 v10, 1280, v10
    v_lshl_add_u32 v242, v8, 3, v10
    s_mul_i32 s28, s3, 20480
    s_mul_i32 s29, s22, 82048
    s_add_u32 s29, s29, s28
    s_or_b32 s34, s22, s23
    s_cmp_eq_u32 s34, 0
    s_cselect_b32 s34, 1, 0
    s_cselect_b32 s36, 1, 8
    v_bfe_u32 v9, v4, 1, 2
    buffer_load_dwordx4 v[32:35], v124, s[8:11], s60 offen
    v_add_u32 v9, s31, v9
    v_mov_b32 v13, 0
    v_lshlrev_b32 v10, 6, v9
    s_cmp_eq_u32 s22, 0
    s_cselect_b32 s40, 0xfffffc20, s22
    v_mov_b32 v11, s22
    v_cmp_le_u32 vcc, 16, v9
    s_nop 0
    v_mov_b32 v12, s40
    v_cndmask_b32 v11, v11, v12, vcc
    v_add_u32 v10, v10, v11
    v_sub_u32 v11, 2048, v10
    v_cmp_eq_u32 vcc, 0, v10
    v_mov_b32 v12, 1024
    s_nop 0
    v_cndmask_b32 v11, v11, v12, vcc
    buffer_load_dwordx4 v[44:47], v122, s[8:11], s61 offen
    v_cmp_eq_u32 vcc, 1, v13
    s_nop 1
    v_cndmask_b32 v10, v10, v11, vcc
    v_and_b32 v12, 7, v4
    v_mov_b32 v11, 1024
    v_cmp_eq_u32 vcc, s36, v12
    s_nop 1
    v_cndmask_b32 v10, v10, v11, vcc
    v_and_b32 v11, 1, v4
    v_cndmask_b32 v11, v11, 0, vcc
    v_cvt_f32_u32 v11, v11
    v_mul_f32 v11, 0x3e800000, v11
    v_bfe_u32 v12, v10, 5, 1
    v_cvt_f32_u32 v12, v12
    v_cvt_f32_u32 v10, v10
    v_mul_f32 v10, 0x3a000000, v10
    v_cvt_f32_u32 v9, v5
    buffer_load_dwordx4 v[48:51], v123, s[8:11], s61 offen
    v_add_f32 v9, v9, v9
    v_fma_f32 v11, v9, v10, v11
    s_cmp_eq_u32 s22, 0
    s_cselect_b32 s40, 0, 0xbe800000
    s_cselect_b32 s41, 1.0, 0
    s_cselect_b32 s42, 0, 1.0
    v_add_f32 v13, s40, v11
    v_mul_f32 v12, s41, v12
    v_sub_f32 v9, 1.0, v12
    v_add_f32 v12, s42, v12
    v_fmamk_f32 v216, v10, 0x00000000, v11
    v_fmamk_f32 v217, v10, 0x00000000, v13
    v_fmamk_f32 v218, v10, 0x3f800000, v11
    v_fmamk_f32 v219, v10, 0x3f800000, v13
    v_fmamk_f32 v220, v10, 0x41000000, v11
    buffer_load_dwordx4 v[52:55], v124, s[8:11], s61 offen
    v_fmamk_f32 v221, v10, 0x41000000, v13
    v_fmamk_f32 v222, v10, 0x41100000, v11
    v_fmamk_f32 v223, v10, 0x41100000, v13
    v_fmamk_f32 v224, v10, 0x41800000, v11
    v_fmamk_f32 v225, v10, 0x41800000, v13
    v_fmamk_f32 v226, v10, 0x41880000, v11
    v_fmamk_f32 v227, v10, 0x41880000, v13
    v_fmamk_f32 v228, v10, 0x41c00000, v11
    v_fmamk_f32 v229, v10, 0x41c00000, v13
    v_fmamk_f32 v230, v10, 0x41c80000, v11
    v_fmamk_f32 v231, v10, 0x41c80000, v13
    v_cos_f32 v216, v216
    v_cos_f32 v217, v217
    v_cos_f32 v218, v218
    v_cos_f32 v219, v219
    buffer_load_dwordx4 v[64:67], v122, s[8:11], s62 offen
    v_cos_f32 v220, v220
    v_cos_f32 v221, v221
    v_cos_f32 v222, v222
    v_cos_f32 v223, v223
    v_cos_f32 v224, v224
    v_cos_f32 v225, v225
    v_cos_f32 v226, v226
    v_cos_f32 v227, v227
    v_cos_f32 v228, v228
    v_cos_f32 v229, v229
    v_cos_f32 v230, v230
    v_cos_f32 v231, v231
    v_mul_f32 v216, v216, v9
    v_mul_f32 v217, v217, v12
    v_mul_f32 v218, v218, v9
    buffer_load_dwordx4 v[68:71], v123, s[8:11], s62 offen
    v_mul_f32 v219, v219, v12
    v_mul_f32 v220, v220, v9
    v_mul_f32 v221, v221, v12
    v_mul_f32 v222, v222, v9
    v_mul_f32 v223, v223, v12
    v_mul_f32 v224, v224, v9
    v_mul_f32 v225, v225, v12
    v_mul_f32 v226, v226, v9
    v_mul_f32 v227, v227, v12
    v_mul_f32 v228, v228, v9
    v_mul_f32 v229, v229, v12
    v_mul_f32 v230, v230, v9
    v_mul_f32 v231, v231, v12
    v_cvt_pk_bf16_f32 v128, v216, v217
    v_cvt_pk_bf16_f32 v129, v218, v219
    buffer_load_dwordx4 v[72:75], v124, s[8:11], s62 offen
    v_cvt_pk_bf16_f32 v130, v220, v221
    v_cvt_pk_bf16_f32 v131, v222, v223
    v_cvt_pk_bf16_f32 v132, v224, v225
    v_cvt_pk_bf16_f32 v133, v226, v227
    v_cvt_pk_bf16_f32 v134, v228, v229
    v_cvt_pk_bf16_f32 v135, v230, v231
    v_bfe_u32 v9, v2, 2, 2
    v_lshrrev_b32 v11, 1, v9
    v_lshl_add_u32 v11, v5, 1, v11
    v_lshlrev_b32 v11, 7, v11
    v_and_b32 v9, 1, v9
    v_lshl_add_u32 v11, v9, 6, v11
    v_and_b32 v9, 3, v2
    v_lshl_add_u32 v11, v9, 3, v11
    v_and_b32 v12, 1, v5
    buffer_load_dwordx4 v[84:87], v122, s[8:11], s63 offen
    v_lshl_add_u32 v11, v12, 5, v11
    v_add_u32 v9, s28, v11
    v_xor_b32 v11, 32, v9
    s_mul_i32 s30, s3, 640
    s_add_u32 s30, s30, 2632192
    s_lshl_b32 s33, s3, 10
    s_add_u32 s33, s33, 129792
    v_lshrrev_b32 v13, 3, v4
    v_lshl_add_u32 v13, v13, 2, v5
    v_lshlrev_b32 v6, 4, v13
    v_add_u32 v6, s33, v6
    v_and_b32 v12, 7, v4
    v_mul_u32_u24 v12, 1288, v12
    v_lshl_add_u32 v12, v13, 3, v12
    s_mul_i32 s35, s3, 320
    buffer_load_dwordx4 v[88:91], v123, s[8:11], s63 offen
    s_add_u32 s35, s35, 116736
    v_add_u32 v12, s35, v12
    s_lshl_b32 s35, s3, 14
    v_bfe_u32 v13, v2, 2, 2
    v_and_b32 v14, 1, v5
    v_lshl_add_u32 v13, v14, 2, v13
    v_lshrrev_b32 v14, 1, v5
    v_lshl_add_u32 v13, v13, 1, v14
    v_mul_u32_u24 v13, 80, v13
    v_and_b32 v14, 3, v2
    v_lshl_add_u32 v13, v14, 3, v13
    s_mul_i32 s38, s3, 2576
    s_add_u32 s38, s38, 116736
    v_add_u32 v234, s38, v13
    v_lshl_add_u32 v13, v5, 6, v4
    buffer_load_dwordx4 v[92:95], v124, s[8:11], s63 offen
    v_lshlrev_b32 v13, 2, v13
    s_add_u32 s38, s35, 4096
    v_add_u32 v237, s38, v13
    s_add_u32 s39, s35, 8512
    v_sub_u32 v238, s39, v13
    v_cmp_eq_u32 vcc, 0, v2
    v_subrev_u32 v13, 2560, v238
    s_nop 0
    v_cndmask_b32 v239, v238, v13, vcc
    v_lshlrev_b32 v13, 12, v7
    v_lshl_add_u32 v13, v8, 4, v13
    v_add_u32 v241, s38, v13
    v_lshlrev_b32 v14, 4, v8
    v_add_u32 v14, 137984, v14
    v_add_u32 v15, 146176, v3
    s_lshl_b32 s38, s22, 6
    s_lshl_b32 s39, s23, 3
    s_add_u32 s38, s38, s39
    s_lshl_b32 s39, s3, 1
    s_add_u32 s38, s38, s39
    s_mul_i32 s38, s38, 1280
    s_add_u32 s39, s38, 12582912
    s_add_u32 s38, s38, 9437184
    v_mul_u32_u24 v10, 1280, v7
    v_lshl_add_u32 v10, v8, 3, v10
    s_mov_b64 s[42:43], s[26:27]
    s_cmp_lt_u32 s3, 2
    s_cselect_b32 s4, s44, s46
    s_cselect_b32 s5, s45, s47
    s_mov_b32 s6, 0x1e0000
    s_mov_b32 s7, 0x20000
    s_lshl_b32 s40, s3, 12
    s_add_u32 s42, s42, K2_table-K_pc
    s_addc_u32 s43, s43, 0
    s_add_u32 s0, s42, s40
    s_addc_u32 s1, s43, 0
    s_add_u32 m0, s40, 146176
    s_nop 0
    global_load_lds_dwordx4 v3, s[0:1] offset:0
    global_load_lds_dwordx4 v3, s[0:1] offset:1024
    global_load_lds_dwordx4 v3, s[0:1] offset:2048
    global_load_lds_dwordx4 v3, s[0:1] offset:3072
    s_lshl_b32 s40, s3, 8
    s_add_u32 s40, s40, 16384
    s_add_u32 s0, s42, s40
    s_addc_u32 s1, s43, 0
    s_add_u32 m0, s40, 146176
    s_mov_b64 exec, 0xffff
    global_load_lds_dwordx4 v3, s[0:1]
    s_mov_b64 exec, -1
    v_lshrrev_b32 v216, 1, v4
    v_lshl_add_u32 v216, v1, 3, v216
    v_and_b32 v217, 1, v4
    v_cmp_eq_u32 vcc, 0, v216
    v_lshlrev_b32 v218, 5, v217
    s_nop 0
    v_cndmask_b32 v218, v216, v218, vcc
    v_cvt_f32_u32 v219, v217
    v_mul_f32 v219, 0x3e800000, v219
    v_cndmask_b32 v219, v219, 0, vcc
    v_cvt_f32_u32 v218, v218
    v_mul_f32 v218, 0x3c800000, v218
    v_cvt_f32_u32 v220, v5
    v_mul_f32 v220, 0x41000000, v220
    v_fma_f32 v219, v220, v218, v219
    v_fmamk_f32 v100, v218, 0x00000000, v219
    v_fmamk_f32 v101, v218, 0x3f800000, v219
    v_fmamk_f32 v102, v218, 0x40000000, v219
    v_fmamk_f32 v103, v218, 0x40400000, v219
    v_fmamk_f32 v104, v218, 0x40800000, v219
    v_fmamk_f32 v105, v218, 0x40a00000, v219
    v_fmamk_f32 v106, v218, 0x40c00000, v219
    v_fmamk_f32 v107, v218, 0x40e00000, v219
    v_fmamk_f32 v108, v218, 0x42000000, v219
    v_fmamk_f32 v109, v218, 0x42040000, v219
    v_fmamk_f32 v110, v218, 0x42080000, v219
    v_fmamk_f32 v111, v218, 0x420c0000, v219
    v_fmamk_f32 v112, v218, 0x42100000, v219
    v_fmamk_f32 v113, v218, 0x42140000, v219
    v_fmamk_f32 v114, v218, 0x42180000, v219
    v_fmamk_f32 v115, v218, 0x421c0000, v219
    v_cos_f32 v100, v100
    v_cos_f32 v101, v101
    v_cos_f32 v102, v102
    v_cos_f32 v103, v103
    v_cos_f32 v104, v104
    v_cos_f32 v105, v105
    v_cos_f32 v106, v106
    v_cos_f32 v107, v107
    v_cos_f32 v108, v108
    v_cos_f32 v109, v109
    v_cos_f32 v110, v110
    v_cos_f32 v111, v111
    v_cos_f32 v112, v112
    v_cos_f32 v113, v113
    v_cos_f32 v114, v114
    v_cos_f32 v115, v115
    v_lshrrev_b32 v216, 3, v2
    v_lshl_add_u32 v216, v1, 3, v216
    s_mov_b32 s96, 82048
    v_mul_lo_u32 v116, v216, s96
    s_and_b32 s97, s94, 2
    s_lshl_b32 s97, s97, 4
    v_and_b32 v216, 7, v2
    v_lshlrev_b32 v216, 4, v216
    v_xor_b32 v216, s97, v216
    v_add_u32 v116, v116, v216
    s_mul_i32 s99, s3, 5760
    s_add_u32 s99, s99, 21504
    v_lshl_add_u32 v98, v4, 2, v5
    v_lshrrev_b32 v99, 3, v98
    v_add_u32 v98, v98, v99
    v_lshlrev_b32 v98, 4, v98
    v_add_u32 v98, s99, v98
    v_lshrrev_b32 v99, 3, v2
    v_add_u32 v99, v99, v2
    v_lshlrev_b32 v99, 4, v99
    v_add_u32 v99, s99, v99
    s_mul_i32 s98, s95, 20480
    s_lshl_b32 s99, s94, 7
    s_add_u32 s98, s98, s99
    v_lshl_add_u32 v216, v1, 4, v5
    v_mul_u32_u24 v216, 320, v216
    v_lshl_add_u32 v117, v4, 4, v216
    v_bfe_u32 v216, v2, 2, 2
    v_lshl_add_u32 v216, v5, 3, v216
    v_mul_u32_u24 v216, 320, v216
    v_and_b32 v217, 3, v2
    v_lshl_add_u32 v118, v217, 4, v216
    v_mov_b32 v119, 0x3f803f80
    s_mov_b32 s92, 0x000f000f
    s_mov_b32 s93, 0x000f000f
    v_lshl_add_u32 v96, v4, 2, v5
    v_lshl_add_u32 v96, v1, 4, v96
    v_lshlrev_b32 v97, 2, v96
    v_lshlrev_b32 v96, 1, v96
    v_cmp_eq_u32 s[86:87], 1, v4
    v_cmp_eq_u32 s[88:89], 2, v4
    v_cmp_eq_u32 s[90:91], 3, v4
    v_mov_b32 v120, 0
    v_mov_b32 v124, 0
    v_mov_b32 v121, 0
    v_mov_b32 v125, 0
    v_mov_b32 v122, 0
    v_mov_b32 v126, 0
    v_mov_b32 v123, 0
    v_mov_b32 v127, 0
    s_waitcnt vmcnt(24)
    ds_write_b128 v117, v[16:19] offset:0
    v_dot2c_f32_bf16 v120, v16, v119
    v_dot2c_f32_bf16 v124, v16, v16
    v_dot2c_f32_bf16 v120, v17, v119
    v_dot2c_f32_bf16 v124, v17, v17
    v_dot2c_f32_bf16 v120, v18, v119
    v_dot2c_f32_bf16 v124, v18, v18
    v_dot2c_f32_bf16 v120, v19, v119
    v_dot2c_f32_bf16 v124, v19, v19
    s_waitcnt vmcnt(23)
    s_mov_b64 exec, s[92:93]
    ds_write_b128 v117, v[20:23] offset:256
    s_mov_b64 exec, -1
    v_dot2c_f32_bf16 v120, v20, v119
    v_dot2c_f32_bf16 v124, v20, v20
    v_dot2c_f32_bf16 v120, v21, v119
    v_dot2c_f32_bf16 v124, v21, v21
    v_dot2c_f32_bf16 v120, v22, v119
    v_dot2c_f32_bf16 v124, v22, v22
    v_dot2c_f32_bf16 v120, v23, v119
    v_dot2c_f32_bf16 v124, v23, v23
    s_waitcnt vmcnt(22)
    ds_write_b128 v117, v[36:39] offset:1280
    v_dot2c_f32_bf16 v121, v36, v119
    v_dot2c_f32_bf16 v125, v36, v36
    v_dot2c_f32_bf16 v121, v37, v119
    v_dot2c_f32_bf16 v125, v37, v37
    v_dot2c_f32_bf16 v121, v38, v119
    v_dot2c_f32_bf16 v125, v38, v38
    v_dot2c_f32_bf16 v121, v39, v119
    v_dot2c_f32_bf16 v125, v39, v39
    s_waitcnt vmcnt(21)
    s_mov_b64 exec, s[92:93]
    ds_write_b128 v117, v[40:43] offset:1536
    s_mov_b64 exec, -1
    v_dot2c_f32_bf16 v121, v40, v119
    v_dot2c_f32_bf16 v125, v40, v40
    v_dot2c_f32_bf16 v121, v41, v119
    v_dot2c_f32_bf16 v125, v41, v41
    v_dot2c_f32_bf16 v121, v42, v119
    v_dot2c_f32_bf16 v125, v42, v42
    v_dot2c_f32_bf16 v121, v43, v119
    v_dot2c_f32_bf16 v125, v43, v43
    s_waitcnt vmcnt(20)
    ds_write_b128 v117, v[56:59] offset:2560
    v_dot2c_f32_bf16 v122, v56, v119
    v_dot2c_f32_bf16 v126, v56, v56
    v_dot2c_f32_bf16 v122, v57, v119
    v_dot2c_f32_bf16 v126, v57, v57
    v_dot2c_f32_bf16 v122, v58, v119
    v_dot2c_f32_bf16 v126, v58, v58
    v_dot2c_f32_bf16 v122, v59, v119
    v_dot2c_f32_bf16 v126, v59, v59
    s_waitcnt vmcnt(19)
    s_mov_b64 exec, s[92:93]
    ds_write_b128 v117, v[60:63] offset:2816
    s_mov_b64 exec, -1
    v_dot2c_f32_bf16 v122, v60, v119
    v_dot2c_f32_bf16 v126, v60, v60
    v_dot2c_f32_bf16 v122, v61, v119
    v_dot2c_f32_bf16 v126, v61, v61
    v_dot2c_f32_bf16 v122, v62, v119
    v_dot2c_f32_bf16 v126, v62, v62
    v_dot2c_f32_bf16 v122, v63, v119
    v_dot2c_f32_bf16 v126, v63, v63
    s_waitcnt vmcnt(18)
    ds_write_b128 v117, v[76:79] offset:3840
    v_dot2c_f32_bf16 v123, v76, v119
    v_dot2c_f32_bf16 v127, v76, v76
    v_dot2c_f32_bf16 v123, v77, v119
    v_dot2c_f32_bf16 v127, v77, v77
    v_dot2c_f32_bf16 v123, v78, v119
    v_dot2c_f32_bf16 v127, v78, v78
    v_dot2c_f32_bf16 v123, v79, v119
    v_dot2c_f32_bf16 v127, v79, v79
    s_waitcnt vmcnt(17)
    s_mov_b64 exec, s[92:93]
    ds_write_b128 v117, v[80:83] offset:4096
    s_mov_b64 exec, -1
    s_waitcnt lgkmcnt(0)
    s_barrier
    v_dot2c_f32_bf16 v123, v80, v119
    v_dot2c_f32_bf16 v127, v80, v80
    v_dot2c_f32_bf16 v123, v81, v119
    v_dot2c_f32_bf16 v127, v81, v81
    v_dot2c_f32_bf16 v123, v82, v119
    v_dot2c_f32_bf16 v127, v82, v82
    v_dot2c_f32_bf16 v123, v83, v119
    v_dot2c_f32_bf16 v127, v83, v83
    ds_read_b64_tr_b16 v[136:137], v118 offset:0
    ds_read_b64_tr_b16 v[138:139], v118 offset:1280
    ds_read_b64_tr_b16 v[140:141], v118 offset:10240
    ds_read_b64_tr_b16 v[142:143], v118 offset:11520
    s_waitcnt vmcnt(16)
    v_dot2c_f32_bf16 v120, v24, v119
    v_dot2c_f32_bf16 v124, v24, v24
    v_dot2c_f32_bf16 v120, v25, v119
    v_dot2c_f32_bf16 v124, v25, v25
    v_dot2c_f32_bf16 v120, v26, v119
    v_dot2c_f32_bf16 v124, v26, v26
    v_dot2c_f32_bf16 v120, v27, v119
    v_dot2c_f32_bf16 v124, v27, v27
    ds_read_b64_tr_b16 v[144:145], v118 offset:8
    ds_read_b64_tr_b16 v[146:147], v118 offset:1288
    ds_read_b64_tr_b16 v[148:149], v118 offset:10248
    ds_read_b64_tr_b16 v[150:151], v118 offset:11528
    s_waitcnt vmcnt(15)
    v_dot2c_f32_bf16 v120, v28, v119
    v_dot2c_f32_bf16 v124, v28, v28
    v_dot2c_f32_bf16 v120, v29, v119
    v_dot2c_f32_bf16 v124, v29, v29
    v_dot2c_f32_bf16 v120, v30, v119
    v_dot2c_f32_bf16 v124, v30, v30
    v_dot2c_f32_bf16 v120, v31, v119
    v_dot2c_f32_bf16 v124, v31, v31
    ds_read_b64_tr_b16 v[152:153], v118 offset:64
    ds_read_b64_tr_b16 v[154:155], v118 offset:1344
    ds_read_b64_tr_b16 v[156:157], v118 offset:10304
    ds_read_b64_tr_b16 v[158:159], v118 offset:11584
    s_waitcnt vmcnt(14)
    v_dot2c_f32_bf16 v120, v32, v119
    v_dot2c_f32_bf16 v124, v32, v32
    v_dot2c_f32_bf16 v120, v33, v119
    v_dot2c_f32_bf16 v124, v33, v33
    v_dot2c_f32_bf16 v120, v34, v119
    v_dot2c_f32_bf16 v124, v34, v34
    v_dot2c_f32_bf16 v120, v35, v119
    v_dot2c_f32_bf16 v124, v35, v35
    ds_read_b64_tr_b16 v[160:161], v118 offset:72
    ds_read_b64_tr_b16 v[162:163], v118 offset:1352
    ds_read_b64_tr_b16 v[164:165], v118 offset:10312
    ds_read_b64_tr_b16 v[166:167], v118 offset:11592
    s_waitcnt vmcnt(13)
    v_dot2c_f32_bf16 v121, v44, v119
    v_dot2c_f32_bf16 v125, v44, v44
    v_dot2c_f32_bf16 v121, v45, v119
    v_dot2c_f32_bf16 v125, v45, v45
    v_dot2c_f32_bf16 v121, v46, v119
    v_dot2c_f32_bf16 v125, v46, v46
    v_dot2c_f32_bf16 v121, v47, v119
    v_dot2c_f32_bf16 v125, v47, v47
    v_add_f32_dpp v120, v120, v120 row_ror:8 row_mask:0xf bank_mask:0xf
    v_add_f32_dpp v124, v124, v124 row_ror:8 row_mask:0xf bank_mask:0xf
    s_nop 0
    v_add_f32_dpp v120, v120, v120 row_ror:4 row_mask:0xf bank_mask:0xf
    v_add_f32_dpp v124, v124, v124 row_ror:4 row_mask:0xf bank_mask:0xf
    s_nop 0
    v_add_f32_dpp v120, v120, v120 row_ror:2 row_mask:0xf bank_mask:0xf
    v_add_f32_dpp v124, v124, v124 row_ror:2 row_mask:0xf bank_mask:0xf
    s_nop 0
    v_add_f32_dpp v120, v120, v120 row_ror:1 row_mask:0xf bank_mask:0xf
    v_add_f32_dpp v124, v124, v124 row_ror:1 row_mask:0xf bank_mask:0xf
    ds_read_b64_tr_b16 v[168:169], v118 offset:128
    ds_read_b64_tr_b16 v[170:171], v118 offset:1408
    ds_read_b64_tr_b16 v[172:173], v118 offset:10368
    ds_read_b64_tr_b16 v[174:175], v118 offset:11648
    s_waitcnt vmcnt(12)
    v_dot2c_f32_bf16 v121, v48, v119
    v_dot2c_f32_bf16 v125, v48, v48
    v_dot2c_f32_bf16 v121, v49, v119
    v_dot2c_f32_bf16 v125, v49, v49
    v_dot2c_f32_bf16 v121, v50, v119
    v_dot2c_f32_bf16 v125, v50, v50
    v_dot2c_f32_bf16 v121, v51, v119
    v_dot2c_f32_bf16 v125, v51, v51
    ds_read_b64_tr_b16 v[176:177], v118 offset:136
    ds_read_b64_tr_b16 v[178:179], v118 offset:1416
    ds_read_b64_tr_b16 v[180:181], v118 offset:10376
    ds_read_b64_tr_b16 v[182:183], v118 offset:11656
    s_waitcnt vmcnt(11)
    v_dot2c_f32_bf16 v121, v52, v119
    v_dot2c_f32_bf16 v125, v52, v52
    v_dot2c_f32_bf16 v121, v53, v119
    v_dot2c_f32_bf16 v125, v53, v53
    v_dot2c_f32_bf16 v121, v54, v119
    v_dot2c_f32_bf16 v125, v54, v54
    v_dot2c_f32_bf16 v121, v55, v119
    v_dot2c_f32_bf16 v125, v55, v55
    ds_read_b64_tr_b16 v[184:185], v118 offset:192
    ds_read_b64_tr_b16 v[186:187], v118 offset:1472
    ds_read_b64_tr_b16 v[188:189], v118 offset:10432
    ds_read_b64_tr_b16 v[190:191], v118 offset:11712
    s_waitcnt vmcnt(10)
    v_dot2c_f32_bf16 v122, v64, v119
    v_dot2c_f32_bf16 v126, v64, v64
    v_dot2c_f32_bf16 v122, v65, v119
    v_dot2c_f32_bf16 v126, v65, v65
    v_dot2c_f32_bf16 v122, v66, v119
    v_dot2c_f32_bf16 v126, v66, v66
    v_dot2c_f32_bf16 v122, v67, v119
    v_dot2c_f32_bf16 v126, v67, v67
    v_add_f32_dpp v121, v121, v121 row_ror:8 row_mask:0xf bank_mask:0xf
    v_add_f32_dpp v125, v125, v125 row_ror:8 row_mask:0xf bank_mask:0xf
    s_nop 0
    v_add_f32_dpp v121, v121, v121 row_ror:4 row_mask:0xf bank_mask:0xf
    v_add_f32_dpp v125, v125, v125 row_ror:4 row_mask:0xf bank_mask:0xf
    s_nop 0
    v_add_f32_dpp v121, v121, v121 row_ror:2 row_mask:0xf bank_mask:0xf
    v_add_f32_dpp v125, v125, v125 row_ror:2 row_mask:0xf bank_mask:0xf
    s_nop 0
    v_add_f32_dpp v121, v121, v121 row_ror:1 row_mask:0xf bank_mask:0xf
    v_add_f32_dpp v125, v125, v125 row_ror:1 row_mask:0xf bank_mask:0xf
    ds_read_b64_tr_b16 v[192:193], v118 offset:200
    ds_read_b64_tr_b16 v[194:195], v118 offset:1480
    ds_read_b64_tr_b16 v[196:197], v118 offset:10440
    ds_read_b64_tr_b16 v[198:199], v118 offset:11720
    s_waitcnt vmcnt(9)
    v_dot2c_f32_bf16 v122, v68, v119
    v_dot2c_f32_bf16 v126, v68, v68
    v_dot2c_f32_bf16 v122, v69, v119
    v_dot2c_f32_bf16 v126, v69, v69
    v_dot2c_f32_bf16 v122, v70, v119
    v_dot2c_f32_bf16 v126, v70, v70
    v_dot2c_f32_bf16 v122, v71, v119
    v_dot2c_f32_bf16 v126, v71, v71
    ds_read_b64_tr_b16 v[200:201], v118 offset:256
    ds_read_b64_tr_b16 v[202:203], v118 offset:1536
    ds_read_b64_tr_b16 v[204:205], v118 offset:10496
    ds_read_b64_tr_b16 v[206:207], v118 offset:11776
    s_waitcnt vmcnt(8)
    v_dot2c_f32_bf16 v122, v72, v119
    v_dot2c_f32_bf16 v126, v72, v72
    v_dot2c_f32_bf16 v122, v73, v119
    v_dot2c_f32_bf16 v126, v73, v73
    v_dot2c_f32_bf16 v122, v74, v119
    v_dot2c_f32_bf16 v126, v74, v74
    v_dot2c_f32_bf16 v122, v75, v119
    v_dot2c_f32_bf16 v126, v75, v75
    ds_read_b64_tr_b16 v[208:209], v118 offset:264
    ds_read_b64_tr_b16 v[210:211], v118 offset:1544
    ds_read_b64_tr_b16 v[212:213], v118 offset:10504
    ds_read_b64_tr_b16 v[214:215], v118 offset:11784
    s_waitcnt vmcnt(7)
    v_dot2c_f32_bf16 v123, v84, v119
    v_dot2c_f32_bf16 v127, v84, v84
    v_dot2c_f32_bf16 v123, v85, v119
    v_dot2c_f32_bf16 v127, v85, v85
    v_dot2c_f32_bf16 v123, v86, v119
    v_dot2c_f32_bf16 v127, v86, v86
    v_dot2c_f32_bf16 v123, v87, v119
    v_dot2c_f32_bf16 v127, v87, v87
    v_add_f32_dpp v122, v122, v122 row_ror:8 row_mask:0xf bank_mask:0xf
    v_add_f32_dpp v126, v126, v126 row_ror:8 row_mask:0xf bank_mask:0xf
    s_nop 0
    v_add_f32_dpp v122, v122, v122 row_ror:4 row_mask:0xf bank_mask:0xf
    v_add_f32_dpp v126, v126, v126 row_ror:4 row_mask:0xf bank_mask:0xf
    s_nop 0
    v_add_f32_dpp v122, v122, v122 row_ror:2 row_mask:0xf bank_mask:0xf
    v_add_f32_dpp v126, v126, v126 row_ror:2 row_mask:0xf bank_mask:0xf
    s_nop 0
    v_add_f32_dpp v122, v122, v122 row_ror:1 row_mask:0xf bank_mask:0xf
    v_add_f32_dpp v126, v126, v126 row_ror:1 row_mask:0xf bank_mask:0xf
    s_waitcnt vmcnt(6)
    v_dot2c_f32_bf16 v123, v88, v119
    v_dot2c_f32_bf16 v127, v88, v88
    v_dot2c_f32_bf16 v123, v89, v119
    v_dot2c_f32_bf16 v127, v89, v89
    v_dot2c_f32_bf16 v123, v90, v119
    v_dot2c_f32_bf16 v127, v90, v90
    v_dot2c_f32_bf16 v123, v91, v119
    v_dot2c_f32_bf16 v127, v91, v91
    s_waitcnt vmcnt(5)
    v_dot2c_f32_bf16 v123, v92, v119
    v_dot2c_f32_bf16 v127, v92, v92
    v_dot2c_f32_bf16 v123, v93, v119
    v_dot2c_f32_bf16 v127, v93, v93
    v_dot2c_f32_bf16 v123, v94, v119
    v_dot2c_f32_bf16 v127, v94, v94
    v_dot2c_f32_bf16 v123, v95, v119
    v_dot2c_f32_bf16 v127, v95, v95
    v_mov_b32 v252, 0
    global_load_dword v253, v252, s[56:57]
    v_add_f32_dpp v123, v123, v123 row_ror:8 row_mask:0xf bank_mask:0xf
    v_add_f32_dpp v127, v127, v127 row_ror:8 row_mask:0xf bank_mask:0xf
    s_nop 0
    v_add_f32_dpp v123, v123, v123 row_ror:4 row_mask:0xf bank_mask:0xf
    v_add_f32_dpp v127, v127, v127 row_ror:4 row_mask:0xf bank_mask:0xf
    s_nop 0
    v_add_f32_dpp v123, v123, v123 row_ror:2 row_mask:0xf bank_mask:0xf
    v_add_f32_dpp v127, v127, v127 row_ror:2 row_mask:0xf bank_mask:0xf
    s_nop 0
    v_add_f32_dpp v123, v123, v123 row_ror:1 row_mask:0xf bank_mask:0xf
    v_add_f32_dpp v127, v127, v127 row_ror:1 row_mask:0xf bank_mask:0xf
    v_cndmask_b32 v120, v120, v121, s[86:87]
    v_cndmask_b32 v120, v120, v122, s[88:89]
    v_cndmask_b32 v120, v120, v123, s[90:91]
    v_cndmask_b32 v124, v124, v125, s[86:87]
    v_cndmask_b32 v124, v124, v126, s[88:89]
    v_cndmask_b32 v124, v124, v127, s[90:91]
    v_mul_f32 v120, 0x3acccccd, v120
    v_mul_f32 v124, 0x3acccccd, v124
    v_fma_f32 v124, -v120, v120, v124
    v_max_f32 v124, 0, v124
    v_add_f32 v124, 0x3727c5ac, v124
    v_rsq_f32 v124, v124
    v_sub_f32 v120, 0, v120
    v_cvt_pk_bf16_f32 v216, v120, v120
    v_lshlrev_b32 v217, 16, v216
    v_sub_f32 v217, v120, v217
    v_cvt_pk_bf16_f32 v217, v217, v217
    s_mov_b64 exec, s[92:93]
    ds_write_b32 v97, v124 offset:20480
    ds_write_b16 v96, v216 offset:20736
    ds_write_b16 v96, v217 offset:20864
    s_mov_b64 exec, -1
    v_lshlrev_b32 v218, 5, v5
    v_lshlrev_b32 v217, 4, v5
    s_waitcnt lgkmcnt(0)
    s_barrier
    ds_read_b128 v[16:19], v218 offset:20480
    ds_read_b128 v[20:23], v218 offset:20496
    ds_read_b128 v[24:27], v218 offset:20608
    ds_read_b128 v[28:31], v218 offset:20624
    ds_read_b128 v[32:35], v217 offset:20736
    ds_read_b128 v[40:43], v217 offset:20864
    ds_read_b128 v[36:39], v217 offset:20800
    ds_read_b128 v[44:47], v217 offset:20928
    s_waitcnt lgkmcnt(6)
    v_pk_mul_f32 v[100:101], v[100:101], v[16:17]
    v_pk_mul_f32 v[102:103], v[102:103], v[18:19]
    v_pk_mul_f32 v[104:105], v[104:105], v[20:21]
    v_pk_mul_f32 v[106:107], v[106:107], v[22:23]
    v_cvt_pk_bf16_f32 v120, v100, v101
    v_cvt_pk_bf16_f32 v121, v102, v103
    v_cvt_pk_bf16_f32 v122, v104, v105
    v_cvt_pk_bf16_f32 v123, v106, v107
    s_waitcnt lgkmcnt(4)
    v_pk_mul_f32 v[108:109], v[108:109], v[24:25]
    v_pk_mul_f32 v[110:111], v[110:111], v[26:27]
    v_pk_mul_f32 v[112:113], v[112:113], v[28:29]
    v_pk_mul_f32 v[114:115], v[114:115], v[30:31]
    v_cvt_pk_bf16_f32 v124, v108, v109
    v_cvt_pk_bf16_f32 v125, v110, v111
    v_cvt_pk_bf16_f32 v126, v112, v113
    v_cvt_pk_bf16_f32 v127, v114, v115
    s_waitcnt lgkmcnt(0)
    v_mfma_f32_16x16x32_bf16 v[16:19], v[32:35], v[120:123], 0
    v_mfma_f32_16x16x32_bf16 v[16:19], v[40:43], v[120:123], v[16:19]
    v_mfma_f32_16x16x32_bf16 v[16:19], v[36:39], v[124:127], v[16:19]
    v_mfma_f32_16x16x32_bf16 v[16:19], v[44:47], v[124:127], v[16:19]
    v_mfma_f32_16x16x32_bf16 v[48:51], v[136:139], v[120:123], v[16:19]
    v_mfma_f32_16x16x32_bf16 v[52:55], v[144:147], v[120:123], v[16:19]
    v_mfma_f32_16x16x32_bf16 v[48:51], v[140:143], v[124:127], v[48:51]
    v_mfma_f32_16x16x32_bf16 v[52:55], v[148:151], v[124:127], v[52:55]
    v_mfma_f32_16x16x32_bf16 v[56:59], v[152:155], v[120:123], v[16:19]
    v_mfma_f32_16x16x32_bf16 v[60:63], v[160:163], v[120:123], v[16:19]
    v_mfma_f32_16x16x32_bf16 v[56:59], v[156:159], v[124:127], v[56:59]
    v_mfma_f32_16x16x32_bf16 v[60:63], v[164:167], v[124:127], v[60:63]
    v_mfma_f32_16x16x32_bf16 v[64:67], v[168:171], v[120:123], v[16:19]
    v_mfma_f32_16x16x32_bf16 v[68:71], v[176:179], v[120:123], v[16:19]
    v_mfma_f32_16x16x32_bf16 v[64:67], v[172:175], v[124:127], v[64:67]
    v_mfma_f32_16x16x32_bf16 v[68:71], v[180:183], v[124:127], v[68:71]
    v_cvt_pk_bf16_f32 v24, v48, v49
    v_cvt_pk_bf16_f32 v25, v50, v51
    v_cvt_pk_bf16_f32 v26, v52, v53
    v_cvt_pk_bf16_f32 v27, v54, v55
    ds_write_b128 v98, v[24:27] offset:0
    ds_read_b128 v[32:35], v99 offset:0
    v_mfma_f32_16x16x32_bf16 v[72:75], v[184:187], v[120:123], v[16:19]
    v_mfma_f32_16x16x32_bf16 v[76:79], v[192:195], v[120:123], v[16:19]
    v_mfma_f32_16x16x32_bf16 v[72:75], v[188:191], v[124:127], v[72:75]
    v_mfma_f32_16x16x32_bf16 v[76:79], v[196:199], v[124:127], v[76:79]
    v_cvt_pk_bf16_f32 v28, v56, v57
    v_cvt_pk_bf16_f32 v29, v58, v59
    v_cvt_pk_bf16_f32 v30, v60, v61
    v_cvt_pk_bf16_f32 v31, v62, v63
    ds_write_b128 v98, v[28:31] offset:1152
    ds_read_b128 v[36:39], v99 offset:1152
    s_waitcnt lgkmcnt(2)
    buffer_store_dwordx4 v[32:35], v116, s[16:19], s98 offen sc1
    s_add_u32 s98, s98, 4096
    v_mfma_f32_16x16x32_bf16 v[80:83], v[200:203], v[120:123], v[16:19]
    v_mfma_f32_16x16x32_bf16 v[84:87], v[208:211], v[120:123], v[16:19]
    v_mfma_f32_16x16x32_bf16 v[80:83], v[204:207], v[124:127], v[80:83]
    v_mfma_f32_16x16x32_bf16 v[84:87], v[212:215], v[124:127], v[84:87]
    v_cvt_pk_bf16_f32 v24, v64, v65
    v_cvt_pk_bf16_f32 v25, v66, v67
    v_cvt_pk_bf16_f32 v26, v68, v69
    v_cvt_pk_bf16_f32 v27, v70, v71
    ds_write_b128 v98, v[24:27] offset:2304
    ds_read_b128 v[40:43], v99 offset:2304
    s_waitcnt lgkmcnt(2)
    buffer_store_dwordx4 v[36:39], v116, s[16:19], s98 offen sc1
    s_add_u32 s98, s98, 4096
    v_cvt_pk_bf16_f32 v28, v72, v73
    v_cvt_pk_bf16_f32 v29, v74, v75
    v_cvt_pk_bf16_f32 v30, v76, v77
    v_cvt_pk_bf16_f32 v31, v78, v79
    ds_write_b128 v98, v[28:31] offset:3456
    ds_read_b128 v[44:47], v99 offset:3456
    s_waitcnt lgkmcnt(2)
    buffer_store_dwordx4 v[40:43], v116, s[16:19], s98 offen sc1
    s_add_u32 s98, s98, 4096
    v_cvt_pk_bf16_f32 v24, v80, v81
    v_cvt_pk_bf16_f32 v25, v82, v83
    v_cvt_pk_bf16_f32 v26, v84, v85
    v_cvt_pk_bf16_f32 v27, v86, v87
    ds_write_b128 v98, v[24:27] offset:4608
    ds_read_b128 v[88:91], v99 offset:4608
    s_waitcnt lgkmcnt(2)
    buffer_store_dwordx4 v[44:47], v116, s[16:19], s98 offen sc1
    s_add_u32 s98, s98, 4096
    s_waitcnt lgkmcnt(0)
    buffer_store_dwordx4 v[88:91], v116, s[16:19], s98 offen sc1
    s_add_u32 s98, s98, 4096
K_join:
    v_cmp_gt_u32 vcc, 8, v4
    s_nop 1
    v_cndmask_b32 v76, v128, 0, vcc
    v_cndmask_b32 v77, v129, 0, vcc
    v_cndmask_b32 v78, v130, 0, vcc
    v_cndmask_b32 v79, v131, 0, vcc
    v_cndmask_b32 v80, v132, 0, vcc
    v_cndmask_b32 v81, v133, 0, vcc
    v_cndmask_b32 v82, v134, 0, vcc
    v_cndmask_b32 v83, v135, 0, vcc
    v_cndmask_b32 v128, 0, v128, vcc
    v_cndmask_b32 v129, 0, v129, vcc
    v_cndmask_b32 v130, 0, v130, vcc
    v_cndmask_b32 v131, 0, v131, vcc
    v_cndmask_b32 v132, 0, v132, vcc
    v_cndmask_b32 v133, 0, v133, vcc
    v_cndmask_b32 v134, 0, v134, vcc
    v_cndmask_b32 v135, 0, v135, vcc
    s_and_b32 s45, s3, 1
    s_mul_i32 s44, s45, 98304
    s_mul_i32 s52, s25, 192
    s_add_u32 s44, s44, s52
    s_mul_i32 s52, s3, 6144
    s_add_u32 s52, s52, 65536
    s_and_b32 s45, s3, 2
    v_add_u32 v216, 0, v2
    v_mul_u32_u24 v217, 5462, v216
    v_lshrrev_b32 v217, 16, v217
    v_mul_u32_u24 v218, 12, v217
    v_sub_u32 v218, v216, v218
    v_lshrrev_b32 v216, 2, v217
    v_and_b32 v216, 2, v216
    v_xor_b32 v218, v216, v218
    v_mul_u32_u24 v217, 3072, v217
    v_lshl_add_u32 v248, v218, 4, v217
    v_add_u32 v216, 64, v2
    v_mul_u32_u24 v217, 5462, v216
    v_lshrrev_b32 v217, 16, v217
    v_mul_u32_u24 v218, 12, v217
    v_sub_u32 v218, v216, v218
    v_lshrrev_b32 v216, 2, v217
    v_and_b32 v216, 2, v216
    v_xor_b32 v218, v216, v218
    v_mul_u32_u24 v217, 3072, v217
    v_lshl_add_u32 v249, v218, 4, v217
    v_add_u32 v216, 128, v2
    v_mul_u32_u24 v217, 5462, v216
    v_lshrrev_b32 v217, 16, v217
    v_mul_u32_u24 v218, 12, v217
    v_sub_u32 v218, v216, v218
    v_lshrrev_b32 v216, 2, v217
    v_and_b32 v216, 2, v216
    v_xor_b32 v218, v216, v218
    v_mul_u32_u24 v217, 3072, v217
    v_lshl_add_u32 v250, v218, 4, v217
    s_cmp_ge_u32 s25, 10
    s_cselect_b32 s50, 10, 0
    s_sub_u32 s50, s25, s50
    s_mov_b32 s51, s50
    s_and_b32 s51, s24, 3
    s_lshl_b32 s51, s51, 2
    s_lshr_b32 s51, 0x5050, s51
    s_and_b32 s51, s51, 15
    s_add_u32 s50, s50, s51
    s_cmp_ge_u32 s50, 10
    s_cselect_b32 s51, 10, 0
    s_sub_u32 s50, s50, s51
    s_mov_b32 s51, s50
    s_mul_i32 s86, s23, 245760
    s_mul_i32 s63, s3, 61440
    s_add_u32 s86, s86, s63
    s_add_u32 s86, s86, 7340032
    s_add_u32 s87, s86, 4096
    s_add_u32 s88, s86, 8192
    s_add_u32 s89, s86, 12288
    s_add_u32 s90, s86, 16384
    s_add_u32 s91, s86, 20480
    s_add_u32 s92, s86, 24576
    s_add_u32 s93, s86, 28672
    s_add_u32 s94, s86, 32768
    s_add_u32 s95, s86, 36864
    s_add_u32 s96, s86, 40960
    s_add_u32 s97, s86, 45056
    s_add_u32 s98, s86, 49152
    s_add_u32 s99, s86, 53248
    s_add_u32 s100, s86, 57344
    s_and_b32 s43, s2, 7
    s_lshl_b32 s43, s43, 8
    s_add_u32 s43, s43, 3145728
    v_mul_u32_u24 v247, 2048, v2
    v_mov_b32 v251, 1
    s_mul_i32 s42, s3, 32768
    s_add_u32 s43, s43, s42
    s_waitcnt vmcnt(0)
    s_barrier
    s_mov_b32 s41, 0
    v_readfirstlane_b32 s40, v253
    s_cmp_lt_u32 s40, 8
    s_cbranch_scc1 K_x8
K_g2:
    s_mov_b64 exec, 0xffff
    buffer_atomic_add v251, v247, s[16:19], s43 offen sc1
    s_mov_b64 exec, -1
K_g1:
    s_cmp_ge_u32 s2, 192
    s_cbranch_scc1 K_x9
K_g9:
    s_mul_i32 s53, s50, 196608
    s_add_u32 s53, s53, s44
    s_add_u32 s50, s50, 1
    s_cmp_eq_u32 s50, 10
    s_cselect_b32 s50, 0, s50
    s_add_u32 m0, s52, 24576
    s_nop 0
    buffer_load_dwordx4 v248, s[4:7], s53 offen lds
    s_add_u32 m0, s52, 25600
    s_nop 0
    buffer_load_dwordx4 v249, s[4:7], s53 offen lds
    s_add_u32 m0, s52, 26624
    s_nop 0
    buffer_load_dwordx4 v250, s[4:7], s53 offen lds
    s_add_u32 m0, s52, 27648
    s_add_u32 s53, s53, 49152
    buffer_load_dwordx4 v248, s[4:7], s53 offen lds
    s_add_u32 m0, s52, 28672
    s_nop 0
    buffer_load_dwordx4 v249, s[4:7], s53 offen lds
    s_add_u32 m0, s52, 29696
    s_nop 0
    buffer_load_dwordx4 v250, s[4:7], s53 offen lds
    v_lshlrev_b32 v251, 5, v0
    v_add_u32 v251, K_g4-K_pc, v251
    v_min_u32 v251, K2_table-K_pc, v251
    s_mov_b32 exec_lo, 0x11111111
    s_mov_b32 exec_hi, 0x11111111
    global_load_dword v251, v251, s[26:27]
    s_mov_b64 exec, -1
    ds_read_b128 v[136:139], v15 offset:0
    ds_read_b128 v[140:143], v15 offset:1024
    ds_read_b128 v[144:147], v15 offset:2048
    ds_read_b128 v[148:151], v15 offset:3072
    ds_read_b128 v[152:155], v15 offset:4096
    ds_read_b128 v[156:159], v15 offset:5120
    ds_read_b128 v[160:163], v15 offset:6144
    ds_read_b128 v[164:167], v15 offset:7168
    ds_read_b128 v[168:171], v15 offset:8192
    ds_read_b128 v[172:175], v15 offset:9216
    ds_read_b128 v[176:179], v15 offset:10240
    ds_read_b128 v[180:183], v15 offset:11264
    ds_read_b128 v[184:187], v15 offset:12288
    ds_read_b128 v[188:191], v15 offset:13312
    ds_read_b128 v[192:195], v15 offset:14336
    ds_read_b128 v[196:199], v15 offset:15360
    ds_read_b128 v[200:203], v15 offset:16384
    s_cmp_lg_u32 s3, 0
    s_cbranch_scc1 K_g4
    s_lshl_b32 s40, s24, 4
    s_add_u32 s40, s40, s25
    s_lshr_b32 s40, s40, 2
    s_mul_i32 s40, s40, 2048
    s_add_u32 s40, s40, 3145728
    s_add_u32 s0, s16, s40
    s_addc_u32 s1, s17, 0
    s_mov_b32 s41, 0
K_g3:
    s_load_dword s54, s[0:1], 0 glc
    s_load_dword s55, s[0:1], 256 glc
    s_load_dword s56, s[0:1], 512 glc
    s_load_dword s57, s[0:1], 768 glc
    s_load_dword s58, s[0:1], 1024 glc
    s_load_dword s59, s[0:1], 1280 glc
    s_load_dword s60, s[0:1], 1536 glc
    s_load_dword s61, s[0:1], 1792 glc
    s_add_u32 s41, s41, 1
    s_cmp_gt_u32 s41, 0x40000
    s_cbranch_scc1 K_g5
    s_waitcnt lgkmcnt(0)
    s_add_u32 s54, s54, s55
    s_add_u32 s54, s54, s56
    s_add_u32 s54, s54, s57
    s_add_u32 s54, s54, s58
    s_add_u32 s54, s54, s59
    s_add_u32 s54, s54, s60
    s_add_u32 s54, s54, s61
    s_cmp_lg_u32 s54, 256
    s_cbranch_scc1 K_g3
K_g5:
    s_waitcnt lgkmcnt(0)
K_g4:
    s_barrier
K_rel:
    s_add_u32 m0, s28, 0
    s_nop 0
    buffer_load_dwordx4 v3, s[16:19], s29 offen offset:0 sc1 lds
    buffer_load_dwordx4 v3, s[16:19], s29 offen offset:1024 sc1 lds
    buffer_load_dwordx4 v3, s[16:19], s29 offen offset:2048 sc1 lds
    buffer_load_dwordx4 v3, s[16:19], s29 offen offset:3072 sc1 lds
    s_mov_b32 m0, s33
    s_nop 0
    buffer_load_dwordx4 v3, s[16:19], s30 offen sc1 lds
    s_cmp_lg_u32 s34, 0
    s_cbranch_scc1 K_x0
K_c0:
    s_add_u32 m0, s28, 4096
    s_add_u32 s29, s29, 4096
    buffer_load_dwordx4 v3, s[16:19], s29 offen offset:0 sc1 lds
    buffer_load_dwordx4 v3, s[16:19], s29 offen offset:1024 sc1 lds
    buffer_load_dwordx4 v3, s[16:19], s29 offen offset:2048 sc1 lds
    buffer_load_dwordx4 v3, s[16:19], s29 offen offset:3072 sc1 lds
    s_lshl_b32 s33, s3, 11
    s_add_u32 m0, s33, 137984
    s_add_u32 s33, s33, 2634752
    buffer_load_dwordx4 v3, s[16:19], s33 offen sc1 lds
    buffer_load_dwordx4 v3, s[16:19], s33 offen offset:1024 sc1 lds
    s_add_u32 m0, s28, 8192
    s_add_u32 s29, s29, 4096
    buffer_load_dwordx4 v3, s[16:19], s29 offen offset:0 sc1 lds
    buffer_load_dwordx4 v3, s[16:19], s29 offen offset:1024 sc1 lds
    buffer_load_dwordx4 v3, s[16:19], s29 offen offset:2048 sc1 lds
    buffer_load_dwordx4 v3, s[16:19], s29 offen offset:3072 sc1 lds
    s_cmp_lg_u32 s34, 0
    s_cselect_b64 vcc, -1, 0
    s_waitcnt vmcnt(11)
    ds_read_b64_tr_b16 v[96:97], v9 offset:0
    ds_read_b64_tr_b16 v[98:99], v9 offset:1024
    ds_read_b64_tr_b16 v[104:105], v11 offset:0
    ds_read_b64_tr_b16 v[106:107], v11 offset:1024
    ds_read_b64_tr_b16 v[100:101], v9 offset:2048
    ds_read_b64_tr_b16 v[102:103], v9 offset:3072
    ds_read_b64_tr_b16 v[108:109], v11 offset:2048
    ds_read_b64_tr_b16 v[110:111], v11 offset:3072
    s_add_u32 m0, s28, 12288
    s_add_u32 s29, s29, 4096
    buffer_load_dwordx4 v3, s[16:19], s29 offen offset:0 sc1 lds
    buffer_load_dwordx4 v3, s[16:19], s29 offen offset:1024 sc1 lds
    buffer_load_dwordx4 v3, s[16:19], s29 offen offset:2048 sc1 lds
    buffer_load_dwordx4 v3, s[16:19], s29 offen offset:3072 sc1 lds
    s_waitcnt vmcnt(14)
    ds_read_b128 v[16:19], v6 offset:0
    ds_read_b128 v[20:23], v6 offset:128
    ds_read_b128 v[24:27], v6 offset:256
    ds_read_b128 v[28:31], v6 offset:384
    ds_read_b128 v[32:35], v6 offset:512
    s_add_u32 m0, s28, 16384
    s_add_u32 s29, s29, 4096
    buffer_load_dwordx4 v3, s[16:19], s29 offen offset:0 sc1 lds
    buffer_load_dwordx4 v3, s[16:19], s29 offen offset:1024 sc1 lds
    buffer_load_dwordx4 v3, s[16:19], s29 offen offset:2048 sc1 lds
    buffer_load_dwordx4 v3, s[16:19], s29 offen offset:3072 sc1 lds
    s_waitcnt vmcnt(14)
    ds_read_b64_tr_b16 v[112:113], v9 offset:4096
    ds_read_b64_tr_b16 v[114:115], v9 offset:5120
    ds_read_b64_tr_b16 v[120:121], v11 offset:4096
    ds_read_b64_tr_b16 v[122:123], v11 offset:5120
    ds_read_b64_tr_b16 v[116:117], v9 offset:6144
    ds_read_b64_tr_b16 v[118:119], v9 offset:7168
    ds_read_b64_tr_b16 v[124:125], v11 offset:6144
    ds_read_b64_tr_b16 v[126:127], v11 offset:7168
    s_waitcnt lgkmcnt(8)
    v_mfma_f32_16x16x32_bf16 v[56:59], v[96:99], v[128:131], 0
    v_mfma_f32_16x16x32_bf16 v[56:59], v[104:107], v[76:79], v[56:59]
    v_mfma_f32_16x16x32_bf16 v[56:59], v[100:103], v[132:135], v[56:59]
    v_mfma_f32_16x16x32_bf16 v[56:59], v[108:111], v[80:83], v[56:59]
    buffer_load_dwordx2 v[204:205], v242, s[8:11], 0 offen offset:0
    buffer_load_dwordx2 v[206:207], v242, s[8:11], 0 offen offset:256
    buffer_load_dwordx2 v[208:209], v242, s[8:11], 0 offen offset:512
    buffer_load_dwordx2 v[210:211], v242, s[8:11], 0 offen offset:768
    buffer_load_dwordx2 v[212:213], v242, s[8:11], 0 offen offset:1024
    s_waitcnt vmcnt(13)
    ds_read_b64_tr_b16 v[96:97], v9 offset:8192
    ds_read_b64_tr_b16 v[98:99], v9 offset:9216
    ds_read_b64_tr_b16 v[104:105], v11 offset:8192
    ds_read_b64_tr_b16 v[106:107], v11 offset:9216
    ds_read_b64_tr_b16 v[100:101], v9 offset:10240
    ds_read_b64_tr_b16 v[102:103], v9 offset:11264
    ds_read_b64_tr_b16 v[108:109], v11 offset:10240
    ds_read_b64_tr_b16 v[110:111], v11 offset:11264
    s_waitcnt lgkmcnt(8)
    v_mfma_f32_16x16x32_bf16 v[60:63], v[112:115], v[128:131], 0
    v_mfma_f32_16x16x32_bf16 v[60:63], v[120:123], v[76:79], v[60:63]
    v_mul_f32 v56, v56, v16
    v_mul_f32 v57, v57, v17
    v_mfma_f32_16x16x32_bf16 v[60:63], v[116:119], v[132:135], v[60:63]
    v_mul_f32 v58, v58, v18
    v_mul_f32 v59, v59, v19
    v_mfma_f32_16x16x32_bf16 v[60:63], v[124:127], v[80:83], v[60:63]
    s_cbranch_vccnz K_x10
K_c10:
    v_cvt_pk_bf16_f32 v56, v56, v57
    v_cvt_pk_bf16_f32 v57, v58, v59
    ds_write_b64 v12, v[56:57] offset:0
    s_waitcnt vmcnt(9)
    ds_read_b64_tr_b16 v[112:113], v9 offset:12288
    ds_read_b64_tr_b16 v[114:115], v9 offset:13312
    ds_read_b64_tr_b16 v[120:121], v11 offset:12288
    ds_read_b64_tr_b16 v[122:123], v11 offset:13312
    ds_read_b64_tr_b16 v[116:117], v9 offset:14336
    ds_read_b64_tr_b16 v[118:119], v9 offset:15360
    ds_read_b64_tr_b16 v[124:125], v11 offset:14336
    ds_read_b64_tr_b16 v[126:127], v11 offset:15360
    s_waitcnt lgkmcnt(8)
    v_mfma_f32_16x16x32_bf16 v[64:67], v[96:99], v[128:131], 0
    v_mfma_f32_16x16x32_bf16 v[64:67], v[104:107], v[76:79], v[64:67]
    v_mul_f32 v60, v60, v20
    v_mul_f32 v61, v61, v21
    v_mfma_f32_16x16x32_bf16 v[64:67], v[100:103], v[132:135], v[64:67]
    v_mul_f32 v62, v62, v22
    v_mul_f32 v63, v63, v23
    v_mfma_f32_16x16x32_bf16 v[64:67], v[108:111], v[80:83], v[64:67]
    s_cbranch_vccnz K_x11
K_c11:
    v_cvt_pk_bf16_f32 v60, v60, v61
    v_cvt_pk_bf16_f32 v61, v62, v63
    ds_write_b64 v12, v[60:61] offset:64
    s_waitcnt lgkmcnt(0)
    v_mfma_f32_16x16x32_bf16 v[68:71], v[112:115], v[128:131], 0
    v_mfma_f32_16x16x32_bf16 v[68:71], v[120:123], v[76:79], v[68:71]
    s_nop 0
    v_mul_f32 v64, v64, v24
    v_mul_f32 v65, v65, v25
    v_mfma_f32_16x16x32_bf16 v[68:71], v[116:119], v[132:135], v[68:71]
    v_mul_f32 v66, v66, v26
    v_mul_f32 v67, v67, v27
    v_mfma_f32_16x16x32_bf16 v[68:71], v[124:127], v[80:83], v[68:71]
    s_cbranch_vccnz K_x12
K_c12:
    v_cvt_pk_bf16_f32 v64, v64, v65
    v_cvt_pk_bf16_f32 v65, v66, v67
    ds_write_b64 v12, v[64:65] offset:128
    s_nop 3
    v_pk_mul_f32 v[68:69], v[68:69], v[28:29]
    v_pk_mul_f32 v[70:71], v[70:71], v[30:31]
    s_cbranch_vccnz K_x13
K_c13:
    v_cvt_pk_bf16_f32 v68, v68, v69
    v_cvt_pk_bf16_f32 v69, v70, v71
    ds_write_b64 v12, v[68:69] offset:192
    s_waitcnt vmcnt(5)
    ds_read_b64_tr_b16 v[96:97], v9 offset:16384
    ds_read_b64_tr_b16 v[98:99], v9 offset:17408
    ds_read_b64_tr_b16 v[104:105], v11 offset:16384
    ds_read_b64_tr_b16 v[106:107], v11 offset:17408
    ds_read_b64_tr_b16 v[100:101], v9 offset:18432
    ds_read_b64_tr_b16 v[102:103], v9 offset:19456
    ds_read_b64_tr_b16 v[108:109], v11 offset:18432
    ds_read_b64_tr_b16 v[110:111], v11 offset:19456
    s_waitcnt lgkmcnt(6)
    v_mfma_f32_16x16x32_bf16 v[72:75], v[96:99], v[128:131], 0
    s_waitcnt lgkmcnt(4)
    v_mfma_f32_16x16x32_bf16 v[72:75], v[104:107], v[76:79], v[72:75]
    s_waitcnt lgkmcnt(2)
    v_mfma_f32_16x16x32_bf16 v[72:75], v[100:103], v[132:135], v[72:75]
    s_waitcnt lgkmcnt(0)
    v_mfma_f32_16x16x32_bf16 v[72:75], v[108:111], v[80:83], v[72:75]
    s_nop 7
    v_pk_mul_f32 v[72:73], v[72:73], v[32:33]
    v_pk_mul_f32 v[74:75], v[74:75], v[34:35]
    s_cbranch_vccnz K_x14
K_c14:
    v_cvt_pk_bf16_f32 v72, v72, v73
    v_cvt_pk_bf16_f32 v73, v74, v75
    ds_write_b64 v12, v[72:73] offset:256
    s_waitcnt lgkmcnt(0)
    s_barrier
    s_cmp_eq_u32 s3, 0
    s_cselect_b32 s40, s34, 0
    s_cmp_eq_u32 s40, 1
    s_cbranch_scc1 K_c2
    ds_read_b64_tr_b16 v[56:57], v234 offset:0
    ds_read_b64_tr_b16 v[58:59], v234 offset:1288
    ds_read_b64_tr_b16 v[60:61], v234 offset:32
    ds_read_b64_tr_b16 v[62:63], v234 offset:1320
    ds_read_b64_tr_b16 v[64:65], v234 offset:64
    ds_read_b64_tr_b16 v[66:67], v234 offset:1352
    ds_read_b128 v[16:19], v14 offset:0
    ds_read_b128 v[20:23], v14 offset:512
    ds_read_b128 v[24:27], v14 offset:1024
    ds_read_b128 v[28:31], v14 offset:1536
    ds_read_b128 v[32:35], v14 offset:2048
    s_mul_i32 s53, s50, 196608
    s_add_u32 s53, s53, s44
    s_add_u32 s50, s50, 1
    s_cmp_eq_u32 s50, 10
    s_cselect_b32 s50, 0, s50
    s_add_u32 m0, s52, 0
    s_nop 0
    buffer_load_dwordx4 v248, s[4:7], s53 offen lds
    s_add_u32 m0, s52, 1024
    s_nop 0
    buffer_load_dwordx4 v249, s[4:7], s53 offen lds
    s_waitcnt lgkmcnt(9)
    v_mfma_f32_16x16x32_bf16 v[68:71], v[56:59], v[136:139], 0
    v_mfma_f32_16x16x32_bf16 v[72:75], v[56:59], v[140:143], 0
    s_waitcnt lgkmcnt(7)
    v_mfma_f32_16x16x32_bf16 v[76:79], v[60:63], v[136:139], 0
    v_mfma_f32_16x16x32_bf16 v[80:83], v[60:63], v[140:143], 0
    s_waitcnt lgkmcnt(5)
    v_mfma_f32_16x16x32_bf16 v[84:87], v[64:67], v[136:139], 0
    v_mfma_f32_16x16x32_bf16 v[88:91], v[64:67], v[140:143], 0
    ds_read_b128 v[214:217], v14 offset:2560
    ds_read_b128 v[218:221], v14 offset:3072
    ds_read_b128 v[222:225], v14 offset:3584
    ds_read_b128 v[226:229], v14 offset:4096
    ds_read_b128 v[230:233], v14 offset:4608
    ds_read_b128 v[36:39], v14 offset:5120
    ds_read_b128 v[40:43], v14 offset:5632
    ds_read_b128 v[44:47], v14 offset:6144
    ds_read_b128 v[48:51], v14 offset:6656
    ds_read_b128 v[52:55], v14 offset:7168
    s_add_u32 m0, s52, 2048
    s_nop 0
    buffer_load_dwordx4 v250, s[4:7], s53 offen lds
    s_add_u32 m0, s52, 3072
    s_add_u32 s53, s53, 49152
    buffer_load_dwordx4 v248, s[4:7], s53 offen lds
    v_pk_mul_f32 v[120:121], v[68:69], v[144:145]
    v_pk_mul_f32 v[124:125], v[72:73], v[144:145]
    v_pk_mul_f32 v[122:123], v[70:71], v[146:147]
    v_pk_mul_f32 v[126:127], v[74:75], v[146:147]
    v_pk_fma_f32 v[120:121], v[72:73], v[148:149], v[120:121]
    v_pk_fma_f32 v[124:125], v[68:69], v[148:149], v[124:125] neg_lo:[1,0,0] neg_hi:[1,0,0]
    v_pk_fma_f32 v[122:123], v[74:75], v[150:151], v[122:123]
    v_pk_fma_f32 v[126:127], v[70:71], v[150:151], v[126:127] neg_lo:[1,0,0] neg_hi:[1,0,0]
    v_cvt_pk_bf16_f32 v56, v120, v124
    v_cvt_pk_bf16_f32 v57, v121, v125
    v_cvt_pk_bf16_f32 v58, v122, v126
    v_cvt_pk_bf16_f32 v59, v123, v127
    s_add_u32 m0, s52, 4096
    s_nop 0
    buffer_load_dwordx4 v249, s[4:7], s53 offen lds
    s_add_u32 m0, s52, 5120
    s_nop 0
    buffer_load_dwordx4 v250, s[4:7], s53 offen lds
    v_pk_mul_f32 v[120:121], v[76:77], v[152:153]
    v_pk_mul_f32 v[124:125], v[80:81], v[152:153]
    v_pk_mul_f32 v[122:123], v[78:79], v[154:155]
    v_pk_mul_f32 v[126:127], v[82:83], v[154:155]
    v_pk_fma_f32 v[120:121], v[80:81], v[156:157], v[120:121]
    v_pk_fma_f32 v[124:125], v[76:77], v[156:157], v[124:125] neg_lo:[1,0,0] neg_hi:[1,0,0]
    v_pk_fma_f32 v[122:123], v[82:83], v[158:159], v[122:123]
    v_pk_fma_f32 v[126:127], v[78:79], v[158:159], v[126:127] neg_lo:[1,0,0] neg_hi:[1,0,0]
    v_cvt_pk_bf16_f32 v60, v120, v124
    v_cvt_pk_bf16_f32 v61, v121, v125
    v_cvt_pk_bf16_f32 v62, v122, v126
    v_cvt_pk_bf16_f32 v63, v123, v127
    v_pk_mul_f32 v[120:121], v[84:85], v[160:161]
    v_pk_mul_f32 v[124:125], v[88:89], v[160:161]
    v_pk_mul_f32 v[122:123], v[86:87], v[162:163]
    v_pk_mul_f32 v[126:127], v[90:91], v[162:163]
    v_pk_fma_f32 v[120:121], v[88:89], v[164:165], v[120:121]
    v_pk_fma_f32 v[124:125], v[84:85], v[164:165], v[124:125] neg_lo:[1,0,0] neg_hi:[1,0,0]
    v_pk_fma_f32 v[122:123], v[90:91], v[166:167], v[122:123]
    v_pk_fma_f32 v[126:127], v[86:87], v[166:167], v[126:127] neg_lo:[1,0,0] neg_hi:[1,0,0]
    v_cvt_pk_bf16_f32 v64, v120, v124
    v_cvt_pk_bf16_f32 v65, v121, v125
    v_cvt_pk_bf16_f32 v66, v122, v126
    v_cvt_pk_bf16_f32 v67, v123, v127
    s_mov_b32 exec_lo, 0
    v_mov_b32 v64, 0
    v_mov_b32 v65, 0
    v_mov_b32 v66, 0
    v_mov_b32 v67, 0
    s_mov_b64 exec, -1
    v_mfma_f32_16x16x32_bf16 v[68:71], v[168:171], v[56:59], 0
    v_mfma_f32_16x16x32_bf16 v[72:75], v[180:183], v[56:59], 0
    v_mfma_f32_16x16x32_bf16 v[76:79], v[192:195], v[56:59], 0
    v_mfma_f32_16x16x32_bf16 v[68:71], v[172:175], v[60:63], v[68:71]
    v_mfma_f32_16x16x32_bf16 v[72:75], v[184:187], v[60:63], v[72:75]
    v_mfma_f32_16x16x32_bf16 v[76:79], v[196:199], v[60:63], v[76:79]
    v_mfma_f32_16x16x32_bf16 v[68:71], v[176:179], v[64:67], v[68:71]
    v_mfma_f32_16x16x32_bf16 v[72:75], v[188:191], v[64:67], v[72:75]
    v_mfma_f32_16x16x32_bf16 v[76:79], v[200:203], v[64:67], v[76:79]
    buffer_load_dwordx4 a[0:3], v3, s[16:19], s86 offen offset:0 sc1
    buffer_load_dwordx4 a[4:7], v3, s[16:19], s86 offen offset:1024 sc1
    s_nop 3
    ds_write_b32 v237, v68 offset:0
    ds_write_b32 v239, v68 offset:2240
    ds_write_b32 v237, v69 offset:64
    ds_write_b32 v238, v69 offset:2176
    ds_write_b32 v237, v70 offset:128
    ds_write_b32 v238, v70 offset:2112
    ds_write_b32 v237, v71 offset:192
    ds_write_b32 v238, v71 offset:2048
    ds_write_b32 v237, v72 offset:1024
    ds_write_b32 v238, v72 offset:1216
    ds_write_b32 v237, v73 offset:1088
    ds_write_b32 v238, v73 offset:1152
    ds_write_b32 v237, v74 offset:1152
    ds_write_b32 v238, v74 offset:1088
    ds_write_b32 v237, v75 offset:1216
    ds_write_b32 v238, v75 offset:1024
    s_mov_b32 exec_hi, 0
    ds_write_b32 v237, v76 offset:2048
    ds_write_b32 v238, v76 offset:192
    ds_write_b32 v237, v77 offset:2112
    ds_write_b32 v238, v77 offset:128
    ds_write_b32 v237, v78 offset:2176
    ds_write_b32 v238, v78 offset:64
    ds_write_b32 v237, v79 offset:2240
    ds_write_b32 v238, v79 offset:0
    s_mov_b64 exec, -1
K_c3:
    ds_read_b128 v[56:59], v241 offset:0
    ds_read_b128 v[60:63], v241 offset:512
    ds_read_b128 v[64:67], v241 offset:1024
    ds_read_b128 v[68:71], v241 offset:1536
    ds_read_b128 v[72:75], v241 offset:2048
    s_waitcnt vmcnt(8)
    v_lshlrev_b32 v96, 16, v204
    v_and_b32 v97, 0xffff0000, v204
    v_lshlrev_b32 v98, 16, v205
    v_and_b32 v99, 0xffff0000, v205
    v_lshlrev_b32 v100, 16, v206
    v_and_b32 v101, 0xffff0000, v206
    v_lshlrev_b32 v102, 16, v207
    v_and_b32 v103, 0xffff0000, v207
    v_lshlrev_b32 v104, 16, v208
    v_and_b32 v105, 0xffff0000, v208
    v_lshlrev_b32 v106, 16, v209
    v_and_b32 v107, 0xffff0000, v209
    v_lshlrev_b32 v108, 16, v210
    v_and_b32 v109, 0xffff0000, v210
    v_lshlrev_b32 v110, 16, v211
    v_and_b32 v111, 0xffff0000, v211
    v_lshlrev_b32 v112, 16, v212
    v_and_b32 v113, 0xffff0000, v212
    v_lshlrev_b32 v114, 16, v213
    v_and_b32 v115, 0xffff0000, v213
    buffer_load_dwordx4 a[8:11], v3, s[16:19], s86 offen offset:2048 sc1
    buffer_load_dwordx4 a[12:15], v3, s[16:19], s86 offen offset:3072 sc1
    buffer_load_dwordx4 a[16:19], v3, s[16:19], s87 offen offset:0 sc1
    buffer_load_dwordx4 a[20:23], v3, s[16:19], s87 offen offset:1024 sc1
    s_waitcnt lgkmcnt(4)
    v_pk_fma_f32 v[96:97], v[16:17], v[56:57], v[96:97]
    v_pk_fma_f32 v[98:99], v[18:19], v[58:59], v[98:99]
    v_pk_mul_f32 v[130:131], v[96:97], v[96:97]
    v_pk_add_f32 v[12:13], v[96:97], v[98:99]
    v_pk_fma_f32 v[130:131], v[98:99], v[98:99], v[130:131]
    s_waitcnt lgkmcnt(3)
    v_pk_fma_f32 v[100:101], v[20:21], v[60:61], v[100:101]
    v_pk_fma_f32 v[102:103], v[22:23], v[62:63], v[102:103]
    v_pk_add_f32 v[12:13], v[12:13], v[100:101]
    v_pk_fma_f32 v[130:131], v[100:101], v[100:101], v[130:131]
    v_pk_add_f32 v[12:13], v[12:13], v[102:103]
    v_pk_fma_f32 v[130:131], v[102:103], v[102:103], v[130:131]
    s_waitcnt lgkmcnt(2)
    v_pk_fma_f32 v[104:105], v[24:25], v[64:65], v[104:105]
    v_pk_fma_f32 v[106:107], v[26:27], v[66:67], v[106:107]
    v_pk_add_f32 v[12:13], v[12:13], v[104:105]
    v_pk_fma_f32 v[130:131], v[104:105], v[104:105], v[130:131]
    v_pk_add_f32 v[12:13], v[12:13], v[106:107]
    v_pk_fma_f32 v[130:131], v[106:107], v[106:107], v[130:131]
    s_waitcnt lgkmcnt(1)
    v_pk_fma_f32 v[108:109], v[28:29], v[68:69], v[108:109]
    v_pk_fma_f32 v[110:111], v[30:31], v[70:71], v[110:111]
    v_pk_add_f32 v[12:13], v[12:13], v[108:109]
    v_pk_fma_f32 v[130:131], v[108:109], v[108:109], v[130:131]
    v_pk_add_f32 v[12:13], v[12:13], v[110:111]
    v_pk_fma_f32 v[130:131], v[110:111], v[110:111], v[130:131]
    s_waitcnt lgkmcnt(0)
    v_pk_fma_f32 v[112:113], v[32:33], v[72:73], v[112:113]
    v_pk_fma_f32 v[114:115], v[34:35], v[74:75], v[114:115]
    v_pk_add_f32 v[12:13], v[12:13], v[112:113]
    v_pk_fma_f32 v[130:131], v[112:113], v[112:113], v[130:131]
    v_pk_add_f32 v[12:13], v[12:13], v[114:115]
    v_pk_fma_f32 v[130:131], v[114:115], v[114:115], v[130:131]
    v_add_f32 v12, v12, v13
    v_add_f32 v130, v130, v131
    v_cvt_pk_bf16_f32 v204, v96, v97
    v_cvt_pk_bf16_f32 v205, v98, v99
    v_add_f32_dpp v12, v12, v12 row_ror:8 row_mask:0xf bank_mask:0xf
    v_add_f32_dpp v130, v130, v130 row_ror:8 row_mask:0xf bank_mask:0xf
    v_cvt_pk_bf16_f32 v206, v100, v101
    v_cvt_pk_bf16_f32 v207, v102, v103
    v_add_f32_dpp v12, v12, v12 row_ror:4 row_mask:0xf bank_mask:0xf
    v_add_f32_dpp v130, v130, v130 row_ror:4 row_mask:0xf bank_mask:0xf
    v_cvt_pk_bf16_f32 v208, v104, v105
    v_cvt_pk_bf16_f32 v209, v106, v107
    v_add_f32_dpp v12, v12, v12 row_ror:2 row_mask:0xf bank_mask:0xf
    v_add_f32_dpp v130, v130, v130 row_ror:2 row_mask:0xf bank_mask:0xf
    v_cvt_pk_bf16_f32 v210, v108, v109
    v_cvt_pk_bf16_f32 v211, v110, v111
    v_add_f32_dpp v12, v12, v12 row_ror:1 row_mask:0xf bank_mask:0xf
    v_add_f32_dpp v130, v130, v130 row_ror:1 row_mask:0xf bank_mask:0xf
    v_mov_b32 v13, v12
    v_mov_b32 v131, v130
    v_cvt_pk_bf16_f32 v212, v112, v113
    v_cvt_pk_bf16_f32 v213, v114, v115
    v_permlane16_swap_b32 v12, v13
    v_permlane16_swap_b32 v130, v131
    v_add_f32 v12, v12, v13
    v_add_f32 v130, v130, v131
    v_mul_f32 v12, 0x3acccccd, v12
    v_mul_f32 v130, 0x3acccccd, v130
    v_fma_f32 v130, -v12, v12, v130
    v_max_f32 v130, 0, v130
    v_add_f32 v130, 0x3727c5ac, v130
    v_rsq_f32 v130, v130
    v_pk_add_f32 v[96:97], v[96:97], v[12:13] op_sel_hi:[1,0] neg_lo:[0,1] neg_hi:[0,1]
    v_pk_add_f32 v[98:99], v[98:99], v[12:13] op_sel_hi:[1,0] neg_lo:[0,1] neg_hi:[0,1]
    v_pk_add_f32 v[100:101], v[100:101], v[12:13] op_sel_hi:[1,0] neg_lo:[0,1] neg_hi:[0,1]
    v_pk_add_f32 v[102:103], v[102:103], v[12:13] op_sel_hi:[1,0] neg_lo:[0,1] neg_hi:[0,1]
    v_pk_add_f32 v[104:105], v[104:105], v[12:13] op_sel_hi:[1,0] neg_lo:[0,1] neg_hi:[0,1]
    v_pk_add_f32 v[106:107], v[106:107], v[12:13] op_sel_hi:[1,0] neg_lo:[0,1] neg_hi:[0,1]
    v_pk_add_f32 v[108:109], v[108:109], v[12:13] op_sel_hi:[1,0] neg_lo:[0,1] neg_hi:[0,1]
    v_pk_add_f32 v[110:111], v[110:111], v[12:13] op_sel_hi:[1,0] neg_lo:[0,1] neg_hi:[0,1]
    v_pk_add_f32 v[112:113], v[112:113], v[12:13] op_sel_hi:[1,0] neg_lo:[0,1] neg_hi:[0,1]
    v_pk_add_f32 v[114:115], v[114:115], v[12:13] op_sel_hi:[1,0] neg_lo:[0,1] neg_hi:[0,1]
    v_pk_mul_f32 v[36:37], v[36:37], v[130:131] op_sel_hi:[1,0]
    v_pk_mul_f32 v[38:39], v[38:39], v[130:131] op_sel_hi:[1,0]
    v_pk_fma_f32 v[96:97], v[96:97], v[36:37], v[214:215]
    v_pk_fma_f32 v[98:99], v[98:99], v[38:39], v[216:217]
    v_cvt_pk_bf16_f32 v56, v96, v97
    v_cvt_pk_bf16_f32 v57, v98, v99
    buffer_store_dwordx2 v[56:57], v10, s[16:19], s38 offen offset:0 sc1
    v_pk_mul_f32 v[40:41], v[40:41], v[130:131] op_sel_hi:[1,0]
    v_pk_mul_f32 v[42:43], v[42:43], v[130:131] op_sel_hi:[1,0]
    v_pk_fma_f32 v[100:101], v[100:101], v[40:41], v[218:219]
    v_pk_fma_f32 v[102:103], v[102:103], v[42:43], v[220:221]
    v_cvt_pk_bf16_f32 v58, v100, v101
    v_cvt_pk_bf16_f32 v59, v102, v103
    buffer_store_dwordx2 v[58:59], v10, s[16:19], s38 offen offset:256 sc1
    v_pk_mul_f32 v[44:45], v[44:45], v[130:131] op_sel_hi:[1,0]
    v_pk_mul_f32 v[46:47], v[46:47], v[130:131] op_sel_hi:[1,0]
    v_pk_fma_f32 v[104:105], v[104:105], v[44:45], v[222:223]
    v_pk_fma_f32 v[106:107], v[106:107], v[46:47], v[224:225]
    v_cvt_pk_bf16_f32 v60, v104, v105
    v_cvt_pk_bf16_f32 v61, v106, v107
    buffer_store_dwordx2 v[60:61], v10, s[16:19], s38 offen offset:512 sc1
    v_pk_mul_f32 v[48:49], v[48:49], v[130:131] op_sel_hi:[1,0]
    v_pk_mul_f32 v[50:51], v[50:51], v[130:131] op_sel_hi:[1,0]
    v_pk_fma_f32 v[108:109], v[108:109], v[48:49], v[226:227]
    v_pk_fma_f32 v[110:111], v[110:111], v[50:51], v[228:229]
    v_cvt_pk_bf16_f32 v62, v108, v109
    v_cvt_pk_bf16_f32 v63, v110, v111
    buffer_store_dwordx2 v[62:63], v10, s[16:19], s38 offen offset:768 sc1
    v_pk_mul_f32 v[52:53], v[52:53], v[130:131] op_sel_hi:[1,0]
    v_pk_mul_f32 v[54:55], v[54:55], v[130:131] op_sel_hi:[1,0]
    v_pk_fma_f32 v[112:113], v[112:113], v[52:53], v[230:231]
    v_pk_fma_f32 v[114:115], v[114:115], v[54:55], v[232:233]
    v_cvt_pk_bf16_f32 v64, v112, v113
    v_cvt_pk_bf16_f32 v65, v114, v115
    buffer_store_dwordx2 v[64:65], v10, s[16:19], s38 offen offset:1024 sc1
    buffer_store_dwordx2 v[204:205], v10, s[16:19], s39 offen offset:0 sc1
    buffer_store_dwordx2 v[206:207], v10, s[16:19], s39 offen offset:256 sc1
    buffer_store_dwordx2 v[208:209], v10, s[16:19], s39 offen offset:512 sc1
    buffer_store_dwordx2 v[210:211], v10, s[16:19], s39 offen offset:768 sc1
    buffer_store_dwordx2 v[212:213], v10, s[16:19], s39 offen offset:1024 sc1
    s_lshl_b32 s40, s24, 12
    s_add_u32 s40, s40, 3276800
    v_mov_b32 v60, 1
    v_lshlrev_b32 v61, 8, v2
    s_lshl_b32 s41, s25, 8
    s_add_u32 s41, s41, s40
    s_add_u32 s0, s16, s41
    s_addc_u32 s1, s17, 0
    s_mov_b32 s42, s40
    v_mov_b32 v56, v248
    v_mov_b32 v57, v249
    v_mov_b32 v58, v250
    v_lshrrev_b32 v6, 3, v2
    v_mul_u32_u24 v6, 1280, v6
    v_and_b32 v7, 7, v2
    v_xor_b32 v7, v7, v5
    v_lshl_add_u32 v6, v7, 4, v6
    v_xor_b32 v7, 64, v6
    s_lshl_b32 s45, s24, 7
    s_lshl_b32 s46, s3, 5
    s_add_u32 s45, s45, s46
    s_mul_i32 s45, s45, 1280
    s_add_u32 s45, s45, 9437184
    s_add_u32 s46, s45, 9216
    s_add_u32 s47, s45, 18432
    s_add_u32 s48, s45, 27648
    s_lshl_b32 s49, s3, 12
    s_lshr_b32 s54, s3, 1
    s_and_b32 s55, s3, 1
    v_and_b32 v12, 31, v2
    v_lshrrev_b32 v13, 5, v2
    v_bfe_u32 v14, v2, 1, 3
    s_lshl_b32 s56, s54, 13
    v_lshlrev_b32 v12, 7, v12
    v_add_u32 v12, s56, v12
    v_add_u32 v15, 0, v13
    v_xor_b32 v15, v15, v14
    v_lshl_add_u32 v8, v15, 4, v12
    v_add_u32 v15, 2, v13
    v_xor_b32 v15, v15, v14
    v_lshl_add_u32 v9, v15, 4, v12
    v_add_u32 v15, 4, v13
    v_xor_b32 v15, v15, v14
    v_lshl_add_u32 v10, v15, 4, v12
    v_add_u32 v15, 6, v13
    v_xor_b32 v15, v15, v14
    v_lshl_add_u32 v11, v15, 4, v12
    v_lshlrev_b32 v12, 7, v4
    v_add_u32 v12, s56, v12
    v_lshrrev_b32 v13, 1, v4
    v_xor_b32 v13, v13, v5
    v_lshl_add_u32 v8, v13, 4, v12
    v_xor_b32 v9, 64, v8
    v_bfe_u32 v13, v2, 2, 2
    v_lshl_add_u32 v13, v5, 3, v13
    v_mul_u32_u24 v13, 192, v13
    v_and_b32 v15, 3, v2
    v_lshl_add_u32 v13, v15, 3, v13
    s_mul_i32 s56, s55, 96
    s_add_u32 s56, s56, 65536
    v_add_u32 v13, s56, v13
    v_and_b32 v12, 1, v5
    v_lshlrev_b32 v12, 5, v12
    s_lshl_b32 s56, s55, 1
    s_sub_u32 s56, 1, s56
    v_mul_i32_i24 v12, s56, v12
    v_sub_u32 v59, v13, v12
    v_add_u32 v12, v13, v12
    v_add_u32 v13, 49152, v12
    v_add_u32 v62, 49152, v59
    v_bfe_u32 v14, v2, 4, 1
    v_mul_u32_u24 v14, 49152, v14
    v_lshrrev_b32 v15, 5, v2
    v_lshl_add_u32 v14, v15, 8, v14
    v_lshl_add_u32 v14, v4, 4, v14
    s_lshl_b32 s56, s24, 1
    s_add_u32 s56, s56, s54
    s_mul_i32 s56, s56, 196608
    s_mul_i32 s57, s25, 6
    s_mul_i32 s58, s55, 3
    s_add_u32 s57, s57, s58
    s_lshl_b32 s57, s57, 9
    s_add_u32 s56, s56, s57
    s_add_u32 s56, s56, 16777216
    s_add_u32 s57, s56, 98304
    v_add_u32 v144, 8192, v56
    v_add_u32 v145, 7168, v57
    v_add_u32 v146, 6144, v58
    v_add_u32 v147, 54272, v56
    v_add_u32 v148, 57344, v57
    v_add_u32 v149, 56320, v58
    v_add_u32 v150, 0, v6
    v_add_u32 v151, 9216, v7
    v_add_u32 v152, 18432, v6
    v_add_u32 v153, 27648, v7
    s_sub_u32 s4, s4, 8192
    s_subb_u32 s5, s5, 0
    s_add_u32 s6, s6, 8192
    s_mul_i32 s60, s50, 196608
    s_add_u32 s60, s60, s44
    s_add_u32 s50, s50, 1
    s_cmp_eq_u32 s50, 10
    s_cselect_b32 s50, 0, s50
    s_mul_i32 s61, s50, 196608
    s_add_u32 s61, s61, s44
    s_add_u32 s50, s50, 1
    s_cmp_eq_u32 s50, 10
    s_cselect_b32 s50, 0, s50
    s_mul_i32 s28, s50, 196608
    s_add_u32 s28, s28, s44
    s_add_u32 s50, s50, 1
    s_cmp_eq_u32 s50, 10
    s_cselect_b32 s50, 0, s50
    s_mul_i32 s29, s50, 196608
    s_add_u32 s29, s29, s44
    s_add_u32 s50, s50, 1
    s_cmp_eq_u32 s50, 10
    s_cselect_b32 s50, 0, s50
    s_mul_i32 s30, s50, 196608
    s_add_u32 s30, s30, s44
    s_add_u32 s50, s50, 1
    s_cmp_eq_u32 s50, 10
    s_cselect_b32 s50, 0, s50
    s_mul_i32 s31, s50, 196608
    s_add_u32 s31, s31, s44
    s_add_u32 s50, s50, 1
    s_cmp_eq_u32 s50, 10
    s_cselect_b32 s50, 0, s50
    s_mul_i32 s32, s50, 196608
    s_add_u32 s32, s32, s44
    s_add_u32 s50, s50, 1
    s_cmp_eq_u32 s50, 10
    s_cselect_b32 s50, 0, s50
    s_mul_i32 s33, s50, 196608
    s_add_u32 s33, s33, s44
    s_add_u32 s50, s50, 1
    s_cmp_eq_u32 s50, 10
    s_cselect_b32 s50, 0, s50
    s_lshl_b32 s58, s51, 7
    s_add_u32 s48, s58, s45
    s_add_u32 s51, s51, 1
    s_cmp_eq_u32 s51, 10
    s_cselect_b32 s51, 0, s51
    s_lshl_b32 s58, s51, 7
    s_add_u32 s59, s58, s45
    s_add_u32 s51, s51, 1
    s_cmp_eq_u32 s51, 10
    s_cselect_b32 s51, 0, s51
    s_lshl_b32 s58, s51, 7
    s_add_u32 s34, s58, s45
    s_add_u32 s51, s51, 1
    s_cmp_eq_u32 s51, 10
    s_cselect_b32 s51, 0, s51
    s_lshl_b32 s58, s51, 7
    s_add_u32 s35, s58, s45
    s_add_u32 s51, s51, 1
    s_cmp_eq_u32 s51, 10
    s_cselect_b32 s51, 0, s51
    s_lshl_b32 s58, s51, 7
    s_add_u32 s36, s58, s45
    s_add_u32 s51, s51, 1
    s_cmp_eq_u32 s51, 10
    s_cselect_b32 s51, 0, s51
    s_lshl_b32 s58, s51, 7
    s_add_u32 s37, s58, s45
    s_add_u32 s51, s51, 1
    s_cmp_eq_u32 s51, 10
    s_cselect_b32 s51, 0, s51
    s_lshl_b32 s58, s51, 7
    s_add_u32 s38, s58, s45
    s_add_u32 s51, s51, 1
    s_cmp_eq_u32 s51, 10
    s_cselect_b32 s51, 0, s51
    s_lshl_b32 s58, s51, 7
    s_add_u32 s39, s58, s45
    s_add_u32 s51, s51, 1
    s_cmp_eq_u32 s51, 10
    s_cselect_b32 s51, 0, s51
    s_lshl_b32 s58, s51, 7
    s_add_u32 s46, s58, s45
    s_add_u32 s51, s51, 1
    s_cmp_eq_u32 s51, 10
    s_cselect_b32 s51, 0, s51
    s_lshl_b32 s58, s51, 7
    s_add_u32 s47, s58, s45
    s_add_u32 s51, s51, 1
    s_cmp_eq_u32 s51, 10
    s_cselect_b32 s51, 0, s51
    s_waitcnt vmcnt(5)
    s_barrier
    s_cmp_lg_u32 s3, 0
    s_cbranch_scc1 K_sa0
    s_mov_b64 exec, 0xffff
    buffer_atomic_add v60, v61, s[16:19], s42 offen sc1
    s_mov_b64 exec, -1
K_sa0:
    s_add_u32 m0, s52, 49152
    s_nop 0
    buffer_load_dwordx4 v144, s[4:7], s60 offen offset:0 lds
    buffer_load_dwordx4 v145, s[4:7], s60 offen offset:1024 lds
    buffer_load_dwordx4 v146, s[4:7], s60 offen offset:2048 lds
    buffer_load_dwordx4 v147, s[4:7], s60 offen offset:3072 lds
    s_add_u32 m0, s52, 53248
    s_nop 0
    buffer_load_dwordx4 v148, s[4:7], s60 offen offset:0 lds
    buffer_load_dwordx4 v149, s[4:7], s60 offen offset:1024 lds
    s_add_u32 m0, s52, 73728
    s_nop 0
    buffer_load_dwordx4 v144, s[4:7], s61 offen offset:0 lds
    buffer_load_dwordx4 v145, s[4:7], s61 offen offset:1024 lds
    buffer_load_dwordx4 v146, s[4:7], s61 offen offset:2048 lds
    buffer_load_dwordx4 v147, s[4:7], s61 offen offset:3072 lds
    s_add_u32 m0, s52, 77824
    s_nop 0
    buffer_load_dwordx4 v148, s[4:7], s61 offen offset:0 lds
    buffer_load_dwordx4 v149, s[4:7], s61 offen offset:1024 lds
    s_cmp_lg_u32 s3, 0
    s_cbranch_scc1 K_sb0
    s_mov_b32 s41, 0
K_poll0:
    s_load_dword s40, s[0:1], 0 glc
    s_add_u32 s41, s41, 1
    s_cmp_gt_u32 s41, 0x40000
    s_cbranch_scc1 K_to0
    s_waitcnt lgkmcnt(0)
    s_cmp_lg_u32 s40, 16
    s_cbranch_scc1 K_poll0
K_to0:
    s_waitcnt lgkmcnt(0)
K_sb0:
    s_barrier
K_rel0:
    s_add_u32 m0, s49, 16384
    s_nop 0
    buffer_load_dwordx4 v150, s[16:19], s48 offen offset:0 sc1 lds
    buffer_load_dwordx4 v151, s[16:19], s48 offen offset:1024 sc1 lds
    buffer_load_dwordx4 v152, s[16:19], s48 offen offset:2048 sc1 lds
    buffer_load_dwordx4 v153, s[16:19], s48 offen offset:3072 sc1 lds
    s_add_u32 m0, s49, 0
    s_nop 0
    buffer_load_dwordx4 v150, s[16:19], s59 offen offset:0 sc1 lds
    buffer_load_dwordx4 v151, s[16:19], s59 offen offset:1024 sc1 lds
    buffer_load_dwordx4 v152, s[16:19], s59 offen offset:2048 sc1 lds
    buffer_load_dwordx4 v153, s[16:19], s59 offen offset:3072 sc1 lds
    ds_read_b64_tr_b16 v[64:65], v12 offset:24576
    ds_read_b64_tr_b16 v[66:67], v12 offset:25344
    ds_read_b64_tr_b16 v[68:69], v59 offset:24608
    ds_read_b64_tr_b16 v[70:71], v59 offset:25376
    ds_read_b64_tr_b16 v[72:73], v12 offset:24640
    ds_read_b64_tr_b16 v[74:75], v12 offset:25408
    ds_read_b64_tr_b16 v[76:77], v12 offset:36864
    ds_read_b64_tr_b16 v[78:79], v12 offset:37632
    ds_read_b64_tr_b16 v[80:81], v59 offset:36896
    ds_read_b64_tr_b16 v[82:83], v59 offset:37664
    ds_read_b64_tr_b16 v[84:85], v12 offset:36928
    ds_read_b64_tr_b16 v[86:87], v12 offset:37696
    s_waitcnt vmcnt(4)
    s_barrier
    ds_read_b128 v[112:115], v8 offset:16384
    ds_read_b128 v[116:119], v8 offset:18432
    ds_read_b128 v[120:123], v8 offset:20480
    ds_read_b128 v[124:127], v8 offset:22528
    s_waitcnt lgkmcnt(0)
    v_mfma_f32_16x16x32_bf16 v[160:163], v[64:67], v[112:115], 0
    ds_read_b64_tr_b16 v[88:89], v12 offset:30720
    v_mfma_f32_16x16x32_bf16 v[164:167], v[64:67], v[116:119], 0
    ds_read_b64_tr_b16 v[90:91], v12 offset:31488
    s_add_u32 m0, s49, 32768
    v_mfma_f32_16x16x32_bf16 v[168:171], v[64:67], v[120:123], 0
    ds_read_b128 v[128:131], v9 offset:16384
    v_mfma_f32_16x16x32_bf16 v[172:175], v[64:67], v[124:127], 0
    ds_read_b128 v[132:135], v9 offset:18432
    buffer_load_dwordx4 v150, s[16:19], s34 offen offset:0 sc1 lds
    v_mfma_f32_16x16x32_bf16 v[188:191], v[68:71], v[124:127], 0
    ds_read_b128 v[136:139], v9 offset:20480
    v_mfma_f32_16x16x32_bf16 v[184:187], v[68:71], v[120:123], 0
    ds_read_b128 v[140:143], v9 offset:22528
    buffer_load_dwordx4 v151, s[16:19], s34 offen offset:1024 sc1 lds
    v_mfma_f32_16x16x32_bf16 v[180:183], v[68:71], v[116:119], 0
    ds_read_b64_tr_b16 v[92:93], v59 offset:30752
    v_mfma_f32_16x16x32_bf16 v[176:179], v[68:71], v[112:115], 0
    ds_read_b64_tr_b16 v[94:95], v59 offset:31520
    v_mfma_f32_16x16x32_bf16 v[192:195], v[72:75], v[112:115], 0
    ds_read_b64_tr_b16 v[96:97], v12 offset:30784
    buffer_load_dwordx4 v152, s[16:19], s34 offen offset:2048 sc1 lds
    v_mfma_f32_16x16x32_bf16 v[196:199], v[72:75], v[116:119], 0
    ds_read_b64_tr_b16 v[98:99], v12 offset:31552
    v_mfma_f32_16x16x32_bf16 v[200:203], v[72:75], v[120:123], 0
    ds_read_b64_tr_b16 v[100:101], v12 offset:43008
    buffer_load_dwordx4 v153, s[16:19], s34 offen offset:3072 sc1 lds
    v_mfma_f32_16x16x32_bf16 v[204:207], v[72:75], v[124:127], 0
    ds_read_b64_tr_b16 v[102:103], v12 offset:43776
    v_mfma_f32_16x16x32_bf16 v[220:223], v[76:79], v[124:127], 0
    ds_read_b64_tr_b16 v[104:105], v59 offset:43040
    s_add_u32 m0, s49, 49152
    v_mfma_f32_16x16x32_bf16 v[216:219], v[76:79], v[120:123], 0
    ds_read_b64_tr_b16 v[106:107], v59 offset:43808
    v_mfma_f32_16x16x32_bf16 v[212:215], v[76:79], v[116:119], 0
    ds_read_b64_tr_b16 v[108:109], v12 offset:43072
    buffer_load_dwordx4 v150, s[16:19], s35 offen offset:0 sc1 lds
    v_mfma_f32_16x16x32_bf16 v[208:211], v[76:79], v[112:115], 0
    ds_read_b64_tr_b16 v[110:111], v12 offset:43840
    v_mfma_f32_16x16x32_bf16 v[224:227], v[80:83], v[112:115], 0
    v_mfma_f32_16x16x32_bf16 v[228:231], v[80:83], v[116:119], 0
    buffer_load_dwordx4 v151, s[16:19], s35 offen offset:1024 sc1 lds
    v_mfma_f32_16x16x32_bf16 v[232:235], v[80:83], v[120:123], 0
    v_mfma_f32_16x16x32_bf16 v[236:239], v[80:83], v[124:127], 0
    buffer_load_dwordx4 v152, s[16:19], s35 offen offset:2048 sc1 lds
    v_mfma_f32_16x16x32_bf16 v[252:255], v[84:87], v[124:127], 0
    v_mfma_f32_16x16x32_bf16 v[248:251], v[84:87], v[120:123], 0
    buffer_load_dwordx4 v153, s[16:19], s35 offen offset:3072 sc1 lds
    v_mfma_f32_16x16x32_bf16 v[244:247], v[84:87], v[116:119], 0
    v_mfma_f32_16x16x32_bf16 v[240:243], v[84:87], v[112:115], 0
    s_waitcnt vmcnt(8) lgkmcnt(0)
    s_barrier
    v_mfma_f32_16x16x32_bf16 v[160:163], v[88:91], v[128:131], v[160:163]
    ds_read_b64_tr_b16 v[64:65], v12 offset:0
    v_mfma_f32_16x16x32_bf16 v[164:167], v[88:91], v[132:135], v[164:167]
    ds_read_b64_tr_b16 v[66:67], v12 offset:768
    s_add_u32 m0, s52, 24576
    v_mfma_f32_16x16x32_bf16 v[168:171], v[88:91], v[136:139], v[168:171]
    ds_read_b128 v[112:115], v8 offset:0
    v_mfma_f32_16x16x32_bf16 v[172:175], v[88:91], v[140:143], v[172:175]
    ds_read_b128 v[116:119], v8 offset:2048
    v_mfma_f32_16x16x32_bf16 v[188:191], v[92:95], v[140:143], v[188:191]
    ds_read_b128 v[120:123], v8 offset:4096
    buffer_load_dwordx4 v144, s[4:7], s28 offen offset:0 lds
    v_mfma_f32_16x16x32_bf16 v[184:187], v[92:95], v[136:139], v[184:187]
    ds_read_b128 v[124:127], v8 offset:6144
    v_mfma_f32_16x16x32_bf16 v[180:183], v[92:95], v[132:135], v[180:183]
    ds_read_b64_tr_b16 v[68:69], v59 offset:32
    v_mfma_f32_16x16x32_bf16 v[176:179], v[92:95], v[128:131], v[176:179]
    ds_read_b64_tr_b16 v[70:71], v59 offset:800
    v_mfma_f32_16x16x32_bf16 v[192:195], v[96:99], v[128:131], v[192:195]
    ds_read_b64_tr_b16 v[72:73], v12 offset:64
    buffer_load_dwordx4 v145, s[4:7], s28 offen offset:1024 lds
    v_mfma_f32_16x16x32_bf16 v[196:199], v[96:99], v[132:135], v[196:199]
    ds_read_b64_tr_b16 v[74:75], v12 offset:832
    v_mfma_f32_16x16x32_bf16 v[200:203], v[96:99], v[136:139], v[200:203]
    ds_read_b64_tr_b16 v[76:77], v12 offset:12288
    v_mfma_f32_16x16x32_bf16 v[204:207], v[96:99], v[140:143], v[204:207]
    ds_read_b64_tr_b16 v[78:79], v12 offset:13056
    buffer_load_dwordx4 v146, s[4:7], s28 offen offset:2048 lds
    v_mfma_f32_16x16x32_bf16 v[220:223], v[100:103], v[140:143], v[220:223]
    ds_read_b64_tr_b16 v[80:81], v59 offset:12320
    v_mfma_f32_16x16x32_bf16 v[216:219], v[100:103], v[136:139], v[216:219]
    ds_read_b64_tr_b16 v[82:83], v59 offset:13088
    v_mfma_f32_16x16x32_bf16 v[212:215], v[100:103], v[132:135], v[212:215]
    ds_read_b64_tr_b16 v[84:85], v12 offset:12352
    buffer_load_dwordx4 v147, s[4:7], s28 offen offset:3072 lds
    v_mfma_f32_16x16x32_bf16 v[208:211], v[100:103], v[128:131], v[208:211]
    ds_read_b64_tr_b16 v[86:87], v12 offset:13120
    v_mfma_f32_16x16x32_bf16 v[224:227], v[104:107], v[128:131], v[224:227]
    v_mfma_f32_16x16x32_bf16 v[228:231], v[104:107], v[132:135], v[228:231]
    v_mfma_f32_16x16x32_bf16 v[232:235], v[104:107], v[136:139], v[232:235]
    s_add_u32 m0, s52, 28672
    v_mfma_f32_16x16x32_bf16 v[236:239], v[104:107], v[140:143], v[236:239]
    v_mfma_f32_16x16x32_bf16 v[252:255], v[108:111], v[140:143], v[252:255]
    v_mfma_f32_16x16x32_bf16 v[248:251], v[108:111], v[136:139], v[248:251]
    buffer_load_dwordx4 v148, s[4:7], s28 offen offset:0 lds
    v_mfma_f32_16x16x32_bf16 v[244:247], v[108:111], v[132:135], v[244:247]
    v_mfma_f32_16x16x32_bf16 v[240:243], v[108:111], v[128:131], v[240:243]
    s_waitcnt lgkmcnt(0)
    v_mfma_f32_16x16x32_bf16 v[160:163], v[64:67], v[112:115], v[160:163]
    ds_read_b64_tr_b16 v[88:89], v12 offset:6144
    v_mfma_f32_16x16x32_bf16 v[164:167], v[64:67], v[116:119], v[164:167]
    ds_read_b64_tr_b16 v[90:91], v12 offset:6912
    buffer_load_dwordx4 v149, s[4:7], s28 offen offset:1024 lds
    v_mfma_f32_16x16x32_bf16 v[168:171], v[64:67], v[120:123], v[168:171]
    ds_read_b128 v[128:131], v9 offset:0
    v_mfma_f32_16x16x32_bf16 v[172:175], v[64:67], v[124:127], v[172:175]
    ds_read_b128 v[132:135], v9 offset:2048
    v_mfma_f32_16x16x32_bf16 v[188:191], v[68:71], v[124:127], v[188:191]
    ds_read_b128 v[136:139], v9 offset:4096
    v_mfma_f32_16x16x32_bf16 v[184:187], v[68:71], v[120:123], v[184:187]
    ds_read_b128 v[140:143], v9 offset:6144
    s_add_u32 m0, s49, 16384
    v_mfma_f32_16x16x32_bf16 v[180:183], v[68:71], v[116:119], v[180:183]
    ds_read_b64_tr_b16 v[92:93], v59 offset:6176
    v_mfma_f32_16x16x32_bf16 v[176:179], v[68:71], v[112:115], v[176:179]
    ds_read_b64_tr_b16 v[94:95], v59 offset:6944
    v_mfma_f32_16x16x32_bf16 v[192:195], v[72:75], v[112:115], v[192:195]
    ds_read_b64_tr_b16 v[96:97], v12 offset:6208
    v_mfma_f32_16x16x32_bf16 v[196:199], v[72:75], v[116:119], v[196:199]
    ds_read_b64_tr_b16 v[98:99], v12 offset:6976
    buffer_load_dwordx4 v150, s[16:19], s36 offen offset:0 sc1 lds
    v_mfma_f32_16x16x32_bf16 v[200:203], v[72:75], v[120:123], v[200:203]
    ds_read_b64_tr_b16 v[100:101], v12 offset:18432
    v_mfma_f32_16x16x32_bf16 v[204:207], v[72:75], v[124:127], v[204:207]
    ds_read_b64_tr_b16 v[102:103], v12 offset:19200
    v_mfma_f32_16x16x32_bf16 v[220:223], v[76:79], v[124:127], v[220:223]
    ds_read_b64_tr_b16 v[104:105], v59 offset:18464
    v_mfma_f32_16x16x32_bf16 v[216:219], v[76:79], v[120:123], v[216:219]
    ds_read_b64_tr_b16 v[106:107], v59 offset:19232
    buffer_load_dwordx4 v151, s[16:19], s36 offen offset:1024 sc1 lds
    v_mfma_f32_16x16x32_bf16 v[212:215], v[76:79], v[116:119], v[212:215]
    ds_read_b64_tr_b16 v[108:109], v12 offset:18496
    v_mfma_f32_16x16x32_bf16 v[208:211], v[76:79], v[112:115], v[208:211]
    ds_read_b64_tr_b16 v[110:111], v12 offset:19264
    v_mfma_f32_16x16x32_bf16 v[224:227], v[80:83], v[112:115], v[224:227]
    v_mfma_f32_16x16x32_bf16 v[228:231], v[80:83], v[116:119], v[228:231]
    buffer_load_dwordx4 v152, s[16:19], s36 offen offset:2048 sc1 lds
    v_mfma_f32_16x16x32_bf16 v[232:235], v[80:83], v[120:123], v[232:235]
    v_mfma_f32_16x16x32_bf16 v[236:239], v[80:83], v[124:127], v[236:239]
    v_mfma_f32_16x16x32_bf16 v[252:255], v[84:87], v[124:127], v[252:255]
    v_mfma_f32_16x16x32_bf16 v[248:251], v[84:87], v[120:123], v[248:251]
    buffer_load_dwordx4 v153, s[16:19], s36 offen offset:3072 sc1 lds
    v_mfma_f32_16x16x32_bf16 v[244:247], v[84:87], v[116:119], v[244:247]
    v_mfma_f32_16x16x32_bf16 v[240:243], v[84:87], v[112:115], v[240:243]
    s_waitcnt vmcnt(14) lgkmcnt(0)
    s_barrier
    v_mfma_f32_16x16x32_bf16 v[160:163], v[88:91], v[128:131], v[160:163]
    ds_read_b64_tr_b16 v[64:65], v13 offset:0
    v_mfma_f32_16x16x32_bf16 v[164:167], v[88:91], v[132:135], v[164:167]
    ds_read_b64_tr_b16 v[66:67], v13 offset:768
    s_add_u32 m0, s52, 0
    v_mfma_f32_16x16x32_bf16 v[168:171], v[88:91], v[136:139], v[168:171]
    ds_read_b128 v[112:115], v8 offset:32768
    v_mfma_f32_16x16x32_bf16 v[172:175], v[88:91], v[140:143], v[172:175]
    ds_read_b128 v[116:119], v8 offset:34816
    v_mfma_f32_16x16x32_bf16 v[188:191], v[92:95], v[140:143], v[188:191]
    ds_read_b128 v[120:123], v8 offset:36864
    buffer_load_dwordx4 v144, s[4:7], s29 offen offset:0 lds
    v_mfma_f32_16x16x32_bf16 v[184:187], v[92:95], v[136:139], v[184:187]
    ds_read_b128 v[124:127], v8 offset:38912
    v_mfma_f32_16x16x32_bf16 v[180:183], v[92:95], v[132:135], v[180:183]
    ds_read_b64_tr_b16 v[68:69], v62 offset:32
    v_mfma_f32_16x16x32_bf16 v[176:179], v[92:95], v[128:131], v[176:179]
    ds_read_b64_tr_b16 v[70:71], v62 offset:800
    v_mfma_f32_16x16x32_bf16 v[192:195], v[96:99], v[128:131], v[192:195]
    ds_read_b64_tr_b16 v[72:73], v13 offset:64
    buffer_load_dwordx4 v145, s[4:7], s29 offen offset:1024 lds
    v_mfma_f32_16x16x32_bf16 v[196:199], v[96:99], v[132:135], v[196:199]
    ds_read_b64_tr_b16 v[74:75], v13 offset:832
    v_mfma_f32_16x16x32_bf16 v[200:203], v[96:99], v[136:139], v[200:203]
    ds_read_b64_tr_b16 v[76:77], v13 offset:12288
    v_mfma_f32_16x16x32_bf16 v[204:207], v[96:99], v[140:143], v[204:207]
    ds_read_b64_tr_b16 v[78:79], v13 offset:13056
    buffer_load_dwordx4 v146, s[4:7], s29 offen offset:2048 lds
    v_mfma_f32_16x16x32_bf16 v[220:223], v[100:103], v[140:143], v[220:223]
    ds_read_b64_tr_b16 v[80:81], v62 offset:12320
    v_mfma_f32_16x16x32_bf16 v[216:219], v[100:103], v[136:139], v[216:219]
    ds_read_b64_tr_b16 v[82:83], v62 offset:13088
    v_mfma_f32_16x16x32_bf16 v[212:215], v[100:103], v[132:135], v[212:215]
    ds_read_b64_tr_b16 v[84:85], v13 offset:12352
    buffer_load_dwordx4 v147, s[4:7], s29 offen offset:3072 lds
    v_mfma_f32_16x16x32_bf16 v[208:211], v[100:103], v[128:131], v[208:211]
    ds_read_b64_tr_b16 v[86:87], v13 offset:13120
    v_mfma_f32_16x16x32_bf16 v[224:227], v[104:107], v[128:131], v[224:227]
    v_mfma_f32_16x16x32_bf16 v[228:231], v[104:107], v[132:135], v[228:231]
    v_mfma_f32_16x16x32_bf16 v[232:235], v[104:107], v[136:139], v[232:235]
    s_add_u32 m0, s52, 4096
    v_mfma_f32_16x16x32_bf16 v[236:239], v[104:107], v[140:143], v[236:239]
    v_mfma_f32_16x16x32_bf16 v[252:255], v[108:111], v[140:143], v[252:255]
    v_mfma_f32_16x16x32_bf16 v[248:251], v[108:111], v[136:139], v[248:251]
    buffer_load_dwordx4 v148, s[4:7], s29 offen offset:0 lds
    v_mfma_f32_16x16x32_bf16 v[244:247], v[108:111], v[132:135], v[244:247]
    v_mfma_f32_16x16x32_bf16 v[240:243], v[108:111], v[128:131], v[240:243]
    s_waitcnt lgkmcnt(0)
    v_mfma_f32_16x16x32_bf16 v[160:163], v[64:67], v[112:115], v[160:163]
    ds_read_b64_tr_b16 v[88:89], v13 offset:6144
    v_mfma_f32_16x16x32_bf16 v[164:167], v[64:67], v[116:119], v[164:167]
    ds_read_b64_tr_b16 v[90:91], v13 offset:6912
    buffer_load_dwordx4 v149, s[4:7], s29 offen offset:1024 lds
    v_mfma_f32_16x16x32_bf16 v[168:171], v[64:67], v[120:123], v[168:171]
    ds_read_b128 v[128:131], v9 offset:32768
    v_mfma_f32_16x16x32_bf16 v[172:175], v[64:67], v[124:127], v[172:175]
    ds_read_b128 v[132:135], v9 offset:34816
    v_mfma_f32_16x16x32_bf16 v[188:191], v[68:71], v[124:127], v[188:191]
    ds_read_b128 v[136:139], v9 offset:36864
    v_mfma_f32_16x16x32_bf16 v[184:187], v[68:71], v[120:123], v[184:187]
    ds_read_b128 v[140:143], v9 offset:38912
    s_add_u32 m0, s49, 0
    v_mfma_f32_16x16x32_bf16 v[180:183], v[68:71], v[116:119], v[180:183]
    ds_read_b64_tr_b16 v[92:93], v62 offset:6176
    v_mfma_f32_16x16x32_bf16 v[176:179], v[68:71], v[112:115], v[176:179]
    ds_read_b64_tr_b16 v[94:95], v62 offset:6944
    v_mfma_f32_16x16x32_bf16 v[192:195], v[72:75], v[112:115], v[192:195]
    ds_read_b64_tr_b16 v[96:97], v13 offset:6208
    v_mfma_f32_16x16x32_bf16 v[196:199], v[72:75], v[116:119], v[196:199]
    ds_read_b64_tr_b16 v[98:99], v13 offset:6976
    buffer_load_dwordx4 v150, s[16:19], s37 offen offset:0 sc1 lds
    v_mfma_f32_16x16x32_bf16 v[200:203], v[72:75], v[120:123], v[200:203]
    ds_read_b64_tr_b16 v[100:101], v13 offset:18432
    v_mfma_f32_16x16x32_bf16 v[204:207], v[72:75], v[124:127], v[204:207]
    ds_read_b64_tr_b16 v[102:103], v13 offset:19200
    v_mfma_f32_16x16x32_bf16 v[220:223], v[76:79], v[124:127], v[220:223]
    ds_read_b64_tr_b16 v[104:105], v62 offset:18464
    v_mfma_f32_16x16x32_bf16 v[216:219], v[76:79], v[120:123], v[216:219]
    ds_read_b64_tr_b16 v[106:107], v62 offset:19232
    buffer_load_dwordx4 v151, s[16:19], s37 offen offset:1024 sc1 lds
    v_mfma_f32_16x16x32_bf16 v[212:215], v[76:79], v[116:119], v[212:215]
    ds_read_b64_tr_b16 v[108:109], v13 offset:18496
    v_mfma_f32_16x16x32_bf16 v[208:211], v[76:79], v[112:115], v[208:211]
    ds_read_b64_tr_b16 v[110:111], v13 offset:19264
    v_mfma_f32_16x16x32_bf16 v[224:227], v[80:83], v[112:115], v[224:227]
    v_mfma_f32_16x16x32_bf16 v[228:231], v[80:83], v[116:119], v[228:231]
    buffer_load_dwordx4 v152, s[16:19], s37 offen offset:2048 sc1 lds
    v_mfma_f32_16x16x32_bf16 v[232:235], v[80:83], v[120:123], v[232:235]
    v_mfma_f32_16x16x32_bf16 v[236:239], v[80:83], v[124:127], v[236:239]
    v_mfma_f32_16x16x32_bf16 v[252:255], v[84:87], v[124:127], v[252:255]
    v_mfma_f32_16x16x32_bf16 v[248:251], v[84:87], v[120:123], v[248:251]
    buffer_load_dwordx4 v153, s[16:19], s37 offen offset:3072 sc1 lds
    v_mfma_f32_16x16x32_bf16 v[244:247], v[84:87], v[116:119], v[244:247]
    v_mfma_f32_16x16x32_bf16 v[240:243], v[84:87], v[112:115], v[240:243]
    s_waitcnt vmcnt(20) lgkmcnt(0)
    s_barrier
    v_mfma_f32_16x16x32_bf16 v[160:163], v[88:91], v[128:131], v[160:163]
    ds_read_b64_tr_b16 v[64:65], v13 offset:24576
    v_mfma_f32_16x16x32_bf16 v[164:167], v[88:91], v[132:135], v[164:167]
    ds_read_b64_tr_b16 v[66:67], v13 offset:25344
    s_add_u32 m0, s52, 49152
    v_mfma_f32_16x16x32_bf16 v[168:171], v[88:91], v[136:139], v[168:171]
    ds_read_b128 v[112:115], v8 offset:49152
    v_mfma_f32_16x16x32_bf16 v[172:175], v[88:91], v[140:143], v[172:175]
    ds_read_b128 v[116:119], v8 offset:51200
    v_mfma_f32_16x16x32_bf16 v[188:191], v[92:95], v[140:143], v[188:191]
    ds_read_b128 v[120:123], v8 offset:53248
    buffer_load_dwordx4 v144, s[4:7], s30 offen offset:0 lds
    v_mfma_f32_16x16x32_bf16 v[184:187], v[92:95], v[136:139], v[184:187]
    ds_read_b128 v[124:127], v8 offset:55296
    v_mfma_f32_16x16x32_bf16 v[180:183], v[92:95], v[132:135], v[180:183]
    ds_read_b64_tr_b16 v[68:69], v62 offset:24608
    v_mfma_f32_16x16x32_bf16 v[176:179], v[92:95], v[128:131], v[176:179]
    ds_read_b64_tr_b16 v[70:71], v62 offset:25376
    v_mfma_f32_16x16x32_bf16 v[192:195], v[96:99], v[128:131], v[192:195]
    ds_read_b64_tr_b16 v[72:73], v13 offset:24640
    buffer_load_dwordx4 v145, s[4:7], s30 offen offset:1024 lds
    v_mfma_f32_16x16x32_bf16 v[196:199], v[96:99], v[132:135], v[196:199]
    ds_read_b64_tr_b16 v[74:75], v13 offset:25408
    v_mfma_f32_16x16x32_bf16 v[200:203], v[96:99], v[136:139], v[200:203]
    ds_read_b64_tr_b16 v[76:77], v13 offset:36864
    v_mfma_f32_16x16x32_bf16 v[204:207], v[96:99], v[140:143], v[204:207]
    ds_read_b64_tr_b16 v[78:79], v13 offset:37632
    buffer_load_dwordx4 v146, s[4:7], s30 offen offset:2048 lds
    v_mfma_f32_16x16x32_bf16 v[220:223], v[100:103], v[140:143], v[220:223]
    ds_read_b64_tr_b16 v[80:81], v62 offset:36896
    v_mfma_f32_16x16x32_bf16 v[216:219], v[100:103], v[136:139], v[216:219]
    ds_read_b64_tr_b16 v[82:83], v62 offset:37664
    v_mfma_f32_16x16x32_bf16 v[212:215], v[100:103], v[132:135], v[212:215]
    ds_read_b64_tr_b16 v[84:85], v13 offset:36928
    buffer_load_dwordx4 v147, s[4:7], s30 offen offset:3072 lds
    v_mfma_f32_16x16x32_bf16 v[208:211], v[100:103], v[128:131], v[208:211]
    ds_read_b64_tr_b16 v[86:87], v13 offset:37696
    v_mfma_f32_16x16x32_bf16 v[224:227], v[104:107], v[128:131], v[224:227]
    v_mfma_f32_16x16x32_bf16 v[228:231], v[104:107], v[132:135], v[228:231]
    v_mfma_f32_16x16x32_bf16 v[232:235], v[104:107], v[136:139], v[232:235]
    s_add_u32 m0, s52, 53248
    v_mfma_f32_16x16x32_bf16 v[236:239], v[104:107], v[140:143], v[236:239]
    v_mfma_f32_16x16x32_bf16 v[252:255], v[108:111], v[140:143], v[252:255]
    v_mfma_f32_16x16x32_bf16 v[248:251], v[108:111], v[136:139], v[248:251]
    buffer_load_dwordx4 v148, s[4:7], s30 offen offset:0 lds
    v_mfma_f32_16x16x32_bf16 v[244:247], v[108:111], v[132:135], v[244:247]
    v_mfma_f32_16x16x32_bf16 v[240:243], v[108:111], v[128:131], v[240:243]
    s_waitcnt lgkmcnt(0)
    v_mfma_f32_16x16x32_bf16 v[160:163], v[64:67], v[112:115], v[160:163]
    ds_read_b64_tr_b16 v[88:89], v13 offset:30720
    v_mfma_f32_16x16x32_bf16 v[164:167], v[64:67], v[116:119], v[164:167]
    ds_read_b64_tr_b16 v[90:91], v13 offset:31488
    buffer_load_dwordx4 v149, s[4:7], s30 offen offset:1024 lds
    v_mfma_f32_16x16x32_bf16 v[168:171], v[64:67], v[120:123], v[168:171]
    ds_read_b128 v[128:131], v9 offset:49152
    v_mfma_f32_16x16x32_bf16 v[172:175], v[64:67], v[124:127], v[172:175]
    ds_read_b128 v[132:135], v9 offset:51200
    v_mfma_f32_16x16x32_bf16 v[188:191], v[68:71], v[124:127], v[188:191]
    ds_read_b128 v[136:139], v9 offset:53248
    v_mfma_f32_16x16x32_bf16 v[184:187], v[68:71], v[120:123], v[184:187]
    ds_read_b128 v[140:143], v9 offset:55296
    s_add_u32 m0, s49, 32768
    v_mfma_f32_16x16x32_bf16 v[180:183], v[68:71], v[116:119], v[180:183]
    ds_read_b64_tr_b16 v[92:93], v62 offset:30752
    v_mfma_f32_16x16x32_bf16 v[176:179], v[68:71], v[112:115], v[176:179]
    ds_read_b64_tr_b16 v[94:95], v62 offset:31520
    v_mfma_f32_16x16x32_bf16 v[192:195], v[72:75], v[112:115], v[192:195]
    ds_read_b64_tr_b16 v[96:97], v13 offset:30784
    v_mfma_f32_16x16x32_bf16 v[196:199], v[72:75], v[116:119], v[196:199]
    ds_read_b64_tr_b16 v[98:99], v13 offset:31552
    buffer_load_dwordx4 v150, s[16:19], s38 offen offset:0 sc1 lds
    v_mfma_f32_16x16x32_bf16 v[200:203], v[72:75], v[120:123], v[200:203]
    ds_read_b64_tr_b16 v[100:101], v13 offset:43008
    v_mfma_f32_16x16x32_bf16 v[204:207], v[72:75], v[124:127], v[204:207]
    ds_read_b64_tr_b16 v[102:103], v13 offset:43776
    v_mfma_f32_16x16x32_bf16 v[220:223], v[76:79], v[124:127], v[220:223]
    ds_read_b64_tr_b16 v[104:105], v62 offset:43040
    v_mfma_f32_16x16x32_bf16 v[216:219], v[76:79], v[120:123], v[216:219]
    ds_read_b64_tr_b16 v[106:107], v62 offset:43808
    buffer_load_dwordx4 v151, s[16:19], s38 offen offset:1024 sc1 lds
    v_mfma_f32_16x16x32_bf16 v[212:215], v[76:79], v[116:119], v[212:215]
    ds_read_b64_tr_b16 v[108:109], v13 offset:43072
    v_mfma_f32_16x16x32_bf16 v[208:211], v[76:79], v[112:115], v[208:211]
    ds_read_b64_tr_b16 v[110:111], v13 offset:43840
    v_mfma_f32_16x16x32_bf16 v[224:227], v[80:83], v[112:115], v[224:227]
    v_mfma_f32_16x16x32_bf16 v[228:231], v[80:83], v[116:119], v[228:231]
    buffer_load_dwordx4 v152, s[16:19], s38 offen offset:2048 sc1 lds
    v_mfma_f32_16x16x32_bf16 v[232:235], v[80:83], v[120:123], v[232:235]
    v_mfma_f32_16x16x32_bf16 v[236:239], v[80:83], v[124:127], v[236:239]
    v_mfma_f32_16x16x32_bf16 v[252:255], v[84:87], v[124:127], v[252:255]
    v_mfma_f32_16x16x32_bf16 v[248:251], v[84:87], v[120:123], v[248:251]
    buffer_load_dwordx4 v153, s[16:19], s38 offen offset:3072 sc1 lds
    v_mfma_f32_16x16x32_bf16 v[244:247], v[84:87], v[116:119], v[244:247]
    v_mfma_f32_16x16x32_bf16 v[240:243], v[84:87], v[112:115], v[240:243]
    s_waitcnt vmcnt(20) lgkmcnt(0)
    s_barrier
    v_mfma_f32_16x16x32_bf16 v[160:163], v[88:91], v[128:131], v[160:163]
    ds_read_b64_tr_b16 v[64:65], v12 offset:24576
    v_mfma_f32_16x16x32_bf16 v[164:167], v[88:91], v[132:135], v[164:167]
    ds_read_b64_tr_b16 v[66:67], v12 offset:25344
    s_add_u32 m0, s52, 73728
    v_mfma_f32_16x16x32_bf16 v[168:171], v[88:91], v[136:139], v[168:171]
    ds_read_b128 v[112:115], v8 offset:16384
    v_mfma_f32_16x16x32_bf16 v[172:175], v[88:91], v[140:143], v[172:175]
    ds_read_b128 v[116:119], v8 offset:18432
    v_mfma_f32_16x16x32_bf16 v[188:191], v[92:95], v[140:143], v[188:191]
    ds_read_b128 v[120:123], v8 offset:20480
    buffer_load_dwordx4 v144, s[4:7], s31 offen offset:0 lds
    v_mfma_f32_16x16x32_bf16 v[184:187], v[92:95], v[136:139], v[184:187]
    ds_read_b128 v[124:127], v8 offset:22528
    v_mfma_f32_16x16x32_bf16 v[180:183], v[92:95], v[132:135], v[180:183]
    ds_read_b64_tr_b16 v[68:69], v59 offset:24608
    v_mfma_f32_16x16x32_bf16 v[176:179], v[92:95], v[128:131], v[176:179]
    ds_read_b64_tr_b16 v[70:71], v59 offset:25376
    v_mfma_f32_16x16x32_bf16 v[192:195], v[96:99], v[128:131], v[192:195]
    ds_read_b64_tr_b16 v[72:73], v12 offset:24640
    buffer_load_dwordx4 v145, s[4:7], s31 offen offset:1024 lds
    v_mfma_f32_16x16x32_bf16 v[196:199], v[96:99], v[132:135], v[196:199]
    ds_read_b64_tr_b16 v[74:75], v12 offset:25408
    v_mfma_f32_16x16x32_bf16 v[200:203], v[96:99], v[136:139], v[200:203]
    ds_read_b64_tr_b16 v[76:77], v12 offset:36864
    v_mfma_f32_16x16x32_bf16 v[204:207], v[96:99], v[140:143], v[204:207]
    ds_read_b64_tr_b16 v[78:79], v12 offset:37632
    buffer_load_dwordx4 v146, s[4:7], s31 offen offset:2048 lds
    v_mfma_f32_16x16x32_bf16 v[220:223], v[100:103], v[140:143], v[220:223]
    ds_read_b64_tr_b16 v[80:81], v59 offset:36896
    v_mfma_f32_16x16x32_bf16 v[216:219], v[100:103], v[136:139], v[216:219]
    ds_read_b64_tr_b16 v[82:83], v59 offset:37664
    v_mfma_f32_16x16x32_bf16 v[212:215], v[100:103], v[132:135], v[212:215]
    ds_read_b64_tr_b16 v[84:85], v12 offset:36928
    buffer_load_dwordx4 v147, s[4:7], s31 offen offset:3072 lds
    v_mfma_f32_16x16x32_bf16 v[208:211], v[100:103], v[128:131], v[208:211]
    ds_read_b64_tr_b16 v[86:87], v12 offset:37696
    v_mfma_f32_16x16x32_bf16 v[224:227], v[104:107], v[128:131], v[224:227]
    v_mfma_f32_16x16x32_bf16 v[228:231], v[104:107], v[132:135], v[228:231]
    v_mfma_f32_16x16x32_bf16 v[232:235], v[104:107], v[136:139], v[232:235]
    s_add_u32 m0, s52, 77824
    v_mfma_f32_16x16x32_bf16 v[236:239], v[104:107], v[140:143], v[236:239]
    v_mfma_f32_16x16x32_bf16 v[252:255], v[108:111], v[140:143], v[252:255]
    v_mfma_f32_16x16x32_bf16 v[248:251], v[108:111], v[136:139], v[248:251]
    buffer_load_dwordx4 v148, s[4:7], s31 offen offset:0 lds
    v_mfma_f32_16x16x32_bf16 v[244:247], v[108:111], v[132:135], v[244:247]
    v_mfma_f32_16x16x32_bf16 v[240:243], v[108:111], v[128:131], v[240:243]
    s_waitcnt lgkmcnt(0)
    v_mfma_f32_16x16x32_bf16 v[160:163], v[64:67], v[112:115], v[160:163]
    ds_read_b64_tr_b16 v[88:89], v12 offset:30720
    v_mfma_f32_16x16x32_bf16 v[164:167], v[64:67], v[116:119], v[164:167]
    ds_read_b64_tr_b16 v[90:91], v12 offset:31488
    buffer_load_dwordx4 v149, s[4:7], s31 offen offset:1024 lds
    v_mfma_f32_16x16x32_bf16 v[168:171], v[64:67], v[120:123], v[168:171]
    ds_read_b128 v[128:131], v9 offset:16384
    v_mfma_f32_16x16x32_bf16 v[172:175], v[64:67], v[124:127], v[172:175]
    ds_read_b128 v[132:135], v9 offset:18432
    v_mfma_f32_16x16x32_bf16 v[188:191], v[68:71], v[124:127], v[188:191]
    ds_read_b128 v[136:139], v9 offset:20480
    v_mfma_f32_16x16x32_bf16 v[184:187], v[68:71], v[120:123], v[184:187]
    ds_read_b128 v[140:143], v9 offset:22528
    s_add_u32 m0, s49, 49152
    v_mfma_f32_16x16x32_bf16 v[180:183], v[68:71], v[116:119], v[180:183]
    ds_read_b64_tr_b16 v[92:93], v59 offset:30752
    v_mfma_f32_16x16x32_bf16 v[176:179], v[68:71], v[112:115], v[176:179]
    ds_read_b64_tr_b16 v[94:95], v59 offset:31520
    v_mfma_f32_16x16x32_bf16 v[192:195], v[72:75], v[112:115], v[192:195]
    ds_read_b64_tr_b16 v[96:97], v12 offset:30784
    v_mfma_f32_16x16x32_bf16 v[196:199], v[72:75], v[116:119], v[196:199]
    ds_read_b64_tr_b16 v[98:99], v12 offset:31552
    buffer_load_dwordx4 v150, s[16:19], s39 offen offset:0 sc1 lds
    v_mfma_f32_16x16x32_bf16 v[200:203], v[72:75], v[120:123], v[200:203]
    ds_read_b64_tr_b16 v[100:101], v12 offset:43008
    v_mfma_f32_16x16x32_bf16 v[204:207], v[72:75], v[124:127], v[204:207]
    ds_read_b64_tr_b16 v[102:103], v12 offset:43776
    v_mfma_f32_16x16x32_bf16 v[220:223], v[76:79], v[124:127], v[220:223]
    ds_read_b64_tr_b16 v[104:105], v59 offset:43040
    v_mfma_f32_16x16x32_bf16 v[216:219], v[76:79], v[120:123], v[216:219]
    ds_read_b64_tr_b16 v[106:107], v59 offset:43808
    buffer_load_dwordx4 v151, s[16:19], s39 offen offset:1024 sc1 lds
    v_mfma_f32_16x16x32_bf16 v[212:215], v[76:79], v[116:119], v[212:215]
    ds_read_b64_tr_b16 v[108:109], v12 offset:43072
    v_mfma_f32_16x16x32_bf16 v[208:211], v[76:79], v[112:115], v[208:211]
    ds_read_b64_tr_b16 v[110:111], v12 offset:43840
    v_mfma_f32_16x16x32_bf16 v[224:227], v[80:83], v[112:115], v[224:227]
    v_mfma_f32_16x16x32_bf16 v[228:231], v[80:83], v[116:119], v[228:231]
    buffer_load_dwordx4 v152, s[16:19], s39 offen offset:2048 sc1 lds
    v_mfma_f32_16x16x32_bf16 v[232:235], v[80:83], v[120:123], v[232:235]
    v_mfma_f32_16x16x32_bf16 v[236:239], v[80:83], v[124:127], v[236:239]
    v_mfma_f32_16x16x32_bf16 v[252:255], v[84:87], v[124:127], v[252:255]
    v_mfma_f32_16x16x32_bf16 v[248:251], v[84:87], v[120:123], v[248:251]
    buffer_load_dwordx4 v153, s[16:19], s39 offen offset:3072 sc1 lds
    v_mfma_f32_16x16x32_bf16 v[244:247], v[84:87], v[116:119], v[244:247]
    v_mfma_f32_16x16x32_bf16 v[240:243], v[84:87], v[112:115], v[240:243]
    s_waitcnt vmcnt(20) lgkmcnt(0)
    s_barrier
    v_mfma_f32_16x16x32_bf16 v[160:163], v[88:91], v[128:131], v[160:163]
    ds_read_b64_tr_b16 v[64:65], v12 offset:0
    v_mfma_f32_16x16x32_bf16 v[164:167], v[88:91], v[132:135], v[164:167]
    ds_read_b64_tr_b16 v[66:67], v12 offset:768
    s_add_u32 m0, s52, 24576
    v_mfma_f32_16x16x32_bf16 v[168:171], v[88:91], v[136:139], v[168:171]
    ds_read_b128 v[112:115], v8 offset:0
    v_mfma_f32_16x16x32_bf16 v[172:175], v[88:91], v[140:143], v[172:175]
    ds_read_b128 v[116:119], v8 offset:2048
    v_mfma_f32_16x16x32_bf16 v[188:191], v[92:95], v[140:143], v[188:191]
    ds_read_b128 v[120:123], v8 offset:4096
    buffer_load_dwordx4 v144, s[4:7], s32 offen offset:0 lds
    v_mfma_f32_16x16x32_bf16 v[184:187], v[92:95], v[136:139], v[184:187]
    ds_read_b128 v[124:127], v8 offset:6144
    v_mfma_f32_16x16x32_bf16 v[180:183], v[92:95], v[132:135], v[180:183]
    ds_read_b64_tr_b16 v[68:69], v59 offset:32
    v_mfma_f32_16x16x32_bf16 v[176:179], v[92:95], v[128:131], v[176:179]
    ds_read_b64_tr_b16 v[70:71], v59 offset:800
    v_mfma_f32_16x16x32_bf16 v[192:195], v[96:99], v[128:131], v[192:195]
    ds_read_b64_tr_b16 v[72:73], v12 offset:64
    buffer_load_dwordx4 v145, s[4:7], s32 offen offset:1024 lds
    v_mfma_f32_16x16x32_bf16 v[196:199], v[96:99], v[132:135], v[196:199]
    ds_read_b64_tr_b16 v[74:75], v12 offset:832
    v_mfma_f32_16x16x32_bf16 v[200:203], v[96:99], v[136:139], v[200:203]
    ds_read_b64_tr_b16 v[76:77], v12 offset:12288
    v_mfma_f32_16x16x32_bf16 v[204:207], v[96:99], v[140:143], v[204:207]
    ds_read_b64_tr_b16 v[78:79], v12 offset:13056
    buffer_load_dwordx4 v146, s[4:7], s32 offen offset:2048 lds
    v_mfma_f32_16x16x32_bf16 v[220:223], v[100:103], v[140:143], v[220:223]
    ds_read_b64_tr_b16 v[80:81], v59 offset:12320
    v_mfma_f32_16x16x32_bf16 v[216:219], v[100:103], v[136:139], v[216:219]
    ds_read_b64_tr_b16 v[82:83], v59 offset:13088
    v_mfma_f32_16x16x32_bf16 v[212:215], v[100:103], v[132:135], v[212:215]
    ds_read_b64_tr_b16 v[84:85], v12 offset:12352
    buffer_load_dwordx4 v147, s[4:7], s32 offen offset:3072 lds
    v_mfma_f32_16x16x32_bf16 v[208:211], v[100:103], v[128:131], v[208:211]
    ds_read_b64_tr_b16 v[86:87], v12 offset:13120
    v_mfma_f32_16x16x32_bf16 v[224:227], v[104:107], v[128:131], v[224:227]
    v_mfma_f32_16x16x32_bf16 v[228:231], v[104:107], v[132:135], v[228:231]
    v_mfma_f32_16x16x32_bf16 v[232:235], v[104:107], v[136:139], v[232:235]
    s_add_u32 m0, s52, 28672
    v_mfma_f32_16x16x32_bf16 v[236:239], v[104:107], v[140:143], v[236:239]
    v_mfma_f32_16x16x32_bf16 v[252:255], v[108:111], v[140:143], v[252:255]
    v_mfma_f32_16x16x32_bf16 v[248:251], v[108:111], v[136:139], v[248:251]
    buffer_load_dwordx4 v148, s[4:7], s32 offen offset:0 lds
    v_mfma_f32_16x16x32_bf16 v[244:247], v[108:111], v[132:135], v[244:247]
    v_mfma_f32_16x16x32_bf16 v[240:243], v[108:111], v[128:131], v[240:243]
    s_waitcnt lgkmcnt(0)
    v_mfma_f32_16x16x32_bf16 v[160:163], v[64:67], v[112:115], v[160:163]
    ds_read_b64_tr_b16 v[88:89], v12 offset:6144
    v_mfma_f32_16x16x32_bf16 v[164:167], v[64:67], v[116:119], v[164:167]
    ds_read_b64_tr_b16 v[90:91], v12 offset:6912
    buffer_load_dwordx4 v149, s[4:7], s32 offen offset:1024 lds
    v_mfma_f32_16x16x32_bf16 v[168:171], v[64:67], v[120:123], v[168:171]
    ds_read_b128 v[128:131], v9 offset:0
    v_mfma_f32_16x16x32_bf16 v[172:175], v[64:67], v[124:127], v[172:175]
    ds_read_b128 v[132:135], v9 offset:2048
    v_mfma_f32_16x16x32_bf16 v[188:191], v[68:71], v[124:127], v[188:191]
    ds_read_b128 v[136:139], v9 offset:4096
    v_mfma_f32_16x16x32_bf16 v[184:187], v[68:71], v[120:123], v[184:187]
    ds_read_b128 v[140:143], v9 offset:6144
    s_add_u32 m0, s49, 16384
    v_mfma_f32_16x16x32_bf16 v[180:183], v[68:71], v[116:119], v[180:183]
    ds_read_b64_tr_b16 v[92:93], v59 offset:6176
    v_mfma_f32_16x16x32_bf16 v[176:179], v[68:71], v[112:115], v[176:179]
    ds_read_b64_tr_b16 v[94:95], v59 offset:6944
    v_mfma_f32_16x16x32_bf16 v[192:195], v[72:75], v[112:115], v[192:195]
    ds_read_b64_tr_b16 v[96:97], v12 offset:6208
    v_mfma_f32_16x16x32_bf16 v[196:199], v[72:75], v[116:119], v[196:199]
    ds_read_b64_tr_b16 v[98:99], v12 offset:6976
    buffer_load_dwordx4 v150, s[16:19], s46 offen offset:0 sc1 lds
    v_mfma_f32_16x16x32_bf16 v[200:203], v[72:75], v[120:123], v[200:203]
    ds_read_b64_tr_b16 v[100:101], v12 offset:18432
    v_mfma_f32_16x16x32_bf16 v[204:207], v[72:75], v[124:127], v[204:207]
    ds_read_b64_tr_b16 v[102:103], v12 offset:19200
    v_mfma_f32_16x16x32_bf16 v[220:223], v[76:79], v[124:127], v[220:223]
    ds_read_b64_tr_b16 v[104:105], v59 offset:18464
    v_mfma_f32_16x16x32_bf16 v[216:219], v[76:79], v[120:123], v[216:219]
    ds_read_b64_tr_b16 v[106:107], v59 offset:19232
    buffer_load_dwordx4 v151, s[16:19], s46 offen offset:1024 sc1 lds
    v_mfma_f32_16x16x32_bf16 v[212:215], v[76:79], v[116:119], v[212:215]
    ds_read_b64_tr_b16 v[108:109], v12 offset:18496
    v_mfma_f32_16x16x32_bf16 v[208:211], v[76:79], v[112:115], v[208:211]
    ds_read_b64_tr_b16 v[110:111], v12 offset:19264
    v_mfma_f32_16x16x32_bf16 v[224:227], v[80:83], v[112:115], v[224:227]
    v_mfma_f32_16x16x32_bf16 v[228:231], v[80:83], v[116:119], v[228:231]
    buffer_load_dwordx4 v152, s[16:19], s46 offen offset:2048 sc1 lds
    v_mfma_f32_16x16x32_bf16 v[232:235], v[80:83], v[120:123], v[232:235]
    v_mfma_f32_16x16x32_bf16 v[236:239], v[80:83], v[124:127], v[236:239]
    v_mfma_f32_16x16x32_bf16 v[252:255], v[84:87], v[124:127], v[252:255]
    v_mfma_f32_16x16x32_bf16 v[248:251], v[84:87], v[120:123], v[248:251]
    buffer_load_dwordx4 v153, s[16:19], s46 offen offset:3072 sc1 lds
    v_mfma_f32_16x16x32_bf16 v[244:247], v[84:87], v[116:119], v[244:247]
    v_mfma_f32_16x16x32_bf16 v[240:243], v[84:87], v[112:115], v[240:243]
    s_waitcnt vmcnt(20) lgkmcnt(0)
    s_barrier
    v_mfma_f32_16x16x32_bf16 v[160:163], v[88:91], v[128:131], v[160:163]
    ds_read_b64_tr_b16 v[64:65], v13 offset:0
    v_mfma_f32_16x16x32_bf16 v[164:167], v[88:91], v[132:135], v[164:167]
    ds_read_b64_tr_b16 v[66:67], v13 offset:768
    s_add_u32 m0, s52, 0
    v_mfma_f32_16x16x32_bf16 v[168:171], v[88:91], v[136:139], v[168:171]
    ds_read_b128 v[112:115], v8 offset:32768
    v_mfma_f32_16x16x32_bf16 v[172:175], v[88:91], v[140:143], v[172:175]
    ds_read_b128 v[116:119], v8 offset:34816
    v_mfma_f32_16x16x32_bf16 v[188:191], v[92:95], v[140:143], v[188:191]
    ds_read_b128 v[120:123], v8 offset:36864
    buffer_load_dwordx4 v144, s[4:7], s33 offen offset:0 lds
    v_mfma_f32_16x16x32_bf16 v[184:187], v[92:95], v[136:139], v[184:187]
    ds_read_b128 v[124:127], v8 offset:38912
    v_mfma_f32_16x16x32_bf16 v[180:183], v[92:95], v[132:135], v[180:183]
    ds_read_b64_tr_b16 v[68:69], v62 offset:32
    v_mfma_f32_16x16x32_bf16 v[176:179], v[92:95], v[128:131], v[176:179]
    ds_read_b64_tr_b16 v[70:71], v62 offset:800
    v_mfma_f32_16x16x32_bf16 v[192:195], v[96:99], v[128:131], v[192:195]
    ds_read_b64_tr_b16 v[72:73], v13 offset:64
    buffer_load_dwordx4 v145, s[4:7], s33 offen offset:1024 lds
    v_mfma_f32_16x16x32_bf16 v[196:199], v[96:99], v[132:135], v[196:199]
    ds_read_b64_tr_b16 v[74:75], v13 offset:832
    v_mfma_f32_16x16x32_bf16 v[200:203], v[96:99], v[136:139], v[200:203]
    ds_read_b64_tr_b16 v[76:77], v13 offset:12288
    v_mfma_f32_16x16x32_bf16 v[204:207], v[96:99], v[140:143], v[204:207]
    ds_read_b64_tr_b16 v[78:79], v13 offset:13056
    buffer_load_dwordx4 v146, s[4:7], s33 offen offset:2048 lds
    v_mfma_f32_16x16x32_bf16 v[220:223], v[100:103], v[140:143], v[220:223]
    ds_read_b64_tr_b16 v[80:81], v62 offset:12320
    v_mfma_f32_16x16x32_bf16 v[216:219], v[100:103], v[136:139], v[216:219]
    ds_read_b64_tr_b16 v[82:83], v62 offset:13088
    v_mfma_f32_16x16x32_bf16 v[212:215], v[100:103], v[132:135], v[212:215]
    ds_read_b64_tr_b16 v[84:85], v13 offset:12352
    buffer_load_dwordx4 v147, s[4:7], s33 offen offset:3072 lds
    v_mfma_f32_16x16x32_bf16 v[208:211], v[100:103], v[128:131], v[208:211]
    ds_read_b64_tr_b16 v[86:87], v13 offset:13120
    v_mfma_f32_16x16x32_bf16 v[224:227], v[104:107], v[128:131], v[224:227]
    v_mfma_f32_16x16x32_bf16 v[228:231], v[104:107], v[132:135], v[228:231]
    v_mfma_f32_16x16x32_bf16 v[232:235], v[104:107], v[136:139], v[232:235]
    s_add_u32 m0, s52, 4096
    v_mfma_f32_16x16x32_bf16 v[236:239], v[104:107], v[140:143], v[236:239]
    v_mfma_f32_16x16x32_bf16 v[252:255], v[108:111], v[140:143], v[252:255]
    v_mfma_f32_16x16x32_bf16 v[248:251], v[108:111], v[136:139], v[248:251]
    buffer_load_dwordx4 v148, s[4:7], s33 offen offset:0 lds
    v_mfma_f32_16x16x32_bf16 v[244:247], v[108:111], v[132:135], v[244:247]
    v_mfma_f32_16x16x32_bf16 v[240:243], v[108:111], v[128:131], v[240:243]
    s_waitcnt lgkmcnt(0)
    v_mfma_f32_16x16x32_bf16 v[160:163], v[64:67], v[112:115], v[160:163]
    ds_read_b64_tr_b16 v[88:89], v13 offset:6144
    v_mfma_f32_16x16x32_bf16 v[164:167], v[64:67], v[116:119], v[164:167]
    ds_read_b64_tr_b16 v[90:91], v13 offset:6912
    buffer_load_dwordx4 v149, s[4:7], s33 offen offset:1024 lds
    v_mfma_f32_16x16x32_bf16 v[168:171], v[64:67], v[120:123], v[168:171]
    ds_read_b128 v[128:131], v9 offset:32768
    v_mfma_f32_16x16x32_bf16 v[172:175], v[64:67], v[124:127], v[172:175]
    ds_read_b128 v[132:135], v9 offset:34816
    v_mfma_f32_16x16x32_bf16 v[188:191], v[68:71], v[124:127], v[188:191]
    ds_read_b128 v[136:139], v9 offset:36864
    s_add_u32 m0, s49, 0
    v_mfma_f32_16x16x32_bf16 v[184:187], v[68:71], v[120:123], v[184:187]
    ds_read_b128 v[140:143], v9 offset:38912
    v_mfma_f32_16x16x32_bf16 v[180:183], v[68:71], v[116:119], v[180:183]
    ds_read_b64_tr_b16 v[92:93], v62 offset:6176
    v_mfma_f32_16x16x32_bf16 v[176:179], v[68:71], v[112:115], v[176:179]
    ds_read_b64_tr_b16 v[94:95], v62 offset:6944
    v_mfma_f32_16x16x32_bf16 v[192:195], v[72:75], v[112:115], v[192:195]
    ds_read_b64_tr_b16 v[96:97], v13 offset:6208
    buffer_load_dwordx4 v150, s[16:19], s47 offen offset:0 sc1 lds
    v_mfma_f32_16x16x32_bf16 v[196:199], v[72:75], v[116:119], v[196:199]
    ds_read_b64_tr_b16 v[98:99], v13 offset:6976
    v_mfma_f32_16x16x32_bf16 v[200:203], v[72:75], v[120:123], v[200:203]
    ds_read_b64_tr_b16 v[100:101], v13 offset:18432
    v_mfma_f32_16x16x32_bf16 v[204:207], v[72:75], v[124:127], v[204:207]
    ds_read_b64_tr_b16 v[102:103], v13 offset:19200
    buffer_load_dwordx4 v151, s[16:19], s47 offen offset:1024 sc1 lds
    v_mfma_f32_16x16x32_bf16 v[220:223], v[76:79], v[124:127], v[220:223]
    ds_read_b64_tr_b16 v[104:105], v62 offset:18464
    v_mfma_f32_16x16x32_bf16 v[216:219], v[76:79], v[120:123], v[216:219]
    ds_read_b64_tr_b16 v[106:107], v62 offset:19232
    v_mfma_f32_16x16x32_bf16 v[212:215], v[76:79], v[116:119], v[212:215]
    ds_read_b64_tr_b16 v[108:109], v13 offset:18496
    buffer_load_dwordx4 v152, s[16:19], s47 offen offset:2048 sc1 lds
    v_mfma_f32_16x16x32_bf16 v[208:211], v[76:79], v[112:115], v[208:211]
    ds_read_b64_tr_b16 v[110:111], v13 offset:19264
    v_mfma_f32_16x16x32_bf16 v[224:227], v[80:83], v[112:115], v[224:227]
    v_mfma_f32_16x16x32_bf16 v[228:231], v[80:83], v[116:119], v[228:231]
    v_mfma_f32_16x16x32_bf16 v[232:235], v[80:83], v[120:123], v[232:235]
    buffer_load_dwordx4 v153, s[16:19], s47 offen offset:3072 sc1 lds
    v_mfma_f32_16x16x32_bf16 v[236:239], v[80:83], v[124:127], v[236:239]
    v_mfma_f32_16x16x32_bf16 v[252:255], v[84:87], v[124:127], v[252:255]
    v_mfma_f32_16x16x32_bf16 v[248:251], v[84:87], v[120:123], v[248:251]
    v_lshlrev_b32 v63, 5, v0
    v_add_u32 v63, K_depi-K_pc, v63
    v_min_u32 v63, K2_table-K_pc, v63
    s_mov_b32 exec_lo, 0x11111111
    s_mov_b32 exec_hi, 0x11111111
    global_load_dword v63, v63, s[26:27]
    s_mov_b64 exec, -1
    v_mfma_f32_16x16x32_bf16 v[244:247], v[84:87], v[116:119], v[244:247]
    v_mfma_f32_16x16x32_bf16 v[240:243], v[84:87], v[112:115], v[240:243]
    s_waitcnt vmcnt(21) lgkmcnt(0)
    s_barrier
    v_mfma_f32_16x16x32_bf16 v[160:163], v[88:91], v[128:131], v[160:163]
    ds_read_b64_tr_b16 v[64:65], v13 offset:24576
    v_mfma_f32_16x16x32_bf16 v[164:167], v[88:91], v[132:135], v[164:167]
    ds_read_b64_tr_b16 v[66:67], v13 offset:25344
    v_mfma_f32_16x16x32_bf16 v[168:171], v[88:91], v[136:139], v[168:171]
    ds_read_b128 v[112:115], v8 offset:49152
    buffer_load_dwordx4 a[24:27], v3, s[16:19], s87 offen offset:2048 sc1
    v_mfma_f32_16x16x32_bf16 v[172:175], v[88:91], v[140:143], v[172:175]
    ds_read_b128 v[116:119], v8 offset:51200
    v_mfma_f32_16x16x32_bf16 v[188:191], v[92:95], v[140:143], v[188:191]
    ds_read_b128 v[120:123], v8 offset:53248
    v_mfma_f32_16x16x32_bf16 v[184:187], v[92:95], v[136:139], v[184:187]
    ds_read_b128 v[124:127], v8 offset:55296
    v_mfma_f32_16x16x32_bf16 v[180:183], v[92:95], v[132:135], v[180:183]
    ds_read_b64_tr_b16 v[68:69], v62 offset:24608
    buffer_load_dwordx4 a[28:31], v3, s[16:19], s87 offen offset:3072 sc1
    v_mfma_f32_16x16x32_bf16 v[176:179], v[92:95], v[128:131], v[176:179]
    ds_read_b64_tr_b16 v[70:71], v62 offset:25376
    v_mfma_f32_16x16x32_bf16 v[192:195], v[96:99], v[128:131], v[192:195]
    ds_read_b64_tr_b16 v[72:73], v13 offset:24640
    v_mfma_f32_16x16x32_bf16 v[196:199], v[96:99], v[132:135], v[196:199]
    ds_read_b64_tr_b16 v[74:75], v13 offset:25408
    v_mfma_f32_16x16x32_bf16 v[200:203], v[96:99], v[136:139], v[200:203]
    ds_read_b64_tr_b16 v[76:77], v13 offset:36864
    v_mfma_f32_16x16x32_bf16 v[204:207], v[96:99], v[140:143], v[204:207]
    ds_read_b64_tr_b16 v[78:79], v13 offset:37632
    buffer_load_dwordx4 a[32:35], v3, s[16:19], s88 offen offset:0 sc1
    v_mfma_f32_16x16x32_bf16 v[220:223], v[100:103], v[140:143], v[220:223]
    ds_read_b64_tr_b16 v[80:81], v62 offset:36896
    v_mfma_f32_16x16x32_bf16 v[216:219], v[100:103], v[136:139], v[216:219]
    ds_read_b64_tr_b16 v[82:83], v62 offset:37664
    v_mfma_f32_16x16x32_bf16 v[212:215], v[100:103], v[132:135], v[212:215]
    ds_read_b64_tr_b16 v[84:85], v13 offset:36928
    v_mfma_f32_16x16x32_bf16 v[208:211], v[100:103], v[128:131], v[208:211]
    ds_read_b64_tr_b16 v[86:87], v13 offset:37696
    v_mfma_f32_16x16x32_bf16 v[224:227], v[104:107], v[128:131], v[224:227]
    buffer_load_dwordx4 a[36:39], v3, s[16:19], s88 offen offset:1024 sc1
    v_mfma_f32_16x16x32_bf16 v[228:231], v[104:107], v[132:135], v[228:231]
    v_mfma_f32_16x16x32_bf16 v[232:235], v[104:107], v[136:139], v[232:235]
    v_mfma_f32_16x16x32_bf16 v[236:239], v[104:107], v[140:143], v[236:239]
    v_mfma_f32_16x16x32_bf16 v[252:255], v[108:111], v[140:143], v[252:255]
    buffer_load_dwordx4 a[40:43], v3, s[16:19], s88 offen offset:2048 sc1
    v_mfma_f32_16x16x32_bf16 v[248:251], v[108:111], v[136:139], v[248:251]
    v_mfma_f32_16x16x32_bf16 v[244:247], v[108:111], v[132:135], v[244:247]
    v_mfma_f32_16x16x32_bf16 v[240:243], v[108:111], v[128:131], v[240:243]
    s_waitcnt lgkmcnt(0)
    v_mfma_f32_16x16x32_bf16 v[160:163], v[64:67], v[112:115], v[160:163]
    ds_read_b64_tr_b16 v[88:89], v13 offset:30720
    v_mfma_f32_16x16x32_bf16 v[164:167], v[64:67], v[116:119], v[164:167]
    ds_read_b64_tr_b16 v[90:91], v13 offset:31488
    v_mfma_f32_16x16x32_bf16 v[168:171], v[64:67], v[120:123], v[168:171]
    ds_read_b128 v[128:131], v9 offset:49152
    buffer_load_dwordx4 a[44:47], v3, s[16:19], s88 offen offset:3072 sc1
    v_mfma_f32_16x16x32_bf16 v[172:175], v[64:67], v[124:127], v[172:175]
    ds_read_b128 v[132:135], v9 offset:51200
    v_mfma_f32_16x16x32_bf16 v[188:191], v[68:71], v[124:127], v[188:191]
    ds_read_b128 v[136:139], v9 offset:53248
    v_mfma_f32_16x16x32_bf16 v[184:187], v[68:71], v[120:123], v[184:187]
    ds_read_b128 v[140:143], v9 offset:55296
    v_mfma_f32_16x16x32_bf16 v[180:183], v[68:71], v[116:119], v[180:183]
    ds_read_b64_tr_b16 v[92:93], v62 offset:30752
    buffer_load_dwordx4 a[48:51], v3, s[16:19], s89 offen offset:0 sc1
    v_mfma_f32_16x16x32_bf16 v[176:179], v[68:71], v[112:115], v[176:179]
    ds_read_b64_tr_b16 v[94:95], v62 offset:31520
    v_mfma_f32_16x16x32_bf16 v[192:195], v[72:75], v[112:115], v[192:195]
    ds_read_b64_tr_b16 v[96:97], v13 offset:30784
    v_mfma_f32_16x16x32_bf16 v[196:199], v[72:75], v[116:119], v[196:199]
    ds_read_b64_tr_b16 v[98:99], v13 offset:31552
    v_mfma_f32_16x16x32_bf16 v[200:203], v[72:75], v[120:123], v[200:203]
    ds_read_b64_tr_b16 v[100:101], v13 offset:43008
    v_mfma_f32_16x16x32_bf16 v[204:207], v[72:75], v[124:127], v[204:207]
    ds_read_b64_tr_b16 v[102:103], v13 offset:43776
    buffer_load_dwordx4 a[52:55], v3, s[16:19], s89 offen offset:1024 sc1
    v_mfma_f32_16x16x32_bf16 v[220:223], v[76:79], v[124:127], v[220:223]
    ds_read_b64_tr_b16 v[104:105], v62 offset:43040
    v_mfma_f32_16x16x32_bf16 v[216:219], v[76:79], v[120:123], v[216:219]
    ds_read_b64_tr_b16 v[106:107], v62 offset:43808
    v_mfma_f32_16x16x32_bf16 v[212:215], v[76:79], v[116:119], v[212:215]
    ds_read_b64_tr_b16 v[108:109], v13 offset:43072
    v_mfma_f32_16x16x32_bf16 v[208:211], v[76:79], v[112:115], v[208:211]
    ds_read_b64_tr_b16 v[110:111], v13 offset:43840
    v_mfma_f32_16x16x32_bf16 v[224:227], v[80:83], v[112:115], v[224:227]
    buffer_load_dwordx4 a[56:59], v3, s[16:19], s89 offen offset:2048 sc1
    v_mfma_f32_16x16x32_bf16 v[228:231], v[80:83], v[116:119], v[228:231]
    v_mfma_f32_16x16x32_bf16 v[232:235], v[80:83], v[120:123], v[232:235]
    v_mfma_f32_16x16x32_bf16 v[236:239], v[80:83], v[124:127], v[236:239]
    v_mfma_f32_16x16x32_bf16 v[252:255], v[84:87], v[124:127], v[252:255]
    buffer_load_dwordx4 a[60:63], v3, s[16:19], s89 offen offset:3072 sc1
    v_mfma_f32_16x16x32_bf16 v[248:251], v[84:87], v[120:123], v[248:251]
    v_mfma_f32_16x16x32_bf16 v[244:247], v[84:87], v[116:119], v[244:247]
    v_mfma_f32_16x16x32_bf16 v[240:243], v[84:87], v[112:115], v[240:243]
    s_waitcnt vmcnt(21) lgkmcnt(0)
    s_barrier
    v_mfma_f32_16x16x32_bf16 v[160:163], v[88:91], v[128:131], v[160:163]
    ds_read_b64_tr_b16 v[64:65], v12 offset:24576
    v_mfma_f32_16x16x32_bf16 v[164:167], v[88:91], v[132:135], v[164:167]
    ds_read_b64_tr_b16 v[66:67], v12 offset:25344
    buffer_load_dwordx4 a[64:67], v3, s[16:19], s90 offen offset:0 sc1
    v_mfma_f32_16x16x32_bf16 v[168:171], v[88:91], v[136:139], v[168:171]
    ds_read_b128 v[112:115], v8 offset:16384
    v_mfma_f32_16x16x32_bf16 v[172:175], v[88:91], v[140:143], v[172:175]
    ds_read_b128 v[116:119], v8 offset:18432
    v_mfma_f32_16x16x32_bf16 v[188:191], v[92:95], v[140:143], v[188:191]
    ds_read_b128 v[120:123], v8 offset:20480
    v_mfma_f32_16x16x32_bf16 v[184:187], v[92:95], v[136:139], v[184:187]
    ds_read_b128 v[124:127], v8 offset:22528
    buffer_load_dwordx4 a[68:71], v3, s[16:19], s90 offen offset:1024 sc1
    v_mfma_f32_16x16x32_bf16 v[180:183], v[92:95], v[132:135], v[180:183]
    ds_read_b64_tr_b16 v[68:69], v59 offset:24608
    v_mfma_f32_16x16x32_bf16 v[176:179], v[92:95], v[128:131], v[176:179]
    ds_read_b64_tr_b16 v[70:71], v59 offset:25376
    v_mfma_f32_16x16x32_bf16 v[192:195], v[96:99], v[128:131], v[192:195]
    ds_read_b64_tr_b16 v[72:73], v12 offset:24640
    v_mfma_f32_16x16x32_bf16 v[196:199], v[96:99], v[132:135], v[196:199]
    ds_read_b64_tr_b16 v[74:75], v12 offset:25408
    buffer_load_dwordx4 a[72:75], v3, s[16:19], s90 offen offset:2048 sc1
    v_mfma_f32_16x16x32_bf16 v[200:203], v[96:99], v[136:139], v[200:203]
    ds_read_b64_tr_b16 v[76:77], v12 offset:36864
    v_mfma_f32_16x16x32_bf16 v[204:207], v[96:99], v[140:143], v[204:207]
    ds_read_b64_tr_b16 v[78:79], v12 offset:37632
    v_mfma_f32_16x16x32_bf16 v[220:223], v[100:103], v[140:143], v[220:223]
    ds_read_b64_tr_b16 v[80:81], v59 offset:36896
    v_mfma_f32_16x16x32_bf16 v[216:219], v[100:103], v[136:139], v[216:219]
    ds_read_b64_tr_b16 v[82:83], v59 offset:37664
    buffer_load_dwordx4 a[76:79], v3, s[16:19], s90 offen offset:3072 sc1
    v_mfma_f32_16x16x32_bf16 v[212:215], v[100:103], v[132:135], v[212:215]
    ds_read_b64_tr_b16 v[84:85], v12 offset:36928
    v_mfma_f32_16x16x32_bf16 v[208:211], v[100:103], v[128:131], v[208:211]
    ds_read_b64_tr_b16 v[86:87], v12 offset:37696
    v_mfma_f32_16x16x32_bf16 v[224:227], v[104:107], v[128:131], v[224:227]
    v_mfma_f32_16x16x32_bf16 v[228:231], v[104:107], v[132:135], v[228:231]
    buffer_load_dwordx4 a[80:83], v3, s[16:19], s91 offen offset:0 sc1
    v_mfma_f32_16x16x32_bf16 v[232:235], v[104:107], v[136:139], v[232:235]
    v_mfma_f32_16x16x32_bf16 v[236:239], v[104:107], v[140:143], v[236:239]
    v_mfma_f32_16x16x32_bf16 v[252:255], v[108:111], v[140:143], v[252:255]
    v_mfma_f32_16x16x32_bf16 v[248:251], v[108:111], v[136:139], v[248:251]
    buffer_load_dwordx4 a[84:87], v3, s[16:19], s91 offen offset:1024 sc1
    v_mfma_f32_16x16x32_bf16 v[244:247], v[108:111], v[132:135], v[244:247]
    v_mfma_f32_16x16x32_bf16 v[240:243], v[108:111], v[128:131], v[240:243]
    s_waitcnt lgkmcnt(0)
    v_mfma_f32_16x16x32_bf16 v[160:163], v[64:67], v[112:115], v[160:163]
    ds_read_b64_tr_b16 v[88:89], v12 offset:30720
    v_mfma_f32_16x16x32_bf16 v[164:167], v[64:67], v[116:119], v[164:167]
    ds_read_b64_tr_b16 v[90:91], v12 offset:31488
    buffer_load_dwordx4 a[88:91], v3, s[16:19], s91 offen offset:2048 sc1
    v_mfma_f32_16x16x32_bf16 v[168:171], v[64:67], v[120:123], v[168:171]
    ds_read_b128 v[128:131], v9 offset:16384
    v_mfma_f32_16x16x32_bf16 v[172:175], v[64:67], v[124:127], v[172:175]
    ds_read_b128 v[132:135], v9 offset:18432
    v_mfma_f32_16x16x32_bf16 v[188:191], v[68:71], v[124:127], v[188:191]
    ds_read_b128 v[136:139], v9 offset:20480
    v_mfma_f32_16x16x32_bf16 v[184:187], v[68:71], v[120:123], v[184:187]
    ds_read_b128 v[140:143], v9 offset:22528
    buffer_load_dwordx4 a[92:95], v3, s[16:19], s91 offen offset:3072 sc1
    v_mfma_f32_16x16x32_bf16 v[180:183], v[68:71], v[116:119], v[180:183]
    ds_read_b64_tr_b16 v[92:93], v59 offset:30752
    v_mfma_f32_16x16x32_bf16 v[176:179], v[68:71], v[112:115], v[176:179]
    ds_read_b64_tr_b16 v[94:95], v59 offset:31520
    v_mfma_f32_16x16x32_bf16 v[192:195], v[72:75], v[112:115], v[192:195]
    ds_read_b64_tr_b16 v[96:97], v12 offset:30784
    v_mfma_f32_16x16x32_bf16 v[196:199], v[72:75], v[116:119], v[196:199]
    ds_read_b64_tr_b16 v[98:99], v12 offset:31552
    buffer_load_dwordx4 a[96:99], v3, s[16:19], s92 offen offset:0 sc1
    v_mfma_f32_16x16x32_bf16 v[200:203], v[72:75], v[120:123], v[200:203]
    ds_read_b64_tr_b16 v[100:101], v12 offset:43008
    v_mfma_f32_16x16x32_bf16 v[204:207], v[72:75], v[124:127], v[204:207]
    ds_read_b64_tr_b16 v[102:103], v12 offset:43776
    v_mfma_f32_16x16x32_bf16 v[220:223], v[76:79], v[124:127], v[220:223]
    ds_read_b64_tr_b16 v[104:105], v59 offset:43040
    v_mfma_f32_16x16x32_bf16 v[216:219], v[76:79], v[120:123], v[216:219]
    ds_read_b64_tr_b16 v[106:107], v59 offset:43808
    buffer_load_dwordx4 a[100:103], v3, s[16:19], s92 offen offset:1024 sc1
    v_mfma_f32_16x16x32_bf16 v[212:215], v[76:79], v[116:119], v[212:215]
    ds_read_b64_tr_b16 v[108:109], v12 offset:43072
    v_mfma_f32_16x16x32_bf16 v[208:211], v[76:79], v[112:115], v[208:211]
    ds_read_b64_tr_b16 v[110:111], v12 offset:43840
    v_mfma_f32_16x16x32_bf16 v[224:227], v[80:83], v[112:115], v[224:227]
    v_mfma_f32_16x16x32_bf16 v[228:231], v[80:83], v[116:119], v[228:231]
    buffer_load_dwordx4 a[104:107], v3, s[16:19], s92 offen offset:2048 sc1
    v_mfma_f32_16x16x32_bf16 v[232:235], v[80:83], v[120:123], v[232:235]
    v_mfma_f32_16x16x32_bf16 v[236:239], v[80:83], v[124:127], v[236:239]
    v_mfma_f32_16x16x32_bf16 v[252:255], v[84:87], v[124:127], v[252:255]
    v_mfma_f32_16x16x32_bf16 v[248:251], v[84:87], v[120:123], v[248:251]
    buffer_load_dwordx4 a[108:111], v3, s[16:19], s92 offen offset:3072 sc1
    v_mfma_f32_16x16x32_bf16 v[244:247], v[84:87], v[116:119], v[244:247]
    v_mfma_f32_16x16x32_bf16 v[240:243], v[84:87], v[112:115], v[240:243]
    s_waitcnt vmcnt(23) lgkmcnt(0)
    s_barrier
    v_mfma_f32_16x16x32_bf16 v[160:163], v[88:91], v[128:131], v[160:163]
    ds_read_b64_tr_b16 v[64:65], v12 offset:0
    v_mfma_f32_16x16x32_bf16 v[164:167], v[88:91], v[132:135], v[164:167]
    ds_read_b64_tr_b16 v[66:67], v12 offset:768
    buffer_load_dwordx4 a[112:115], v3, s[16:19], s93 offen offset:0 sc1
    v_mfma_f32_16x16x32_bf16 v[168:171], v[88:91], v[136:139], v[168:171]
    ds_read_b128 v[112:115], v8 offset:0
    v_mfma_f32_16x16x32_bf16 v[172:175], v[88:91], v[140:143], v[172:175]
    ds_read_b128 v[116:119], v8 offset:2048
    v_mfma_f32_16x16x32_bf16 v[188:191], v[92:95], v[140:143], v[188:191]
    ds_read_b128 v[120:123], v8 offset:4096
    v_mfma_f32_16x16x32_bf16 v[184:187], v[92:95], v[136:139], v[184:187]
    ds_read_b128 v[124:127], v8 offset:6144
    buffer_load_dwordx4 a[116:119], v3, s[16:19], s93 offen offset:1024 sc1
    v_mfma_f32_16x16x32_bf16 v[180:183], v[92:95], v[132:135], v[180:183]
    ds_read_b64_tr_b16 v[68:69], v59 offset:32
    v_mfma_f32_16x16x32_bf16 v[176:179], v[92:95], v[128:131], v[176:179]
    ds_read_b64_tr_b16 v[70:71], v59 offset:800
    v_mfma_f32_16x16x32_bf16 v[192:195], v[96:99], v[128:131], v[192:195]
    ds_read_b64_tr_b16 v[72:73], v12 offset:64
    v_mfma_f32_16x16x32_bf16 v[196:199], v[96:99], v[132:135], v[196:199]
    ds_read_b64_tr_b16 v[74:75], v12 offset:832
    buffer_load_dwordx4 a[120:123], v3, s[16:19], s93 offen offset:2048 sc1
    v_mfma_f32_16x16x32_bf16 v[200:203], v[96:99], v[136:139], v[200:203]
    ds_read_b64_tr_b16 v[76:77], v12 offset:12288
    v_mfma_f32_16x16x32_bf16 v[204:207], v[96:99], v[140:143], v[204:207]
    ds_read_b64_tr_b16 v[78:79], v12 offset:13056
    v_mfma_f32_16x16x32_bf16 v[220:223], v[100:103], v[140:143], v[220:223]
    ds_read_b64_tr_b16 v[80:81], v59 offset:12320
    v_mfma_f32_16x16x32_bf16 v[216:219], v[100:103], v[136:139], v[216:219]
    ds_read_b64_tr_b16 v[82:83], v59 offset:13088
    buffer_load_dwordx4 a[124:127], v3, s[16:19], s93 offen offset:3072 sc1
    v_mfma_f32_16x16x32_bf16 v[212:215], v[100:103], v[132:135], v[212:215]
    ds_read_b64_tr_b16 v[84:85], v12 offset:12352
    v_mfma_f32_16x16x32_bf16 v[208:211], v[100:103], v[128:131], v[208:211]
    ds_read_b64_tr_b16 v[86:87], v12 offset:13120
    v_mfma_f32_16x16x32_bf16 v[224:227], v[104:107], v[128:131], v[224:227]
    v_mfma_f32_16x16x32_bf16 v[228:231], v[104:107], v[132:135], v[228:231]
    buffer_load_dwordx4 a[128:131], v3, s[16:19], s94 offen offset:0 sc1
    v_mfma_f32_16x16x32_bf16 v[232:235], v[104:107], v[136:139], v[232:235]
    v_mfma_f32_16x16x32_bf16 v[236:239], v[104:107], v[140:143], v[236:239]
    v_mfma_f32_16x16x32_bf16 v[252:255], v[108:111], v[140:143], v[252:255]
    v_mfma_f32_16x16x32_bf16 v[248:251], v[108:111], v[136:139], v[248:251]
    buffer_load_dwordx4 a[132:135], v3, s[16:19], s94 offen offset:1024 sc1
    v_mfma_f32_16x16x32_bf16 v[244:247], v[108:111], v[132:135], v[244:247]
    v_mfma_f32_16x16x32_bf16 v[240:243], v[108:111], v[128:131], v[240:243]
    s_mov_b32 s60, 0xc0135761
    s_mov_b32 s62, 0xbdd2d3e8
    v_mov_b32 v16, s60
    v_mov_b32 v17, s60
    s_waitcnt lgkmcnt(0)
    v_mfma_f32_16x16x32_bf16 v[160:163], v[64:67], v[112:115], v[160:163]
    ds_read_b64_tr_b16 v[88:89], v12 offset:6144
    ds_read_b64_tr_b16 v[90:91], v12 offset:6912
    v_mfma_f32_16x16x32_bf16 v[164:167], v[64:67], v[116:119], v[164:167]
    ds_read_b128 v[128:131], v9 offset:0
    ds_read_b128 v[132:135], v9 offset:2048
    v_mfma_f32_16x16x32_bf16 v[180:183], v[68:71], v[116:119], v[180:183]
    ds_read_b128 v[136:139], v9 offset:4096
    ds_read_b128 v[140:143], v9 offset:6144
    v_mfma_f32_16x16x32_bf16 v[176:179], v[68:71], v[112:115], v[176:179]
    ds_read_b64_tr_b16 v[92:93], v59 offset:6176
    ds_read_b64_tr_b16 v[94:95], v59 offset:6944
    v_mfma_f32_16x16x32_bf16 v[192:195], v[72:75], v[112:115], v[192:195]
    ds_read_b64_tr_b16 v[96:97], v12 offset:6208
    ds_read_b64_tr_b16 v[98:99], v12 offset:6976
    v_mfma_f32_16x16x32_bf16 v[196:199], v[72:75], v[116:119], v[196:199]
    ds_read_b64_tr_b16 v[100:101], v12 offset:18432
    ds_read_b64_tr_b16 v[102:103], v12 offset:19200
    v_mfma_f32_16x16x32_bf16 v[212:215], v[76:79], v[116:119], v[212:215]
    ds_read_b64_tr_b16 v[104:105], v59 offset:18464
    ds_read_b64_tr_b16 v[106:107], v59 offset:19232
    v_mfma_f32_16x16x32_bf16 v[208:211], v[76:79], v[112:115], v[208:211]
    ds_read_b64_tr_b16 v[108:109], v12 offset:18496
    ds_read_b64_tr_b16 v[110:111], v12 offset:19264
    v_mfma_f32_16x16x32_bf16 v[224:227], v[80:83], v[112:115], v[224:227]
    v_mfma_f32_16x16x32_bf16 v[228:231], v[80:83], v[116:119], v[228:231]
    v_mfma_f32_16x16x32_bf16 v[244:247], v[84:87], v[116:119], v[244:247]
    v_mfma_f32_16x16x32_bf16 v[240:243], v[84:87], v[112:115], v[240:243]
    s_waitcnt lgkmcnt(0)
    v_mfma_f32_16x16x32_bf16 v[160:163], v[88:91], v[128:131], v[160:163]
    buffer_load_dwordx4 a[136:139], v3, s[16:19], s94 offen offset:2048 sc1
    v_mfma_f32_16x16x32_bf16 v[164:167], v[88:91], v[132:135], v[164:167]
    buffer_load_dwordx4 a[140:143], v3, s[16:19], s94 offen offset:3072 sc1
    v_mfma_f32_16x16x32_bf16 v[208:211], v[100:103], v[128:131], v[208:211]
    buffer_load_dwordx4 a[144:147], v3, s[16:19], s95 offen offset:0 sc1
    v_mfma_f32_16x16x32_bf16 v[212:215], v[100:103], v[132:135], v[212:215]
    buffer_load_dwordx4 a[148:151], v3, s[16:19], s95 offen offset:1024 sc1
    v_mfma_f32_16x16x32_bf16 v[176:179], v[92:95], v[128:131], v[176:179]
    buffer_load_dwordx4 a[152:155], v3, s[16:19], s95 offen offset:2048 sc1
    v_mfma_f32_16x16x32_bf16 v[180:183], v[92:95], v[132:135], v[180:183]
    buffer_load_dwordx4 a[156:159], v3, s[16:19], s95 offen offset:3072 sc1
    v_mfma_f32_16x16x32_bf16 v[224:227], v[104:107], v[128:131], v[224:227]
    v_mfma_f32_16x16x32_bf16 v[228:231], v[104:107], v[132:135], v[228:231]
    v_mfma_f32_16x16x32_bf16 v[192:195], v[96:99], v[128:131], v[192:195]
    v_mfma_f32_16x16x32_bf16 v[196:199], v[96:99], v[132:135], v[196:199]
    v_mfma_f32_16x16x32_bf16 v[240:243], v[108:111], v[128:131], v[240:243]
    v_mfma_f32_16x16x32_bf16 v[244:247], v[108:111], v[132:135], v[244:247]
    v_mfma_f32_16x16x32_bf16 v[168:171], v[64:67], v[120:123], v[168:171]
    v_mul_f32 v20, v160, v160
    v_mul_f32 v21, v161, v161
    v_mfma_f32_16x16x32_bf16 v[172:175], v[64:67], v[124:127], v[172:175]
    v_mul_f32 v22, v162, v162
    v_mul_f32 v23, v163, v163
    v_mfma_f32_16x16x32_bf16 v[188:191], v[68:71], v[124:127], v[188:191]
    v_mul_f32 v24, v164, v164
    v_mul_f32 v25, v165, v165
    v_mfma_f32_16x16x32_bf16 v[184:187], v[68:71], v[120:123], v[184:187]
    v_mul_f32 v26, v166, v166
    v_mul_f32 v27, v167, v167
    v_mfma_f32_16x16x32_bf16 v[200:203], v[72:75], v[120:123], v[200:203]
    v_fma_f32 v20, v20, s62, v16
    v_fma_f32 v21, v21, s62, v16
    v_mfma_f32_16x16x32_bf16 v[204:207], v[72:75], v[124:127], v[204:207]
    v_fma_f32 v22, v22, s62, v16
    v_fma_f32 v23, v23, s62, v16
    v_mfma_f32_16x16x32_bf16 v[220:223], v[76:79], v[124:127], v[220:223]
    v_fma_f32 v24, v24, s62, v16
    v_fma_f32 v25, v25, s62, v16
    v_mfma_f32_16x16x32_bf16 v[216:219], v[76:79], v[120:123], v[216:219]
    v_fma_f32 v26, v26, s62, v16
    v_fma_f32 v27, v27, s62, v16
    v_mfma_f32_16x16x32_bf16 v[232:235], v[80:83], v[120:123], v[232:235]
    v_mul_f32 v20, v20, v160
    v_mul_f32 v21, v21, v161
    v_mfma_f32_16x16x32_bf16 v[236:239], v[80:83], v[124:127], v[236:239]
    v_mul_f32 v22, v22, v162
    v_mul_f32 v23, v23, v163
    v_mfma_f32_16x16x32_bf16 v[252:255], v[84:87], v[124:127], v[252:255]
    v_mul_f32 v24, v24, v164
    v_mul_f32 v25, v25, v165
    v_mfma_f32_16x16x32_bf16 v[248:251], v[84:87], v[120:123], v[248:251]
    v_mul_f32 v26, v26, v166
    v_mul_f32 v27, v27, v167
    v_mfma_f32_16x16x32_bf16 v[168:171], v[88:91], v[136:139], v[168:171]
    v_exp_f32 v20, v20
    v_mfma_f32_16x16x32_bf16 v[172:175], v[88:91], v[140:143], v[172:175]
    v_exp_f32 v21, v21
    v_mfma_f32_16x16x32_bf16 v[188:191], v[92:95], v[140:143], v[188:191]
    v_exp_f32 v22, v22
    v_mfma_f32_16x16x32_bf16 v[184:187], v[92:95], v[136:139], v[184:187]
    v_exp_f32 v23, v23
    v_mfma_f32_16x16x32_bf16 v[200:203], v[96:99], v[136:139], v[200:203]
    v_exp_f32 v24, v24
    v_mfma_f32_16x16x32_bf16 v[204:207], v[96:99], v[140:143], v[204:207]
    v_exp_f32 v25, v25
    v_mfma_f32_16x16x32_bf16 v[220:223], v[100:103], v[140:143], v[220:223]
    v_exp_f32 v26, v26
    v_mfma_f32_16x16x32_bf16 v[216:219], v[100:103], v[136:139], v[216:219]
    v_exp_f32 v27, v27
    v_mfma_f32_16x16x32_bf16 v[232:235], v[104:107], v[136:139], v[232:235]
    v_mul_f32 v160, v160, v208
    v_mul_f32 v161, v161, v209
    v_mfma_f32_16x16x32_bf16 v[236:239], v[104:107], v[140:143], v[236:239]
    v_mul_f32 v162, v162, v210
    v_mul_f32 v163, v163, v211
    v_mfma_f32_16x16x32_bf16 v[252:255], v[108:111], v[140:143], v[252:255]
    v_mul_f32 v164, v164, v212
    v_mul_f32 v165, v165, v213
    v_mfma_f32_16x16x32_bf16 v[248:251], v[108:111], v[136:139], v[248:251]
    v_mul_f32 v166, v166, v214
    v_mul_f32 v167, v167, v215
K_depi:
    v_add_f32 v20, 1.0, v20
    v_add_f32 v21, 1.0, v21
    v_add_f32 v22, 1.0, v22
    v_add_f32 v23, 1.0, v23
    v_add_f32 v24, 1.0, v24
    v_add_f32 v25, 1.0, v25
    v_add_f32 v26, 1.0, v26
    v_add_f32 v27, 1.0, v27
    v_rcp_f32 v20, v20
    v_rcp_f32 v21, v21
    v_rcp_f32 v22, v22
    v_rcp_f32 v23, v23
    buffer_load_dwordx4 a[160:163], v3, s[16:19], s96 offen offset:0 sc1
    v_rcp_f32 v24, v24
    v_rcp_f32 v25, v25
    v_rcp_f32 v26, v26
    v_rcp_f32 v27, v27
    v_pk_mul_f32 v[20:21], v[20:21], v[160:161]
    v_pk_mul_f32 v[22:23], v[22:23], v[162:163]
    v_pk_mul_f32 v[24:25], v[24:25], v[164:165]
    v_pk_mul_f32 v[26:27], v[26:27], v[166:167]
    v_cvt_pk_bf16_f32 v28, v20, v21
    v_cvt_pk_bf16_f32 v30, v24, v25
    v_cvt_pk_bf16_f32 v29, v22, v23
    v_cvt_pk_bf16_f32 v31, v26, v27
    v_permlane16_swap_b32 v28, v30
    s_nop 0
    v_permlane16_swap_b32 v29, v31
    buffer_store_dwordx4 v[28:31], v14, s[16:19], s56 offen offset:0 sc1
    v_pk_mul_f32 v[32:33], v[176:177], v[176:177]
    v_pk_mul_f32 v[34:35], v[178:179], v[178:179]
    v_pk_mul_f32 v[36:37], v[180:181], v[180:181]
    v_pk_mul_f32 v[38:39], v[182:183], v[182:183]
    v_pk_fma_f32 v[32:33], v[32:33], s[62:63], v[16:17] op_sel_hi:[1,0,1]
    v_pk_fma_f32 v[34:35], v[34:35], s[62:63], v[16:17] op_sel_hi:[1,0,1]
    v_pk_fma_f32 v[36:37], v[36:37], s[62:63], v[16:17] op_sel_hi:[1,0,1]
    v_pk_fma_f32 v[38:39], v[38:39], s[62:63], v[16:17] op_sel_hi:[1,0,1]
    v_pk_mul_f32 v[32:33], v[32:33], v[176:177]
    v_pk_mul_f32 v[34:35], v[34:35], v[178:179]
    v_pk_mul_f32 v[36:37], v[36:37], v[180:181]
    v_pk_mul_f32 v[38:39], v[38:39], v[182:183]
    v_exp_f32 v32, v32
    v_exp_f32 v33, v33
    buffer_load_dwordx4 a[164:167], v3, s[16:19], s96 offen offset:1024 sc1
    v_exp_f32 v34, v34
    v_exp_f32 v35, v35
    v_exp_f32 v36, v36
    v_exp_f32 v37, v37
    v_exp_f32 v38, v38
    buffer_load_dwordx4 a[168:171], v3, s[16:19], s96 offen offset:2048 sc1
    v_exp_f32 v39, v39
    v_pk_mul_f32 v[176:177], v[176:177], v[224:225]
    v_pk_mul_f32 v[178:179], v[178:179], v[226:227]
    v_pk_mul_f32 v[180:181], v[180:181], v[228:229]
    v_pk_mul_f32 v[182:183], v[182:183], v[230:231]
    v_pk_add_f32 v[32:33], v[32:33], 1.0 op_sel_hi:[1,0]
    v_pk_add_f32 v[34:35], v[34:35], 1.0 op_sel_hi:[1,0]
    v_pk_add_f32 v[36:37], v[36:37], 1.0 op_sel_hi:[1,0]
    v_pk_add_f32 v[38:39], v[38:39], 1.0 op_sel_hi:[1,0]
    v_rcp_f32 v32, v32
    v_rcp_f32 v33, v33
    v_rcp_f32 v34, v34
    v_rcp_f32 v35, v35
    buffer_load_dwordx4 a[172:175], v3, s[16:19], s96 offen offset:3072 sc1
    v_rcp_f32 v36, v36
    v_rcp_f32 v37, v37
    v_rcp_f32 v38, v38
    v_rcp_f32 v39, v39
    v_pk_mul_f32 v[32:33], v[32:33], v[176:177]
    v_pk_mul_f32 v[34:35], v[34:35], v[178:179]
    v_pk_mul_f32 v[36:37], v[36:37], v[180:181]
    v_pk_mul_f32 v[38:39], v[38:39], v[182:183]
    v_cvt_pk_bf16_f32 v40, v32, v33
    v_cvt_pk_bf16_f32 v42, v36, v37
    v_cvt_pk_bf16_f32 v41, v34, v35
    v_cvt_pk_bf16_f32 v43, v38, v39
    v_permlane16_swap_b32 v40, v42
    s_nop 0
    v_permlane16_swap_b32 v41, v43
    buffer_store_dwordx4 v[40:43], v14, s[16:19], s56 offen offset:512 sc1
    v_pk_mul_f32 v[20:21], v[192:193], v[192:193]
    v_pk_mul_f32 v[22:23], v[194:195], v[194:195]
    v_pk_mul_f32 v[24:25], v[196:197], v[196:197]
    v_pk_mul_f32 v[26:27], v[198:199], v[198:199]
    v_pk_fma_f32 v[20:21], v[20:21], s[62:63], v[16:17] op_sel_hi:[1,0,1]
    v_pk_fma_f32 v[22:23], v[22:23], s[62:63], v[16:17] op_sel_hi:[1,0,1]
    v_pk_fma_f32 v[24:25], v[24:25], s[62:63], v[16:17] op_sel_hi:[1,0,1]
    v_pk_fma_f32 v[26:27], v[26:27], s[62:63], v[16:17] op_sel_hi:[1,0,1]
    v_pk_mul_f32 v[20:21], v[20:21], v[192:193]
    v_pk_mul_f32 v[22:23], v[22:23], v[194:195]
    v_pk_mul_f32 v[24:25], v[24:25], v[196:197]
    v_pk_mul_f32 v[26:27], v[26:27], v[198:199]
    v_exp_f32 v20, v20
    v_exp_f32 v21, v21
    buffer_load_dwordx4 a[176:179], v3, s[16:19], s97 offen offset:0 sc1
    v_exp_f32 v22, v22
    v_exp_f32 v23, v23
    v_exp_f32 v24, v24
    v_exp_f32 v25, v25
    v_exp_f32 v26, v26
    buffer_load_dwordx4 a[180:183], v3, s[16:19], s97 offen offset:1024 sc1
    v_exp_f32 v27, v27
    v_pk_mul_f32 v[192:193], v[192:193], v[240:241]
    v_pk_mul_f32 v[194:195], v[194:195], v[242:243]
    v_pk_mul_f32 v[196:197], v[196:197], v[244:245]
    v_pk_mul_f32 v[198:199], v[198:199], v[246:247]
    v_pk_add_f32 v[20:21], v[20:21], 1.0 op_sel_hi:[1,0]
    v_pk_add_f32 v[22:23], v[22:23], 1.0 op_sel_hi:[1,0]
    v_pk_add_f32 v[24:25], v[24:25], 1.0 op_sel_hi:[1,0]
    v_pk_add_f32 v[26:27], v[26:27], 1.0 op_sel_hi:[1,0]
    v_rcp_f32 v20, v20
    v_rcp_f32 v21, v21
    v_rcp_f32 v22, v22
    v_rcp_f32 v23, v23
    v_rcp_f32 v24, v24
    v_rcp_f32 v25, v25
    v_rcp_f32 v26, v26
    v_rcp_f32 v27, v27
    v_pk_mul_f32 v[20:21], v[20:21], v[192:193]
    v_pk_mul_f32 v[22:23], v[22:23], v[194:195]
    v_pk_mul_f32 v[24:25], v[24:25], v[196:197]
    v_pk_mul_f32 v[26:27], v[26:27], v[198:199]
    v_cvt_pk_bf16_f32 v28, v20, v21
    v_cvt_pk_bf16_f32 v30, v24, v25
    v_cvt_pk_bf16_f32 v29, v22, v23
    v_cvt_pk_bf16_f32 v31, v26, v27
    v_permlane16_swap_b32 v28, v30
    s_nop 0
    v_permlane16_swap_b32 v29, v31
    buffer_store_dwordx4 v[28:31], v14, s[16:19], s56 offen offset:1024 sc1
    v_pk_mul_f32 v[32:33], v[168:169], v[168:169]
    v_pk_mul_f32 v[34:35], v[170:171], v[170:171]
    v_pk_mul_f32 v[36:37], v[172:173], v[172:173]
    v_pk_mul_f32 v[38:39], v[174:175], v[174:175]
    v_pk_fma_f32 v[32:33], v[32:33], s[62:63], v[16:17] op_sel_hi:[1,0,1]
    v_pk_fma_f32 v[34:35], v[34:35], s[62:63], v[16:17] op_sel_hi:[1,0,1]
    v_pk_fma_f32 v[36:37], v[36:37], s[62:63], v[16:17] op_sel_hi:[1,0,1]
    v_pk_fma_f32 v[38:39], v[38:39], s[62:63], v[16:17] op_sel_hi:[1,0,1]
    v_pk_mul_f32 v[32:33], v[32:33], v[168:169]
    v_pk_mul_f32 v[34:35], v[34:35], v[170:171]
    v_pk_mul_f32 v[36:37], v[36:37], v[172:173]
    v_pk_mul_f32 v[38:39], v[38:39], v[174:175]
    v_exp_f32 v32, v32
    v_exp_f32 v33, v33
    v_exp_f32 v34, v34
    v_exp_f32 v35, v35
    v_exp_f32 v36, v36
    v_exp_f32 v37, v37
    v_exp_f32 v38, v38
    v_exp_f32 v39, v39
    v_pk_mul_f32 v[168:169], v[168:169], v[216:217]
    v_pk_mul_f32 v[170:171], v[170:171], v[218:219]
    v_pk_mul_f32 v[172:173], v[172:173], v[220:221]
    v_pk_mul_f32 v[174:175], v[174:175], v[222:223]
    v_pk_add_f32 v[32:33], v[32:33], 1.0 op_sel_hi:[1,0]
    v_pk_add_f32 v[34:35], v[34:35], 1.0 op_sel_hi:[1,0]
    v_pk_add_f32 v[36:37], v[36:37], 1.0 op_sel_hi:[1,0]
    v_pk_add_f32 v[38:39], v[38:39], 1.0 op_sel_hi:[1,0]
    v_rcp_f32 v32, v32
    v_rcp_f32 v33, v33
    v_rcp_f32 v34, v34
    v_rcp_f32 v35, v35
    v_rcp_f32 v36, v36
    v_rcp_f32 v37, v37
    v_rcp_f32 v38, v38
    v_rcp_f32 v39, v39
    v_pk_mul_f32 v[32:33], v[32:33], v[168:169]
    v_pk_mul_f32 v[34:35], v[34:35], v[170:171]
    v_pk_mul_f32 v[36:37], v[36:37], v[172:173]
    v_pk_mul_f32 v[38:39], v[38:39], v[174:175]
    v_cvt_pk_bf16_f32 v40, v32, v33
    v_cvt_pk_bf16_f32 v42, v36, v37
    v_cvt_pk_bf16_f32 v41, v34, v35
    v_cvt_pk_bf16_f32 v43, v38, v39
    v_permlane16_swap_b32 v40, v42
    s_nop 0
    v_permlane16_swap_b32 v41, v43
    buffer_store_dwordx4 v[40:43], v14, s[16:19], s57 offen offset:0 sc1
    v_pk_mul_f32 v[20:21], v[184:185], v[184:185]
    v_pk_mul_f32 v[22:23], v[186:187], v[186:187]
    v_pk_mul_f32 v[24:25], v[188:189], v[188:189]
    v_pk_mul_f32 v[26:27], v[190:191], v[190:191]
    v_pk_fma_f32 v[20:21], v[20:21], s[62:63], v[16:17] op_sel_hi:[1,0,1]
    v_pk_fma_f32 v[22:23], v[22:23], s[62:63], v[16:17] op_sel_hi:[1,0,1]
    v_pk_fma_f32 v[24:25], v[24:25], s[62:63], v[16:17] op_sel_hi:[1,0,1]
    v_pk_fma_f32 v[26:27], v[26:27], s[62:63], v[16:17] op_sel_hi:[1,0,1]
    v_pk_mul_f32 v[20:21], v[20:21], v[184:185]
    v_pk_mul_f32 v[22:23], v[22:23], v[186:187]
    v_pk_mul_f32 v[24:25], v[24:25], v[188:189]
    v_pk_mul_f32 v[26:27], v[26:27], v[190:191]
    v_exp_f32 v20, v20
    v_exp_f32 v21, v21
    v_exp_f32 v22, v22
    v_exp_f32 v23, v23
    v_exp_f32 v24, v24
    v_exp_f32 v25, v25
    v_exp_f32 v26, v26
    v_exp_f32 v27, v27
    v_pk_mul_f32 v[184:185], v[184:185], v[232:233]
    v_pk_mul_f32 v[186:187], v[186:187], v[234:235]
    v_pk_mul_f32 v[188:189], v[188:189], v[236:237]
    v_pk_mul_f32 v[190:191], v[190:191], v[238:239]
    v_pk_add_f32 v[20:21], v[20:21], 1.0 op_sel_hi:[1,0]
    v_pk_add_f32 v[22:23], v[22:23], 1.0 op_sel_hi:[1,0]
    v_pk_add_f32 v[24:25], v[24:25], 1.0 op_sel_hi:[1,0]
    v_pk_add_f32 v[26:27], v[26:27], 1.0 op_sel_hi:[1,0]
    v_rcp_f32 v20, v20
    v_rcp_f32 v21, v21
    v_rcp_f32 v22, v22
    v_rcp_f32 v23, v23
    v_rcp_f32 v24, v24
    v_rcp_f32 v25, v25
    v_rcp_f32 v26, v26
    v_rcp_f32 v27, v27
    v_pk_mul_f32 v[20:21], v[20:21], v[184:185]
    v_pk_mul_f32 v[22:23], v[22:23], v[186:187]
    v_pk_mul_f32 v[24:25], v[24:25], v[188:189]
    v_pk_mul_f32 v[26:27], v[26:27], v[190:191]
    v_cvt_pk_bf16_f32 v28, v20, v21
    v_cvt_pk_bf16_f32 v30, v24, v25
    v_cvt_pk_bf16_f32 v29, v22, v23
    v_cvt_pk_bf16_f32 v31, v26, v27
    v_permlane16_swap_b32 v28, v30
    s_nop 0
    v_permlane16_swap_b32 v29, v31
    buffer_store_dwordx4 v[28:31], v14, s[16:19], s57 offen offset:512 sc1
    v_pk_mul_f32 v[32:33], v[200:201], v[200:201]
    v_pk_mul_f32 v[34:35], v[202:203], v[202:203]
    v_pk_mul_f32 v[36:37], v[204:205], v[204:205]
    v_pk_mul_f32 v[38:39], v[206:207], v[206:207]
    v_pk_fma_f32 v[32:33], v[32:33], s[62:63], v[16:17] op_sel_hi:[1,0,1]
    v_pk_fma_f32 v[34:35], v[34:35], s[62:63], v[16:17] op_sel_hi:[1,0,1]
    v_pk_fma_f32 v[36:37], v[36:37], s[62:63], v[16:17] op_sel_hi:[1,0,1]
    v_pk_fma_f32 v[38:39], v[38:39], s[62:63], v[16:17] op_sel_hi:[1,0,1]
    v_pk_mul_f32 v[32:33], v[32:33], v[200:201]
    v_pk_mul_f32 v[34:35], v[34:35], v[202:203]
    v_pk_mul_f32 v[36:37], v[36:37], v[204:205]
    v_pk_mul_f32 v[38:39], v[38:39], v[206:207]
    v_exp_f32 v32, v32
    v_exp_f32 v33, v33
    v_exp_f32 v34, v34
    v_exp_f32 v35, v35
    v_exp_f32 v36, v36
    v_exp_f32 v37, v37
    v_exp_f32 v38, v38
    v_exp_f32 v39, v39
    v_pk_mul_f32 v[200:201], v[200:201], v[248:249]
    v_pk_mul_f32 v[202:203], v[202:203], v[250:251]
    v_pk_mul_f32 v[204:205], v[204:205], v[252:253]
    v_pk_mul_f32 v[206:207], v[206:207], v[254:255]
    v_pk_add_f32 v[32:33], v[32:33], 1.0 op_sel_hi:[1,0]
    v_pk_add_f32 v[34:35], v[34:35], 1.0 op_sel_hi:[1,0]
    v_pk_add_f32 v[36:37], v[36:37], 1.0 op_sel_hi:[1,0]
    v_pk_add_f32 v[38:39], v[38:39], 1.0 op_sel_hi:[1,0]
    v_rcp_f32 v32, v32
    v_rcp_f32 v33, v33
    v_rcp_f32 v34, v34
    v_rcp_f32 v35, v35
    v_rcp_f32 v36, v36
    v_rcp_f32 v37, v37
    v_rcp_f32 v38, v38
    v_rcp_f32 v39, v39
    v_pk_mul_f32 v[32:33], v[32:33], v[200:201]
    v_pk_mul_f32 v[34:35], v[34:35], v[202:203]
    v_pk_mul_f32 v[36:37], v[36:37], v[204:205]
    v_pk_mul_f32 v[38:39], v[38:39], v[206:207]
    v_cvt_pk_bf16_f32 v40, v32, v33
    v_cvt_pk_bf16_f32 v42, v36, v37
    v_cvt_pk_bf16_f32 v41, v34, v35
    v_cvt_pk_bf16_f32 v43, v38, v39
    v_permlane16_swap_b32 v40, v42
    s_nop 0
    v_permlane16_swap_b32 v41, v43
    buffer_store_dwordx4 v[40:43], v14, s[16:19], s57 offen offset:1024 sc1
    s_lshl_b32 s40, s24, 12
    s_add_u32 s40, s40, 3342336
    v_mov_b32 v60, 1
    v_lshlrev_b32 v61, 8, v2
    s_lshl_b32 s41, s25, 8
    s_add_u32 s41, s41, s40
    s_add_u32 s0, s16, s41
    s_addc_u32 s1, s17, 0
    s_mov_b32 s42, s40
    buffer_load_dwordx4 a[184:187], v3, s[16:19], s97 offen offset:2048 sc1
    buffer_load_dwordx4 a[188:191], v3, s[16:19], s97 offen offset:3072 sc1
    buffer_load_dwordx4 a[192:195], v3, s[16:19], s98 offen offset:0 sc1
    buffer_load_dwordx4 a[196:199], v3, s[16:19], s98 offen offset:1024 sc1
    buffer_load_dwordx4 a[200:203], v3, s[16:19], s98 offen offset:2048 sc1
    buffer_load_dwordx4 a[204:207], v3, s[16:19], s98 offen offset:3072 sc1
    s_mul_i32 s44, s22, 196608
    s_mul_i32 s45, s3, 12288
    s_add_u32 s44, s44, s45
    s_add_u32 s44, s44, 16777216
    s_add_u32 s45, s3, 1
    s_and_b32 s45, s45, 3
    s_mul_i32 s46, s45, 49152
    s_add_u32 s28, s46, s44
    s_add_u32 s29, s28, 4096
    s_add_u32 s30, s28, 8192
    s_mul_i32 s48, s45, 15360
    s_add_u32 s45, s3, 2
    s_and_b32 s45, s45, 3
    s_mul_i32 s46, s45, 49152
    s_add_u32 s31, s46, s44
    s_add_u32 s32, s31, 4096
    s_add_u32 s33, s31, 8192
    s_mul_i32 s49, s45, 15360
    s_add_u32 s45, s3, 3
    s_and_b32 s45, s45, 3
    s_mul_i32 s46, s45, 49152
    s_add_u32 s34, s46, s44
    s_add_u32 s35, s34, 4096
    s_add_u32 s36, s34, 8192
    s_mul_i32 s50, s45, 15360
    s_add_u32 s45, s3, 4
    s_and_b32 s45, s45, 3
    s_mul_i32 s46, s45, 49152
    s_add_u32 s37, s46, s44
    s_add_u32 s38, s37, 4096
    s_add_u32 s39, s37, 8192
    s_mul_i32 s46, s23, 160
    s_lshl_b32 s47, s22, 6
    s_lshl_b32 s45, s3, 4
    s_add_u32 s47, s47, s45
    s_mul_i32 s47, s47, 1280
    s_add_u32 s47, s47, s46
    s_add_u32 s47, s47, 12582912
    s_lshl_b32 s45, s3, 3
    v_add_u32 v6, 0, v2
    v_mul_u32_u24 v7, 6554, v6
    v_lshrrev_b32 v7, 16, v7
    v_mul_u32_u24 v8, 10, v7
    v_sub_u32 v8, v6, v8
    v_lshlrev_b32 v8, 4, v8
    v_mul_u32_u24 v9, 1280, v7
    v_add_u32 v87, v9, v8
    v_lshrrev_b32 v6, 1, v7
    v_add_u32 v6, s45, v6
    v_and_b32 v6, 31, v6
    v_and_b32 v7, 1, v7
    v_lshlrev_b32 v9, 6, v6
    s_cmp_eq_u32 s22, 0
    s_cselect_b32 s40, 0xfffffc20, s22
    v_mov_b32 v10, s22
    v_cmp_le_u32 vcc, 16, v6
    s_nop 0
    v_mov_b32 v11, s40
    v_cndmask_b32 v10, v10, v11, vcc
    v_add_u32 v9, v9, v10
    v_sub_u32 v10, 2048, v9
    v_cmp_eq_u32 vcc, 0, v9
    v_mov_b32 v11, 1024
    s_nop 0
    v_cndmask_b32 v10, v10, v11, vcc
    v_cmp_eq_u32 vcc, 1, v7
    s_nop 1
    v_cndmask_b32 v9, v9, v10, vcc
    v_mul_u32_u24 v9, 1280, v9
    v_add_u32 v90, v9, v8
    v_add_u32 v6, 64, v2
    v_mul_u32_u24 v7, 6554, v6
    v_lshrrev_b32 v7, 16, v7
    v_mul_u32_u24 v8, 10, v7
    v_sub_u32 v8, v6, v8
    v_lshlrev_b32 v8, 4, v8
    v_mul_u32_u24 v9, 1280, v7
    v_add_u32 v88, v9, v8
    v_lshrrev_b32 v6, 1, v7
    v_add_u32 v6, s45, v6
    v_and_b32 v6, 31, v6
    v_and_b32 v7, 1, v7
    v_lshlrev_b32 v9, 6, v6
    s_cmp_eq_u32 s22, 0
    s_cselect_b32 s40, 0xfffffc20, s22
    v_mov_b32 v10, s22
    v_cmp_le_u32 vcc, 16, v6
    s_nop 0
    v_mov_b32 v11, s40
    v_cndmask_b32 v10, v10, v11, vcc
    v_add_u32 v9, v9, v10
    v_sub_u32 v10, 2048, v9
    v_cmp_eq_u32 vcc, 0, v9
    v_mov_b32 v11, 1024
    s_nop 0
    v_cndmask_b32 v10, v10, v11, vcc
    v_cmp_eq_u32 vcc, 1, v7
    s_nop 1
    v_cndmask_b32 v9, v9, v10, vcc
    v_mul_u32_u24 v9, 1280, v9
    v_add_u32 v91, v9, v8
    v_add_u32 v6, 128, v2
    v_mul_u32_u24 v7, 6554, v6
    v_lshrrev_b32 v7, 16, v7
    v_mul_u32_u24 v8, 10, v7
    v_sub_u32 v8, v6, v8
    v_lshlrev_b32 v8, 4, v8
    v_mul_u32_u24 v9, 1280, v7
    v_add_u32 v89, v9, v8
    v_lshrrev_b32 v6, 1, v7
    v_add_u32 v6, s45, v6
    v_and_b32 v6, 31, v6
    v_and_b32 v7, 1, v7
    v_lshlrev_b32 v9, 6, v6
    s_cmp_eq_u32 s22, 0
    s_cselect_b32 s40, 0xfffffc20, s22
    v_mov_b32 v10, s22
    v_cmp_le_u32 vcc, 16, v6
    s_nop 0
    v_mov_b32 v11, s40
    v_cndmask_b32 v10, v10, v11, vcc
    v_add_u32 v9, v9, v10
    v_sub_u32 v10, 2048, v9
    v_cmp_eq_u32 vcc, 0, v9
    v_mov_b32 v11, 1024
    s_nop 0
    v_cndmask_b32 v10, v10, v11, vcc
    v_cmp_eq_u32 vcc, 1, v7
    s_nop 1
    v_cndmask_b32 v9, v9, v10, vcc
    v_mul_u32_u24 v9, 1280, v9
    v_add_u32 v92, v9, v8
    s_mul_i32 s53, s3, 6144
    s_add_u32 s53, s53, 61440
    v_mul_u32_u24 v8, 160, v4
    v_lshl_add_u32 v8, v5, 3, v8
    v_add_u32 v8, s53, v8
    v_add_u32 v9, s53, v3
    s_mul_i32 s51, s23, 320
    s_add_u32 s51, s51, 2642432
    v_lshlrev_b32 v10, 4, v5
    buffer_load_dwordx4 v[66:69], v10, s[16:19], s51 offen offset:0 sc1
    buffer_load_dwordx4 v[70:73], v10, s[16:19], s51 offen offset:64 sc1
    buffer_load_dwordx4 v[74:77], v10, s[16:19], s51 offen offset:128 sc1
    buffer_load_dwordx4 v[78:81], v10, s[16:19], s51 offen offset:192 sc1
    buffer_load_dwordx4 v[82:85], v10, s[16:19], s51 offen offset:256 sc1
    v_add_u32 v11, s48, v3
    v_add_u32 v12, s49, v3
    v_add_u32 v13, s50, v3
    s_mul_i32 s45, s3, 15360
    v_add_u32 v14, s45, v3
    s_mul_i32 s52, s22, 196608
    s_mul_i32 s45, s23, 24576
    s_add_u32 s52, s52, s45
    s_mul_i32 s45, s3, 6144
    s_add_u32 s52, s52, s45
    s_add_u32 s52, s52, 16777216
    v_lshlrev_b32 v15, 7, v2
    s_waitcnt vmcnt(11)
    s_barrier
    s_cmp_lg_u32 s3, 0
    s_cbranch_scc1 K_sa1
    s_mov_b64 exec, 0xffff
    buffer_atomic_add v60, v61, s[16:19], s42 offen sc1
    s_mov_b64 exec, -1
K_sa1:
    buffer_load_dwordx4 a[208:211], v3, s[16:19], s99 offen offset:0 sc1
    buffer_load_dwordx4 a[212:215], v3, s[16:19], s99 offen offset:1024 sc1
    buffer_load_dwordx4 a[216:219], v3, s[16:19], s99 offen offset:2048 sc1
    buffer_load_dwordx4 a[220:223], v3, s[16:19], s99 offen offset:3072 sc1
    buffer_load_dwordx4 a[224:227], v3, s[16:19], s100 offen offset:0 sc1
    buffer_load_dwordx4 a[228:231], v3, s[16:19], s100 offen offset:1024 sc1
    buffer_load_dwordx4 a[232:235], v3, s[16:19], s100 offen offset:2048 sc1
    buffer_load_dwordx4 a[236:239], v3, s[16:19], s100 offen offset:3072 sc1
    s_cmp_lg_u32 s3, 0
    s_cbranch_scc1 K_sb1
    s_mov_b32 s41, 0
K_poll1:
    s_load_dword s40, s[0:1], 0 glc
    s_add_u32 s41, s41, 1
    s_cmp_gt_u32 s41, 0x40000
    s_cbranch_scc1 K_to1
    s_waitcnt lgkmcnt(0)
    s_cmp_lg_u32 s40, 16
    s_cbranch_scc1 K_poll1
K_to1:
    s_waitcnt lgkmcnt(0)
K_sb1:
    s_barrier
K_rel1:
    buffer_load_dwordx4 v[96:99], v3, s[16:19], s28 offen offset:0 sc1
    buffer_load_dwordx4 v[100:103], v3, s[16:19], s28 offen offset:1024 sc1
    buffer_load_dwordx4 v[104:107], v3, s[16:19], s28 offen offset:2048 sc1
    buffer_load_dwordx4 v[108:111], v3, s[16:19], s28 offen offset:3072 sc1
    buffer_load_dwordx4 v[112:115], v3, s[16:19], s29 offen offset:0 sc1
    buffer_load_dwordx4 v[116:119], v3, s[16:19], s29 offen offset:1024 sc1
    buffer_load_dwordx4 v[120:123], v3, s[16:19], s29 offen offset:2048 sc1
    buffer_load_dwordx4 v[124:127], v3, s[16:19], s29 offen offset:3072 sc1
    buffer_load_dwordx4 v[128:131], v3, s[16:19], s30 offen offset:0 sc1
    buffer_load_dwordx4 v[132:135], v3, s[16:19], s30 offen offset:1024 sc1
    s_waitcnt vmcnt(9)
    v_mfma_f32_16x16x32_bf16 v[16:19], a[0:3], v[96:99], 0
    buffer_load_dwordx4 v[136:139], v3, s[16:19], s30 offen offset:2048 sc1
    v_mfma_f32_16x16x32_bf16 v[20:23], a[4:7], v[96:99], 0
    v_mfma_f32_16x16x32_bf16 v[24:27], a[8:11], v[96:99], 0
    v_mfma_f32_16x16x32_bf16 v[28:31], a[12:15], v[96:99], 0
    v_mfma_f32_16x16x32_bf16 v[32:35], a[16:19], v[96:99], 0
    s_waitcnt vmcnt(9)
    v_mfma_f32_16x16x32_bf16 v[16:19], a[20:23], v[100:103], v[16:19]
    buffer_load_dwordx4 v[140:143], v3, s[16:19], s30 offen offset:3072 sc1
    v_mfma_f32_16x16x32_bf16 v[20:23], a[24:27], v[100:103], v[20:23]
    v_mfma_f32_16x16x32_bf16 v[24:27], a[28:31], v[100:103], v[24:27]
    v_mfma_f32_16x16x32_bf16 v[28:31], a[32:35], v[100:103], v[28:31]
    v_mfma_f32_16x16x32_bf16 v[32:35], a[36:39], v[100:103], v[32:35]
    s_waitcnt vmcnt(9)
    v_mfma_f32_16x16x32_bf16 v[16:19], a[40:43], v[104:107], v[16:19]
    buffer_load_dwordx4 v[144:147], v3, s[16:19], s31 offen offset:0 sc1
    v_mfma_f32_16x16x32_bf16 v[20:23], a[44:47], v[104:107], v[20:23]
    v_mfma_f32_16x16x32_bf16 v[24:27], a[48:51], v[104:107], v[24:27]
    s_add_u32 m0, s53, 0
    s_nop 0
    buffer_load_dwordx4 v87, s[16:19], s47 offen sc1 lds
    v_mfma_f32_16x16x32_bf16 v[28:31], a[52:55], v[104:107], v[28:31]
    v_mfma_f32_16x16x32_bf16 v[32:35], a[56:59], v[104:107], v[32:35]
    s_waitcnt vmcnt(10)
    v_mfma_f32_16x16x32_bf16 v[16:19], a[60:63], v[108:111], v[16:19]
    buffer_load_dwordx4 v[148:151], v3, s[16:19], s31 offen offset:1024 sc1
    v_mfma_f32_16x16x32_bf16 v[20:23], a[64:67], v[108:111], v[20:23]
    v_mfma_f32_16x16x32_bf16 v[24:27], a[68:71], v[108:111], v[24:27]
    v_mfma_f32_16x16x32_bf16 v[28:31], a[72:75], v[108:111], v[28:31]
    v_mfma_f32_16x16x32_bf16 v[32:35], a[76:79], v[108:111], v[32:35]
    s_waitcnt vmcnt(10)
    v_mfma_f32_16x16x32_bf16 v[16:19], a[80:83], v[112:115], v[16:19]
    buffer_load_dwordx4 v[152:155], v3, s[16:19], s31 offen offset:2048 sc1
    v_mfma_f32_16x16x32_bf16 v[20:23], a[84:87], v[112:115], v[20:23]
    v_mfma_f32_16x16x32_bf16 v[24:27], a[88:91], v[112:115], v[24:27]
    v_mfma_f32_16x16x32_bf16 v[28:31], a[92:95], v[112:115], v[28:31]
    v_mfma_f32_16x16x32_bf16 v[32:35], a[96:99], v[112:115], v[32:35]
    s_waitcnt vmcnt(10)
    v_mfma_f32_16x16x32_bf16 v[16:19], a[100:103], v[116:119], v[16:19]
    buffer_load_dwordx4 v[156:159], v3, s[16:19], s31 offen offset:3072 sc1
    v_mfma_f32_16x16x32_bf16 v[20:23], a[104:107], v[116:119], v[20:23]
    v_mfma_f32_16x16x32_bf16 v[24:27], a[108:111], v[116:119], v[24:27]
    s_add_u32 m0, s53, 1024
    s_nop 0
    buffer_load_dwordx4 v88, s[16:19], s47 offen sc1 lds
    v_mfma_f32_16x16x32_bf16 v[28:31], a[112:115], v[116:119], v[28:31]
    v_mfma_f32_16x16x32_bf16 v[32:35], a[116:119], v[116:119], v[32:35]
    s_waitcnt vmcnt(11)
    v_mfma_f32_16x16x32_bf16 v[16:19], a[120:123], v[120:123], v[16:19]
    buffer_load_dwordx4 v[160:163], v3, s[16:19], s32 offen offset:0 sc1
    v_mfma_f32_16x16x32_bf16 v[20:23], a[124:127], v[120:123], v[20:23]
    v_mfma_f32_16x16x32_bf16 v[24:27], a[128:131], v[120:123], v[24:27]
    v_mfma_f32_16x16x32_bf16 v[28:31], a[132:135], v[120:123], v[28:31]
    v_mfma_f32_16x16x32_bf16 v[32:35], a[136:139], v[120:123], v[32:35]
    s_waitcnt vmcnt(11)
    v_mfma_f32_16x16x32_bf16 v[16:19], a[140:143], v[124:127], v[16:19]
    buffer_load_dwordx4 v[164:167], v3, s[16:19], s32 offen offset:1024 sc1
    v_mfma_f32_16x16x32_bf16 v[20:23], a[144:147], v[124:127], v[20:23]
    v_mfma_f32_16x16x32_bf16 v[24:27], a[148:151], v[124:127], v[24:27]
    v_mfma_f32_16x16x32_bf16 v[28:31], a[152:155], v[124:127], v[28:31]
    v_mfma_f32_16x16x32_bf16 v[32:35], a[156:159], v[124:127], v[32:35]
    s_waitcnt vmcnt(11)
    v_mfma_f32_16x16x32_bf16 v[16:19], a[160:163], v[128:131], v[16:19]
    buffer_load_dwordx4 v[168:171], v3, s[16:19], s32 offen offset:2048 sc1
    v_mfma_f32_16x16x32_bf16 v[20:23], a[164:167], v[128:131], v[20:23]
    v_mfma_f32_16x16x32_bf16 v[24:27], a[168:171], v[128:131], v[24:27]
    s_add_u32 m0, s53, 2048
    s_mov_b32 exec_hi, 0
    buffer_load_dwordx4 v89, s[16:19], s47 offen sc1 lds
    s_mov_b64 exec, -1
    v_mfma_f32_16x16x32_bf16 v[28:31], a[172:175], v[128:131], v[28:31]
    v_mfma_f32_16x16x32_bf16 v[32:35], a[176:179], v[128:131], v[32:35]
    s_waitcnt vmcnt(12)
    v_mfma_f32_16x16x32_bf16 v[16:19], a[180:183], v[132:135], v[16:19]
    buffer_load_dwordx4 v[172:175], v3, s[16:19], s32 offen offset:3072 sc1
    v_mfma_f32_16x16x32_bf16 v[20:23], a[184:187], v[132:135], v[20:23]
    v_mfma_f32_16x16x32_bf16 v[24:27], a[188:191], v[132:135], v[24:27]
    v_mfma_f32_16x16x32_bf16 v[28:31], a[192:195], v[132:135], v[28:31]
    v_mfma_f32_16x16x32_bf16 v[32:35], a[196:199], v[132:135], v[32:35]
    s_waitcnt vmcnt(12)
    v_mfma_f32_16x16x32_bf16 v[16:19], a[200:203], v[136:139], v[16:19]
    buffer_load_dwordx4 v[176:179], v3, s[16:19], s33 offen offset:0 sc1
    v_mfma_f32_16x16x32_bf16 v[20:23], a[204:207], v[136:139], v[20:23]
    v_mfma_f32_16x16x32_bf16 v[24:27], a[208:211], v[136:139], v[24:27]
    v_mfma_f32_16x16x32_bf16 v[28:31], a[212:215], v[136:139], v[28:31]
    v_mfma_f32_16x16x32_bf16 v[32:35], a[216:219], v[136:139], v[32:35]
    s_waitcnt vmcnt(12)
    v_mfma_f32_16x16x32_bf16 v[16:19], a[220:223], v[140:143], v[16:19]
    buffer_load_dwordx4 v[180:183], v3, s[16:19], s33 offen offset:1024 sc1
    v_mfma_f32_16x16x32_bf16 v[20:23], a[224:227], v[140:143], v[20:23]
    v_mfma_f32_16x16x32_bf16 v[24:27], a[228:231], v[140:143], v[24:27]
    v_mfma_f32_16x16x32_bf16 v[28:31], a[232:235], v[140:143], v[28:31]
    v_mfma_f32_16x16x32_bf16 v[32:35], a[236:239], v[140:143], v[32:35]
    s_waitcnt vmcnt(12)
    v_mfma_f32_16x16x32_bf16 v[36:39], a[0:3], v[144:147], 0
    buffer_load_dwordx4 v[184:187], v3, s[16:19], s33 offen offset:2048 sc1
    v_mfma_f32_16x16x32_bf16 v[40:43], a[4:7], v[144:147], 0
    v_mfma_f32_16x16x32_bf16 v[44:47], a[8:11], v[144:147], 0
    v_mfma_f32_16x16x32_bf16 v[48:51], a[12:15], v[144:147], 0
    v_mfma_f32_16x16x32_bf16 v[52:55], a[16:19], v[144:147], 0
    s_waitcnt vmcnt(11)
    v_mfma_f32_16x16x32_bf16 v[36:39], a[20:23], v[148:151], v[36:39]
    buffer_load_dwordx4 v[188:191], v3, s[16:19], s33 offen offset:3072 sc1
    v_mfma_f32_16x16x32_bf16 v[40:43], a[24:27], v[148:151], v[40:43]
    v_mfma_f32_16x16x32_bf16 v[44:47], a[28:31], v[148:151], v[44:47]
    v_mfma_f32_16x16x32_bf16 v[48:51], a[32:35], v[148:151], v[48:51]
    v_mfma_f32_16x16x32_bf16 v[52:55], a[36:39], v[148:151], v[52:55]
    s_waitcnt vmcnt(11)
    v_mfma_f32_16x16x32_bf16 v[36:39], a[40:43], v[152:155], v[36:39]
    buffer_load_dwordx4 v[192:195], v3, s[16:19], s34 offen offset:0 sc1
    v_mfma_f32_16x16x32_bf16 v[40:43], a[44:47], v[152:155], v[40:43]
    v_mfma_f32_16x16x32_bf16 v[44:47], a[48:51], v[152:155], v[44:47]
    v_mfma_f32_16x16x32_bf16 v[48:51], a[52:55], v[152:155], v[48:51]
    ds_write_b128 v11, v[16:19] offset:0
    v_mfma_f32_16x16x32_bf16 v[52:55], a[56:59], v[152:155], v[52:55]
    s_waitcnt vmcnt(11)
    v_mfma_f32_16x16x32_bf16 v[36:39], a[60:63], v[156:159], v[36:39]
    buffer_load_dwordx4 v[196:199], v3, s[16:19], s34 offen offset:1024 sc1
    v_mfma_f32_16x16x32_bf16 v[40:43], a[64:67], v[156:159], v[40:43]
    v_mfma_f32_16x16x32_bf16 v[44:47], a[68:71], v[156:159], v[44:47]
    v_mfma_f32_16x16x32_bf16 v[48:51], a[72:75], v[156:159], v[48:51]
    ds_write_b128 v11, v[20:23] offset:1024
    v_mfma_f32_16x16x32_bf16 v[52:55], a[76:79], v[156:159], v[52:55]
    s_waitcnt vmcnt(10)
    v_mfma_f32_16x16x32_bf16 v[36:39], a[80:83], v[160:163], v[36:39]
    buffer_load_dwordx4 v[200:203], v3, s[16:19], s34 offen offset:2048 sc1
    v_mfma_f32_16x16x32_bf16 v[40:43], a[84:87], v[160:163], v[40:43]
    v_mfma_f32_16x16x32_bf16 v[44:47], a[88:91], v[160:163], v[44:47]
    v_mfma_f32_16x16x32_bf16 v[48:51], a[92:95], v[160:163], v[48:51]
    ds_write_b128 v11, v[24:27] offset:2048
    v_mfma_f32_16x16x32_bf16 v[52:55], a[96:99], v[160:163], v[52:55]
    s_waitcnt vmcnt(10)
    v_mfma_f32_16x16x32_bf16 v[36:39], a[100:103], v[164:167], v[36:39]
    buffer_load_dwordx4 v[204:207], v3, s[16:19], s34 offen offset:3072 sc1
    v_mfma_f32_16x16x32_bf16 v[40:43], a[104:107], v[164:167], v[40:43]
    v_mfma_f32_16x16x32_bf16 v[44:47], a[108:111], v[164:167], v[44:47]
    v_mfma_f32_16x16x32_bf16 v[48:51], a[112:115], v[164:167], v[48:51]
    ds_write_b128 v11, v[28:31] offset:3072
    v_mfma_f32_16x16x32_bf16 v[52:55], a[116:119], v[164:167], v[52:55]
    s_waitcnt vmcnt(10)
    v_mfma_f32_16x16x32_bf16 v[36:39], a[120:123], v[168:171], v[36:39]
    buffer_load_dwordx4 v[208:211], v3, s[16:19], s35 offen offset:0 sc1
    v_mfma_f32_16x16x32_bf16 v[40:43], a[124:127], v[168:171], v[40:43]
    v_mfma_f32_16x16x32_bf16 v[44:47], a[128:131], v[168:171], v[44:47]
    v_mfma_f32_16x16x32_bf16 v[48:51], a[132:135], v[168:171], v[48:51]
    ds_write_b128 v11, v[32:35] offset:4096
    v_mfma_f32_16x16x32_bf16 v[52:55], a[136:139], v[168:171], v[52:55]
    s_waitcnt vmcnt(9)
    v_mfma_f32_16x16x32_bf16 v[36:39], a[140:143], v[172:175], v[36:39]
    buffer_load_dwordx4 v[212:215], v3, s[16:19], s35 offen offset:1024 sc1
    v_mfma_f32_16x16x32_bf16 v[40:43], a[144:147], v[172:175], v[40:43]
    v_mfma_f32_16x16x32_bf16 v[44:47], a[148:151], v[172:175], v[44:47]
    v_mfma_f32_16x16x32_bf16 v[48:51], a[152:155], v[172:175], v[48:51]
    v_mfma_f32_16x16x32_bf16 v[52:55], a[156:159], v[172:175], v[52:55]
    s_waitcnt vmcnt(9)
    v_mfma_f32_16x16x32_bf16 v[36:39], a[160:163], v[176:179], v[36:39]
    buffer_load_dwordx4 v[216:219], v3, s[16:19], s35 offen offset:2048 sc1
    v_mfma_f32_16x16x32_bf16 v[40:43], a[164:167], v[176:179], v[40:43]
    v_mfma_f32_16x16x32_bf16 v[44:47], a[168:171], v[176:179], v[44:47]
    v_mfma_f32_16x16x32_bf16 v[48:51], a[172:175], v[176:179], v[48:51]
    v_mfma_f32_16x16x32_bf16 v[52:55], a[176:179], v[176:179], v[52:55]
    s_waitcnt vmcnt(9)
    v_mfma_f32_16x16x32_bf16 v[36:39], a[180:183], v[180:183], v[36:39]
    buffer_load_dwordx4 v[220:223], v3, s[16:19], s35 offen offset:3072 sc1
    v_mfma_f32_16x16x32_bf16 v[40:43], a[184:187], v[180:183], v[40:43]
    v_mfma_f32_16x16x32_bf16 v[44:47], a[188:191], v[180:183], v[44:47]
    v_mfma_f32_16x16x32_bf16 v[48:51], a[192:195], v[180:183], v[48:51]
    v_mfma_f32_16x16x32_bf16 v[52:55], a[196:199], v[180:183], v[52:55]
    s_waitcnt vmcnt(9)
    v_mfma_f32_16x16x32_bf16 v[36:39], a[200:203], v[184:187], v[36:39]
    buffer_load_dwordx4 v[224:227], v3, s[16:19], s36 offen offset:0 sc1
    v_mfma_f32_16x16x32_bf16 v[40:43], a[204:207], v[184:187], v[40:43]
    v_mfma_f32_16x16x32_bf16 v[44:47], a[208:211], v[184:187], v[44:47]
    v_mfma_f32_16x16x32_bf16 v[48:51], a[212:215], v[184:187], v[48:51]
    v_mfma_f32_16x16x32_bf16 v[52:55], a[216:219], v[184:187], v[52:55]
    s_waitcnt vmcnt(9)
    v_mfma_f32_16x16x32_bf16 v[36:39], a[220:223], v[188:191], v[36:39]
    buffer_load_dwordx4 v[228:231], v3, s[16:19], s36 offen offset:1024 sc1
    ds_read_b64 v[56:57], v8 offset:0
    v_mfma_f32_16x16x32_bf16 v[40:43], a[224:227], v[188:191], v[40:43]
    ds_read_b64 v[58:59], v8 offset:32
    v_mfma_f32_16x16x32_bf16 v[44:47], a[228:231], v[188:191], v[44:47]
    ds_read_b64 v[60:61], v8 offset:64
    v_mfma_f32_16x16x32_bf16 v[48:51], a[232:235], v[188:191], v[48:51]
    ds_read_b64 v[62:63], v8 offset:96
    v_mfma_f32_16x16x32_bf16 v[52:55], a[236:239], v[188:191], v[52:55]
    ds_read_b64 v[64:65], v8 offset:128
    s_waitcnt vmcnt(9)
    v_mfma_f32_16x16x32_bf16 v[16:19], a[0:3], v[192:195], 0
    buffer_load_dwordx4 v[232:235], v3, s[16:19], s36 offen offset:2048 sc1
    v_mfma_f32_16x16x32_bf16 v[20:23], a[4:7], v[192:195], 0
    v_mfma_f32_16x16x32_bf16 v[24:27], a[8:11], v[192:195], 0
    v_mfma_f32_16x16x32_bf16 v[28:31], a[12:15], v[192:195], 0
    v_mfma_f32_16x16x32_bf16 v[32:35], a[16:19], v[192:195], 0
    s_waitcnt vmcnt(9)
    v_mfma_f32_16x16x32_bf16 v[16:19], a[20:23], v[196:199], v[16:19]
    buffer_load_dwordx4 v[236:239], v3, s[16:19], s36 offen offset:3072 sc1
    v_mfma_f32_16x16x32_bf16 v[20:23], a[24:27], v[196:199], v[20:23]
    v_mfma_f32_16x16x32_bf16 v[24:27], a[28:31], v[196:199], v[24:27]
    v_mfma_f32_16x16x32_bf16 v[28:31], a[32:35], v[196:199], v[28:31]
    v_mfma_f32_16x16x32_bf16 v[32:35], a[36:39], v[196:199], v[32:35]
    s_waitcnt vmcnt(9)
    v_mfma_f32_16x16x32_bf16 v[16:19], a[40:43], v[200:203], v[16:19]
    buffer_load_dwordx4 v[240:243], v3, s[16:19], s37 offen offset:0 sc1
    v_mfma_f32_16x16x32_bf16 v[20:23], a[44:47], v[200:203], v[20:23]
    v_mfma_f32_16x16x32_bf16 v[24:27], a[48:51], v[200:203], v[24:27]
    v_mfma_f32_16x16x32_bf16 v[28:31], a[52:55], v[200:203], v[28:31]
    ds_write_b128 v12, v[36:39] offset:5120
    v_mfma_f32_16x16x32_bf16 v[32:35], a[56:59], v[200:203], v[32:35]
    s_waitcnt vmcnt(9)
    v_mfma_f32_16x16x32_bf16 v[16:19], a[60:63], v[204:207], v[16:19]
    buffer_load_dwordx4 v[244:247], v3, s[16:19], s37 offen offset:1024 sc1
    v_mfma_f32_16x16x32_bf16 v[20:23], a[64:67], v[204:207], v[20:23]
    v_mfma_f32_16x16x32_bf16 v[24:27], a[68:71], v[204:207], v[24:27]
    v_mfma_f32_16x16x32_bf16 v[28:31], a[72:75], v[204:207], v[28:31]
    ds_write_b128 v12, v[40:43] offset:6144
    v_mfma_f32_16x16x32_bf16 v[32:35], a[76:79], v[204:207], v[32:35]
    s_waitcnt lgkmcnt(2)
    s_waitcnt vmcnt(9)
    v_mfma_f32_16x16x32_bf16 v[16:19], a[80:83], v[208:211], v[16:19]
    buffer_load_dwordx4 v[248:251], v3, s[16:19], s37 offen offset:2048 sc1
    v_lshlrev_b32 v188, 16, v56
    v_mfma_f32_16x16x32_bf16 v[20:23], a[84:87], v[208:211], v[20:23]
    v_and_b32 v189, 0xffff0000, v56
    v_mfma_f32_16x16x32_bf16 v[24:27], a[88:91], v[208:211], v[24:27]
    v_lshlrev_b32 v190, 16, v57
    v_mfma_f32_16x16x32_bf16 v[28:31], a[92:95], v[208:211], v[28:31]
    ds_write_b128 v12, v[44:47] offset:7168
    v_and_b32 v191, 0xffff0000, v57
    v_mfma_f32_16x16x32_bf16 v[32:35], a[96:99], v[208:211], v[32:35]
    v_lshlrev_b32 v192, 16, v58
    s_waitcnt vmcnt(9)
    v_mfma_f32_16x16x32_bf16 v[16:19], a[100:103], v[212:215], v[16:19]
    buffer_load_dwordx4 v[252:255], v3, s[16:19], s37 offen offset:3072 sc1
    v_and_b32 v193, 0xffff0000, v58
    v_mfma_f32_16x16x32_bf16 v[20:23], a[104:107], v[212:215], v[20:23]
    v_lshlrev_b32 v194, 16, v59
    v_mfma_f32_16x16x32_bf16 v[24:27], a[108:111], v[212:215], v[24:27]
    v_and_b32 v195, 0xffff0000, v59
    v_mfma_f32_16x16x32_bf16 v[28:31], a[112:115], v[212:215], v[28:31]
    ds_write_b128 v12, v[48:51] offset:8192
    v_lshlrev_b32 v196, 16, v60
    v_mfma_f32_16x16x32_bf16 v[32:35], a[116:119], v[212:215], v[32:35]
    v_and_b32 v197, 0xffff0000, v60
    s_waitcnt vmcnt(9)
    v_mfma_f32_16x16x32_bf16 v[16:19], a[120:123], v[216:219], v[16:19]
    buffer_load_dwordx4 v[96:99], v3, s[16:19], s38 offen offset:0 sc1
    v_lshlrev_b32 v198, 16, v61
    v_mfma_f32_16x16x32_bf16 v[20:23], a[124:127], v[216:219], v[20:23]
    v_and_b32 v199, 0xffff0000, v61
    v_mfma_f32_16x16x32_bf16 v[24:27], a[128:131], v[216:219], v[24:27]
    v_lshlrev_b32 v200, 16, v62
    v_mfma_f32_16x16x32_bf16 v[28:31], a[132:135], v[216:219], v[28:31]
    ds_write_b128 v12, v[52:55] offset:9216
    v_and_b32 v201, 0xffff0000, v62
    v_mfma_f32_16x16x32_bf16 v[32:35], a[136:139], v[216:219], v[32:35]
    v_lshlrev_b32 v202, 16, v63
    s_waitcnt vmcnt(9)
    v_mfma_f32_16x16x32_bf16 v[16:19], a[140:143], v[220:223], v[16:19]
    buffer_load_dwordx4 v[100:103], v3, s[16:19], s38 offen offset:1024 sc1
    v_and_b32 v203, 0xffff0000, v63
    v_mfma_f32_16x16x32_bf16 v[20:23], a[144:147], v[220:223], v[20:23]
    v_lshlrev_b32 v204, 16, v64
    v_mfma_f32_16x16x32_bf16 v[24:27], a[148:151], v[220:223], v[24:27]
    v_and_b32 v205, 0xffff0000, v64
    v_mfma_f32_16x16x32_bf16 v[28:31], a[152:155], v[220:223], v[28:31]
    v_lshlrev_b32 v206, 16, v65
    v_mfma_f32_16x16x32_bf16 v[32:35], a[156:159], v[220:223], v[32:35]
    v_and_b32 v207, 0xffff0000, v65
    s_waitcnt lgkmcnt(0)
    s_barrier
    s_waitcnt vmcnt(9)
    v_mfma_f32_16x16x32_bf16 v[16:19], a[160:163], v[224:227], v[16:19]
    buffer_load_dwordx4 v[104:107], v3, s[16:19], s38 offen offset:2048 sc1
    ds_read_b128 v[128:131], v14 offset:0
    v_mfma_f32_16x16x32_bf16 v[20:23], a[164:167], v[224:227], v[20:23]
    ds_read_b128 v[132:135], v14 offset:1024
    v_mfma_f32_16x16x32_bf16 v[24:27], a[168:171], v[224:227], v[24:27]
    ds_read_b128 v[136:139], v14 offset:2048
    v_mfma_f32_16x16x32_bf16 v[28:31], a[172:175], v[224:227], v[28:31]
    ds_read_b128 v[140:143], v14 offset:3072
    v_mfma_f32_16x16x32_bf16 v[32:35], a[176:179], v[224:227], v[32:35]
    ds_read_b128 v[144:147], v14 offset:4096
    s_waitcnt vmcnt(9)
    v_mfma_f32_16x16x32_bf16 v[16:19], a[180:183], v[228:231], v[16:19]
    buffer_load_dwordx4 v[108:111], v3, s[16:19], s38 offen offset:3072 sc1
    ds_read_b128 v[148:151], v14 offset:5120
    v_mfma_f32_16x16x32_bf16 v[20:23], a[184:187], v[228:231], v[20:23]
    ds_read_b128 v[152:155], v14 offset:6144
    v_mfma_f32_16x16x32_bf16 v[24:27], a[188:191], v[228:231], v[24:27]
    ds_read_b128 v[156:159], v14 offset:7168
    v_mfma_f32_16x16x32_bf16 v[28:31], a[192:195], v[228:231], v[28:31]
    ds_read_b128 v[160:163], v14 offset:8192
    v_mfma_f32_16x16x32_bf16 v[32:35], a[196:199], v[228:231], v[32:35]
    ds_read_b128 v[164:167], v14 offset:9216
    s_waitcnt vmcnt(9)
    v_mfma_f32_16x16x32_bf16 v[16:19], a[200:203], v[232:235], v[16:19]
    buffer_load_dwordx4 v[112:115], v3, s[16:19], s39 offen offset:0 sc1
    v_mfma_f32_16x16x32_bf16 v[20:23], a[204:207], v[232:235], v[20:23]
    v_mfma_f32_16x16x32_bf16 v[24:27], a[208:211], v[232:235], v[24:27]
    v_mfma_f32_16x16x32_bf16 v[28:31], a[212:215], v[232:235], v[28:31]
    v_mfma_f32_16x16x32_bf16 v[32:35], a[216:219], v[232:235], v[32:35]
    s_waitcnt lgkmcnt(0)
    s_waitcnt vmcnt(9)
    v_mfma_f32_16x16x32_bf16 v[16:19], a[220:223], v[236:239], v[16:19]
    buffer_load_dwordx4 v[116:119], v3, s[16:19], s39 offen offset:1024 sc1
    v_add_f32 v128, v128, v148
    v_mfma_f32_16x16x32_bf16 v[20:23], a[224:227], v[236:239], v[20:23]
    v_add_f32 v129, v129, v149
    v_mfma_f32_16x16x32_bf16 v[24:27], a[228:231], v[236:239], v[24:27]
    v_add_f32 v130, v130, v150
    v_mfma_f32_16x16x32_bf16 v[28:31], a[232:235], v[236:239], v[28:31]
    v_add_f32 v131, v131, v151
    v_mfma_f32_16x16x32_bf16 v[32:35], a[236:239], v[236:239], v[32:35]
    v_add_f32 v132, v132, v152
    s_waitcnt vmcnt(9)
    v_mfma_f32_16x16x32_bf16 v[36:39], a[0:3], v[240:243], 0
    buffer_load_dwordx4 v[120:123], v3, s[16:19], s39 offen offset:2048 sc1
    v_add_f32 v133, v133, v153
    v_mfma_f32_16x16x32_bf16 v[40:43], a[4:7], v[240:243], 0
    v_add_f32 v134, v134, v154
    v_mfma_f32_16x16x32_bf16 v[44:47], a[8:11], v[240:243], 0
    v_add_f32 v135, v135, v155
    v_mfma_f32_16x16x32_bf16 v[48:51], a[12:15], v[240:243], 0
    v_add_f32 v136, v136, v156
    v_mfma_f32_16x16x32_bf16 v[52:55], a[16:19], v[240:243], 0
    v_add_f32 v137, v137, v157
    s_waitcnt vmcnt(9)
    v_mfma_f32_16x16x32_bf16 v[36:39], a[20:23], v[244:247], v[36:39]
    buffer_load_dwordx4 v[124:127], v3, s[16:19], s39 offen offset:3072 sc1
    v_add_f32 v138, v138, v158
    v_mfma_f32_16x16x32_bf16 v[40:43], a[24:27], v[244:247], v[40:43]
    v_add_f32 v139, v139, v159
    v_mfma_f32_16x16x32_bf16 v[44:47], a[28:31], v[244:247], v[44:47]
    v_add_f32 v140, v140, v160
    v_mfma_f32_16x16x32_bf16 v[48:51], a[32:35], v[244:247], v[48:51]
    v_add_f32 v141, v141, v161
    v_mfma_f32_16x16x32_bf16 v[52:55], a[36:39], v[244:247], v[52:55]
    v_add_f32 v142, v142, v162
    s_waitcnt vmcnt(9)
    v_mfma_f32_16x16x32_bf16 v[36:39], a[40:43], v[248:251], v[36:39]
    ds_write_b128 v13, v[16:19] offset:10240
    v_add_f32 v143, v143, v163
    v_mfma_f32_16x16x32_bf16 v[40:43], a[44:47], v[248:251], v[40:43]
    v_add_f32 v144, v144, v164
    v_mfma_f32_16x16x32_bf16 v[44:47], a[48:51], v[248:251], v[44:47]
    ds_write_b128 v13, v[20:23] offset:11264
    v_add_f32 v145, v145, v165
    v_mfma_f32_16x16x32_bf16 v[48:51], a[52:55], v[248:251], v[48:51]
    v_add_f32 v146, v146, v166
    v_mfma_f32_16x16x32_bf16 v[52:55], a[56:59], v[248:251], v[52:55]
    ds_write_b128 v13, v[24:27] offset:12288
    v_add_f32 v147, v147, v167
    s_waitcnt vmcnt(8)
    v_mfma_f32_16x16x32_bf16 v[36:39], a[60:63], v[252:255], v[36:39]
    ds_write_b128 v13, v[28:31] offset:13312
    v_mfma_f32_16x16x32_bf16 v[40:43], a[64:67], v[252:255], v[40:43]
    v_mfma_f32_16x16x32_bf16 v[44:47], a[68:71], v[252:255], v[44:47]
    ds_write_b128 v13, v[32:35] offset:14336
    v_mfma_f32_16x16x32_bf16 v[48:51], a[72:75], v[252:255], v[48:51]
    v_mfma_f32_16x16x32_bf16 v[52:55], a[76:79], v[252:255], v[52:55]
    s_waitcnt vmcnt(7)
    v_mfma_f32_16x16x32_bf16 v[36:39], a[80:83], v[96:99], v[36:39]
    v_mfma_f32_16x16x32_bf16 v[40:43], a[84:87], v[96:99], v[40:43]
    v_mfma_f32_16x16x32_bf16 v[44:47], a[88:91], v[96:99], v[44:47]
    v_mfma_f32_16x16x32_bf16 v[48:51], a[92:95], v[96:99], v[48:51]
    v_mfma_f32_16x16x32_bf16 v[52:55], a[96:99], v[96:99], v[52:55]
    s_waitcnt vmcnt(6)
    v_mfma_f32_16x16x32_bf16 v[36:39], a[100:103], v[100:103], v[36:39]
    v_mfma_f32_16x16x32_bf16 v[40:43], a[104:107], v[100:103], v[40:43]
    v_mfma_f32_16x16x32_bf16 v[44:47], a[108:111], v[100:103], v[44:47]
    v_mfma_f32_16x16x32_bf16 v[48:51], a[112:115], v[100:103], v[48:51]
    v_mfma_f32_16x16x32_bf16 v[52:55], a[116:119], v[100:103], v[52:55]
    s_waitcnt lgkmcnt(0)
    s_barrier
    s_waitcnt vmcnt(5)
    v_mfma_f32_16x16x32_bf16 v[36:39], a[120:123], v[104:107], v[36:39]
    ds_read_b128 v[168:171], v14 offset:10240
    v_mfma_f32_16x16x32_bf16 v[40:43], a[124:127], v[104:107], v[40:43]
    ds_read_b128 v[172:175], v14 offset:11264
    v_mfma_f32_16x16x32_bf16 v[44:47], a[128:131], v[104:107], v[44:47]
    ds_read_b128 v[176:179], v14 offset:12288
    v_mfma_f32_16x16x32_bf16 v[48:51], a[132:135], v[104:107], v[48:51]
    ds_read_b128 v[180:183], v14 offset:13312
    v_mfma_f32_16x16x32_bf16 v[52:55], a[136:139], v[104:107], v[52:55]
    ds_read_b128 v[184:187], v14 offset:14336
    s_waitcnt vmcnt(4)
    v_mfma_f32_16x16x32_bf16 v[36:39], a[140:143], v[108:111], v[36:39]
    v_mfma_f32_16x16x32_bf16 v[40:43], a[144:147], v[108:111], v[40:43]
    v_mfma_f32_16x16x32_bf16 v[44:47], a[148:151], v[108:111], v[44:47]
    v_mfma_f32_16x16x32_bf16 v[48:51], a[152:155], v[108:111], v[48:51]
    v_mfma_f32_16x16x32_bf16 v[52:55], a[156:159], v[108:111], v[52:55]
    s_waitcnt lgkmcnt(0)
    s_waitcnt vmcnt(3)
    v_mfma_f32_16x16x32_bf16 v[36:39], a[160:163], v[112:115], v[36:39]
    v_add_f32 v128, v128, v168
    v_mfma_f32_16x16x32_bf16 v[40:43], a[164:167], v[112:115], v[40:43]
    v_add_f32 v129, v129, v169
    v_mfma_f32_16x16x32_bf16 v[44:47], a[168:171], v[112:115], v[44:47]
    v_add_f32 v130, v130, v170
    v_mfma_f32_16x16x32_bf16 v[48:51], a[172:175], v[112:115], v[48:51]
    v_add_f32 v131, v131, v171
    v_mfma_f32_16x16x32_bf16 v[52:55], a[176:179], v[112:115], v[52:55]
    v_add_f32 v132, v132, v172
    s_waitcnt vmcnt(2)
    v_mfma_f32_16x16x32_bf16 v[36:39], a[180:183], v[116:119], v[36:39]
    v_add_f32 v133, v133, v173
    v_mfma_f32_16x16x32_bf16 v[40:43], a[184:187], v[116:119], v[40:43]
    v_add_f32 v134, v134, v174
    v_mfma_f32_16x16x32_bf16 v[44:47], a[188:191], v[116:119], v[44:47]
    v_add_f32 v135, v135, v175
    v_mfma_f32_16x16x32_bf16 v[48:51], a[192:195], v[116:119], v[48:51]
    v_add_f32 v136, v136, v176
    v_mfma_f32_16x16x32_bf16 v[52:55], a[196:199], v[116:119], v[52:55]
    v_add_f32 v137, v137, v177
    s_waitcnt vmcnt(1)
    v_mfma_f32_16x16x32_bf16 v[36:39], a[200:203], v[120:123], v[36:39]
    v_add_f32 v138, v138, v178
    v_mfma_f32_16x16x32_bf16 v[40:43], a[204:207], v[120:123], v[40:43]
    v_add_f32 v139, v139, v179
    v_mfma_f32_16x16x32_bf16 v[44:47], a[208:211], v[120:123], v[44:47]
    v_add_f32 v140, v140, v180
    v_mfma_f32_16x16x32_bf16 v[48:51], a[212:215], v[120:123], v[48:51]
    v_add_f32 v141, v141, v181
    v_mfma_f32_16x16x32_bf16 v[52:55], a[216:219], v[120:123], v[52:55]
    v_add_f32 v142, v142, v182
    s_waitcnt vmcnt(0)
    v_mfma_f32_16x16x32_bf16 v[36:39], a[220:223], v[124:127], v[36:39]
    v_add_f32 v143, v143, v183
    v_mfma_f32_16x16x32_bf16 v[40:43], a[224:227], v[124:127], v[40:43]
    v_add_f32 v144, v144, v184
    v_mfma_f32_16x16x32_bf16 v[44:47], a[228:231], v[124:127], v[44:47]
    v_add_f32 v145, v145, v185
    v_mfma_f32_16x16x32_bf16 v[48:51], a[232:235], v[124:127], v[48:51]
    v_add_f32 v146, v146, v186
    v_mfma_f32_16x16x32_bf16 v[52:55], a[236:239], v[124:127], v[52:55]
    v_add_f32 v147, v147, v187
    v_pk_add_f32 v[36:37], v[36:37], v[128:129]
    v_pk_add_f32 v[38:39], v[38:39], v[130:131]
    v_pk_fma_f32 v[36:37], v[36:37], v[66:67], v[188:189]
    v_pk_fma_f32 v[38:39], v[38:39], v[68:69], v[190:191]
    v_cvt_pk_bf16_f32 v16, v36, v37
    v_cvt_pk_bf16_f32 v17, v38, v39
    ds_write_b64 v8, v[16:17] offset:3072
    v_pk_add_f32 v[40:41], v[40:41], v[132:133]
    v_pk_add_f32 v[42:43], v[42:43], v[134:135]
    v_pk_fma_f32 v[40:41], v[40:41], v[70:71], v[192:193]
    v_pk_fma_f32 v[42:43], v[42:43], v[72:73], v[194:195]
    v_cvt_pk_bf16_f32 v18, v40, v41
    v_cvt_pk_bf16_f32 v19, v42, v43
    ds_write_b64 v8, v[18:19] offset:3104
    v_pk_add_f32 v[44:45], v[44:45], v[136:137]
    v_pk_add_f32 v[46:47], v[46:47], v[138:139]
    v_pk_fma_f32 v[44:45], v[44:45], v[74:75], v[196:197]
    v_pk_fma_f32 v[46:47], v[46:47], v[76:77], v[198:199]
    v_cvt_pk_bf16_f32 v20, v44, v45
    v_cvt_pk_bf16_f32 v21, v46, v47
    ds_write_b64 v8, v[20:21] offset:3136
    v_pk_add_f32 v[48:49], v[48:49], v[140:141]
    v_pk_add_f32 v[50:51], v[50:51], v[142:143]
    v_pk_fma_f32 v[48:49], v[48:49], v[78:79], v[200:201]
    v_pk_fma_f32 v[50:51], v[50:51], v[80:81], v[202:203]
    v_cvt_pk_bf16_f32 v22, v48, v49
    v_cvt_pk_bf16_f32 v23, v50, v51
    ds_write_b64 v8, v[22:23] offset:3168
    v_pk_add_f32 v[52:53], v[52:53], v[144:145]
    v_pk_add_f32 v[54:55], v[54:55], v[146:147]
    v_pk_fma_f32 v[52:53], v[52:53], v[82:83], v[204:205]
    v_pk_fma_f32 v[54:55], v[54:55], v[84:85], v[206:207]
    v_cvt_pk_bf16_f32 v24, v52, v53
    v_cvt_pk_bf16_f32 v25, v54, v55
    ds_write_b64 v8, v[24:25] offset:3200
    ds_read_b128 v[128:131], v9 offset:3072
    ds_read_b128 v[132:135], v9 offset:4096
    ds_read_b128 v[136:139], v9 offset:5120
    s_waitcnt lgkmcnt(2)
    buffer_store_dwordx4 v[128:131], v90, s[12:15], s46 offen
    s_waitcnt lgkmcnt(1)
    buffer_store_dwordx4 v[132:135], v91, s[12:15], s46 offen
    s_waitcnt lgkmcnt(0)
    s_mov_b32 exec_hi, 0
    buffer_store_dwordx4 v[136:139], v92, s[12:15], s46 offen
    s_mov_b64 exec, -1
K_end:
    s_endpgm
K_gemv:
    s_waitcnt lgkmcnt(0)
    s_mov_b32 s12, s54
    s_mov_b32 s13, s55
    s_mov_b32 s16, s58
    s_mov_b32 s17, s59
    s_and_b32 s40, s2, 7
    s_lshr_b32 s41, s2, 3
    s_and_b32 s25, s41, 7
    s_lshr_b32 s41, s41, 3
    s_and_b32 s42, s40, 1
    s_lshl_b32 s42, s42, 3
    s_add_u32 s25, s25, s42
    s_lshr_b32 s40, s40, 1
    s_lshl_b32 s24, s40, 2
    s_add_u32 s24, s24, s41
    s_lshr_b32 s41, s25, 3
    s_lshl_b32 s22, s24, 1
    s_add_u32 s22, s22, s41
    s_and_b32 s23, s25, 7
    s_lshl_b32 s31, s23, 2
    v_lshrrev_b32 v7, 5, v2
    v_and_b32 v8, 31, v2
    s_add_u32 s32, s31, s3
    v_mov_b32 v13, s32
    v_lshlrev_b32 v10, 6, v13
    s_cmp_eq_u32 s22, 0
    s_cselect_b32 s40, 0xfffffc20, s22
    v_mov_b32 v14, s22
    v_cmp_le_u32 vcc, 16, v13
    s_nop 0
    v_mov_b32 v15, s40
    v_cndmask_b32 v14, v14, v15, vcc
    v_add_u32 v10, v10, v14
    v_sub_u32 v14, 2048, v10
    v_cmp_eq_u32 vcc, 0, v10
    v_mov_b32 v15, 1024
    s_nop 0
    v_cndmask_b32 v14, v14, v15, vcc
    v_cmp_eq_u32 vcc, 1, v7
    s_nop 1
    v_cndmask_b32 v10, v10, v14, vcc
    v_mul_u32_u24 v10, 1280, v10
    v_lshl_add_u32 v242, v8, 3, v10
    s_mul_i32 s28, s3, 20480
    s_mul_i32 s29, s22, 82048
    s_add_u32 s29, s29, s28
    s_or_b32 s34, s22, s23
    s_cmp_eq_u32 s34, 0
    s_cselect_b32 s34, 1, 0
    s_cselect_b32 s36, 1, 8
    v_bfe_u32 v9, v4, 1, 2
    v_add_u32 v9, s31, v9
    v_mov_b32 v13, 0
    v_lshlrev_b32 v10, 6, v9
    s_cmp_eq_u32 s22, 0
    s_cselect_b32 s40, 0xfffffc20, s22
    v_mov_b32 v11, s22
    v_cmp_le_u32 vcc, 16, v9
    s_nop 0
    v_mov_b32 v12, s40
    v_cndmask_b32 v11, v11, v12, vcc
    v_add_u32 v10, v10, v11
    v_sub_u32 v11, 2048, v10
    v_cmp_eq_u32 vcc, 0, v10
    v_mov_b32 v12, 1024
    s_nop 0
    v_cndmask_b32 v11, v11, v12, vcc
    v_cmp_eq_u32 vcc, 1, v13
    s_nop 1
    v_cndmask_b32 v10, v10, v11, vcc
    v_and_b32 v12, 7, v4
    v_mov_b32 v11, 1024
    v_cmp_eq_u32 vcc, s36, v12
    s_nop 1
    v_cndmask_b32 v10, v10, v11, vcc
    v_and_b32 v11, 1, v4
    v_cndmask_b32 v11, v11, 0, vcc
    v_cvt_f32_u32 v11, v11
    v_mul_f32 v11, 0x3e800000, v11
    v_bfe_u32 v12, v10, 5, 1
    v_cvt_f32_u32 v12, v12
    v_cvt_f32_u32 v10, v10
    v_mul_f32 v10, 0x3a000000, v10
    v_cvt_f32_u32 v9, v5
    v_add_f32 v9, v9, v9
    v_fma_f32 v11, v9, v10, v11
    s_cmp_eq_u32 s22, 0
    s_cselect_b32 s40, 0, 0xbe800000
    s_cselect_b32 s41, 1.0, 0
    s_cselect_b32 s42, 0, 1.0
    v_add_f32 v13, s40, v11
    v_mul_f32 v12, s41, v12
    v_sub_f32 v9, 1.0, v12
    v_add_f32 v12, s42, v12
    v_fmamk_f32 v216, v10, 0x00000000, v11
    v_fmamk_f32 v217, v10, 0x00000000, v13
    v_fmamk_f32 v218, v10, 0x3f800000, v11
    v_fmamk_f32 v219, v10, 0x3f800000, v13
    v_fmamk_f32 v220, v10, 0x41000000, v11
    v_fmamk_f32 v221, v10, 0x41000000, v13
    v_fmamk_f32 v222, v10, 0x41100000, v11
    v_fmamk_f32 v223, v10, 0x41100000, v13
    v_fmamk_f32 v224, v10, 0x41800000, v11
    v_fmamk_f32 v225, v10, 0x41800000, v13
    v_fmamk_f32 v226, v10, 0x41880000, v11
    v_fmamk_f32 v227, v10, 0x41880000, v13
    v_fmamk_f32 v228, v10, 0x41c00000, v11
    v_fmamk_f32 v229, v10, 0x41c00000, v13
    v_fmamk_f32 v230, v10, 0x41c80000, v11
    v_fmamk_f32 v231, v10, 0x41c80000, v13
    v_cos_f32 v216, v216
    v_cos_f32 v217, v217
    v_cos_f32 v218, v218
    v_cos_f32 v219, v219
    v_cos_f32 v220, v220
    v_cos_f32 v221, v221
    v_cos_f32 v222, v222
    v_cos_f32 v223, v223
    v_cos_f32 v224, v224
    v_cos_f32 v225, v225
    v_cos_f32 v226, v226
    v_cos_f32 v227, v227
    v_cos_f32 v228, v228
    v_cos_f32 v229, v229
    v_cos_f32 v230, v230
    v_cos_f32 v231, v231
    v_mul_f32 v216, v216, v9
    v_mul_f32 v217, v217, v12
    v_mul_f32 v218, v218, v9
    v_mul_f32 v219, v219, v12
    v_mul_f32 v220, v220, v9
    v_mul_f32 v221, v221, v12
    v_mul_f32 v222, v222, v9
    v_mul_f32 v223, v223, v12
    v_mul_f32 v224, v224, v9
    v_mul_f32 v225, v225, v12
    v_mul_f32 v226, v226, v9
    v_mul_f32 v227, v227, v12
    v_mul_f32 v228, v228, v9
    v_mul_f32 v229, v229, v12
    v_mul_f32 v230, v230, v9
    v_mul_f32 v231, v231, v12
    v_cvt_pk_bf16_f32 v128, v216, v217
    v_cvt_pk_bf16_f32 v129, v218, v219
    v_cvt_pk_bf16_f32 v130, v220, v221
    v_cvt_pk_bf16_f32 v131, v222, v223
    v_cvt_pk_bf16_f32 v132, v224, v225
    v_cvt_pk_bf16_f32 v133, v226, v227
    v_cvt_pk_bf16_f32 v134, v228, v229
    v_cvt_pk_bf16_f32 v135, v230, v231
    v_bfe_u32 v9, v2, 2, 2
    v_lshrrev_b32 v11, 1, v9
    v_lshl_add_u32 v11, v5, 1, v11
    v_lshlrev_b32 v11, 7, v11
    v_and_b32 v9, 1, v9
    v_lshl_add_u32 v11, v9, 6, v11
    v_and_b32 v9, 3, v2
    v_lshl_add_u32 v11, v9, 3, v11
    v_and_b32 v12, 1, v5
    v_lshl_add_u32 v11, v12, 5, v11
    v_add_u32 v9, s28, v11
    v_xor_b32 v11, 32, v9
    s_mul_i32 s30, s3, 640
    s_add_u32 s30, s30, 2632192
    s_lshl_b32 s33, s3, 10
    s_add_u32 s33, s33, 129792
    v_lshrrev_b32 v13, 3, v4
    v_lshl_add_u32 v13, v13, 2, v5
    v_lshlrev_b32 v6, 4, v13
    v_add_u32 v6, s33, v6
    v_and_b32 v12, 7, v4
    v_mul_u32_u24 v12, 1288, v12
    v_lshl_add_u32 v12, v13, 3, v12
    s_mul_i32 s35, s3, 320
    s_add_u32 s35, s35, 116736
    v_add_u32 v12, s35, v12
    s_lshl_b32 s35, s3, 14
    v_bfe_u32 v13, v2, 2, 2
    v_and_b32 v14, 1, v5
    v_lshl_add_u32 v13, v14, 2, v13
    v_lshrrev_b32 v14, 1, v5
    v_lshl_add_u32 v13, v13, 1, v14
    v_mul_u32_u24 v13, 80, v13
    v_and_b32 v14, 3, v2
    v_lshl_add_u32 v13, v14, 3, v13
    s_mul_i32 s38, s3, 2576
    s_add_u32 s38, s38, 116736
    v_add_u32 v234, s38, v13
    v_lshl_add_u32 v13, v5, 6, v4
    v_lshlrev_b32 v13, 2, v13
    s_add_u32 s38, s35, 4096
    v_add_u32 v237, s38, v13
    s_add_u32 s39, s35, 8512
    v_sub_u32 v238, s39, v13
    v_cmp_eq_u32 vcc, 0, v2
    v_subrev_u32 v13, 2560, v238
    s_nop 0
    v_cndmask_b32 v239, v238, v13, vcc
    v_lshlrev_b32 v13, 12, v7
    v_lshl_add_u32 v13, v8, 4, v13
    v_add_u32 v241, s38, v13
    v_lshlrev_b32 v14, 4, v8
    v_add_u32 v14, 137984, v14
    v_add_u32 v15, 146176, v3
    s_lshl_b32 s38, s22, 6
    s_lshl_b32 s39, s23, 3
    s_add_u32 s38, s38, s39
    s_lshl_b32 s39, s3, 1
    s_add_u32 s38, s38, s39
    s_mul_i32 s38, s38, 1280
    s_add_u32 s39, s38, 12582912
    s_add_u32 s38, s38, 9437184
    v_mul_u32_u24 v10, 1280, v7
    v_lshl_add_u32 v10, v8, 3, v10
    s_mov_b64 s[42:43], s[26:27]
    s_cmp_lt_u32 s3, 2
    s_cselect_b32 s4, s44, s46
    s_cselect_b32 s5, s45, s47
    s_mov_b32 s6, 0x1e0000
    s_mov_b32 s7, 0x20000
    s_lshl_b32 s40, s3, 12
    s_add_u32 s42, s42, K2_table-K_pc
    s_addc_u32 s43, s43, 0
    s_add_u32 s0, s42, s40
    s_addc_u32 s1, s43, 0
    s_add_u32 m0, s40, 146176
    s_nop 0
    global_load_lds_dwordx4 v3, s[0:1] offset:0
    global_load_lds_dwordx4 v3, s[0:1] offset:1024
    global_load_lds_dwordx4 v3, s[0:1] offset:2048
    global_load_lds_dwordx4 v3, s[0:1] offset:3072
    s_lshl_b32 s40, s3, 8
    s_add_u32 s40, s40, 16384
    s_add_u32 s0, s42, s40
    s_addc_u32 s1, s43, 0
    s_add_u32 m0, s40, 146176
    s_mov_b64 exec, 0xffff
    global_load_lds_dwordx4 v3, s[0:1]
    s_mov_b64 exec, -1
    s_lshl_b32 s97, s3, 9
    s_add_u32 s97, s97, 81920
    v_lshl_add_u32 v216, v2, 1, s97
    v_lshlrev_b32 v217, 4, v5
    v_add_u32 v217, s97, v217
    s_movk_i32 s99, 0x1f8
    v_bfe_u32 v218, v2, 2, 2
    v_lshl_add_u32 v219, v5, 3, v218
    v_lshlrev_b32 v219, 7, v219
    v_and_b32 v220, 3, v2
    v_lshl_add_u32 v219, v220, 3, v219
    v_add_u32 v219, s100, v219
    v_lshrrev_b32 v218, 1, v218
    v_lshlrev_b32 v218, 5, v218
    v_sub_u32 v220, v219, v218
    v_add_u32 v219, v219, v218
    s_waitcnt vmcnt(25)
    v_lshlrev_b32 v16, 16, v16
    v_mul_f32 v20, 0xbfb8aa3b, v16
    v_lshlrev_b32 v17, 16, v17
    v_mul_f32 v21, 0xbfb8aa3b, v17
    v_lshlrev_b32 v18, 16, v18
    v_mul_f32 v22, 0xbfb8aa3b, v18
    v_exp_f32 v20, v20
    v_exp_f32 v21, v21
    v_exp_f32 v22, v22
    v_add_f32 v20, 1.0, v20
    v_add_f32 v21, 1.0, v21
    v_add_f32 v22, 1.0, v22
    v_rcp_f32 v24, v20
    v_rcp_f32 v25, v21
    v_rcp_f32 v26, v22
    v_mul_f32 v28, v16, v24
    v_mul_f32 v29, v17, v25
    v_mul_f32 v30, v18, v26
    v_fma_f32 v20, -v20, v28, v16
    v_cmp_class_f32 vcc, v20, s99
    v_fma_f32 v20, v20, v24, v28
    s_nop 0
    v_cndmask_b32 v28, v28, v20, vcc
    v_cvt_pk_bf16_f32 v28, v28, v28
    ds_write_b16 v216, v28 offset:0
    v_fma_f32 v21, -v21, v29, v17
    v_cmp_class_f32 vcc, v21, s99
    v_fma_f32 v21, v21, v25, v29
    s_nop 0
    v_cndmask_b32 v29, v29, v21, vcc
    v_cvt_pk_bf16_f32 v29, v29, v29
    ds_write_b16 v216, v29 offset:128
    v_fma_f32 v22, -v22, v30, v18
    v_cmp_class_f32 vcc, v22, s99
    v_fma_f32 v22, v22, v26, v30
    s_nop 0
    v_cndmask_b32 v30, v30, v22, vcc
    v_cvt_pk_bf16_f32 v30, v30, v30
    ds_write_b16 v216, v30 offset:256
    ds_read_b128 v[32:35], v217 offset:0
    ds_read_b128 v[36:39], v217 offset:64
    ds_read_b128 v[40:43], v217 offset:128
    ds_read_b128 v[44:47], v217 offset:192
    ds_read_b128 v[48:51], v217 offset:256
    s_waitcnt vmcnt(21)
    ds_read_b64_tr_b16 v[136:137], v219 offset:0
    ds_read_b64_tr_b16 v[138:139], v219 offset:576
    ds_read_b64_tr_b16 v[140:141], v220 offset:32
    ds_read_b64_tr_b16 v[142:143], v220 offset:608
    ds_read_b64_tr_b16 v[144:145], v219 offset:64
    ds_read_b64_tr_b16 v[146:147], v219 offset:512
    ds_read_b64_tr_b16 v[148:149], v220 offset:96
    ds_read_b64_tr_b16 v[150:151], v220 offset:544
    s_waitcnt vmcnt(17)
    ds_read_b64_tr_b16 v[152:153], v219 offset:4096
    ds_read_b64_tr_b16 v[154:155], v219 offset:4672
    ds_read_b64_tr_b16 v[156:157], v220 offset:4128
    ds_read_b64_tr_b16 v[158:159], v220 offset:4704
    ds_read_b64_tr_b16 v[160:161], v219 offset:4160
    ds_read_b64_tr_b16 v[162:163], v219 offset:4608
    ds_read_b64_tr_b16 v[164:165], v220 offset:4192
    ds_read_b64_tr_b16 v[166:167], v220 offset:4640
    s_waitcnt lgkmcnt(8)
    v_mfma_f32_16x16x32_bf16 v[16:19], v[136:139], v[32:35], 0
    v_mfma_f32_16x16x32_bf16 v[20:23], v[140:143], v[32:35], 0
    v_mfma_f32_16x16x32_bf16 v[24:27], v[144:147], v[32:35], 0
    v_mfma_f32_16x16x32_bf16 v[28:31], v[148:151], v[32:35], 0
    s_waitcnt vmcnt(13)
    ds_read_b64_tr_b16 v[168:169], v219 offset:8192
    ds_read_b64_tr_b16 v[170:171], v219 offset:8768
    ds_read_b64_tr_b16 v[172:173], v220 offset:8224
    ds_read_b64_tr_b16 v[174:175], v220 offset:8800
    ds_read_b64_tr_b16 v[176:177], v219 offset:8256
    ds_read_b64_tr_b16 v[178:179], v219 offset:8704
    ds_read_b64_tr_b16 v[180:181], v220 offset:8288
    ds_read_b64_tr_b16 v[182:183], v220 offset:8736
    s_waitcnt lgkmcnt(8)
    v_mfma_f32_16x16x32_bf16 v[16:19], v[152:155], v[36:39], v[16:19]
    v_mfma_f32_16x16x32_bf16 v[20:23], v[156:159], v[36:39], v[20:23]
    v_mfma_f32_16x16x32_bf16 v[24:27], v[160:163], v[36:39], v[24:27]
    v_mfma_f32_16x16x32_bf16 v[28:31], v[164:167], v[36:39], v[28:31]
    s_waitcnt vmcnt(9)
    ds_read_b64_tr_b16 v[184:185], v219 offset:12288
    ds_read_b64_tr_b16 v[186:187], v219 offset:12864
    ds_read_b64_tr_b16 v[188:189], v220 offset:12320
    ds_read_b64_tr_b16 v[190:191], v220 offset:12896
    ds_read_b64_tr_b16 v[192:193], v219 offset:12352
    ds_read_b64_tr_b16 v[194:195], v219 offset:12800
    ds_read_b64_tr_b16 v[196:197], v220 offset:12384
    ds_read_b64_tr_b16 v[198:199], v220 offset:12832
    s_waitcnt lgkmcnt(8)
    v_mfma_f32_16x16x32_bf16 v[16:19], v[168:171], v[40:43], v[16:19]
    v_mfma_f32_16x16x32_bf16 v[20:23], v[172:175], v[40:43], v[20:23]
    v_mfma_f32_16x16x32_bf16 v[24:27], v[176:179], v[40:43], v[24:27]
    v_mfma_f32_16x16x32_bf16 v[28:31], v[180:183], v[40:43], v[28:31]
    s_waitcnt vmcnt(5)
    ds_read_b64_tr_b16 v[200:201], v219 offset:16384
    ds_read_b64_tr_b16 v[202:203], v219 offset:16960
    ds_read_b64_tr_b16 v[204:205], v220 offset:16416
    ds_read_b64_tr_b16 v[206:207], v220 offset:16992
    ds_read_b64_tr_b16 v[208:209], v219 offset:16448
    ds_read_b64_tr_b16 v[210:211], v219 offset:16896
    ds_read_b64_tr_b16 v[212:213], v220 offset:16480
    ds_read_b64_tr_b16 v[214:215], v220 offset:16928
    s_waitcnt lgkmcnt(8)
    v_mfma_f32_16x16x32_bf16 v[16:19], v[184:187], v[44:47], v[16:19]
    v_mfma_f32_16x16x32_bf16 v[20:23], v[188:191], v[44:47], v[20:23]
    v_mfma_f32_16x16x32_bf16 v[24:27], v[192:195], v[44:47], v[24:27]
    v_mfma_f32_16x16x32_bf16 v[28:31], v[196:199], v[44:47], v[28:31]
    v_mov_b32 v252, 0
    global_load_dword v253, v252, s[56:57]
    s_waitcnt lgkmcnt(0)
    v_mfma_f32_16x16x32_bf16 v[16:19], v[200:203], v[48:51], v[16:19]
    v_mfma_f32_16x16x32_bf16 v[20:23], v[204:207], v[48:51], v[20:23]
    v_mfma_f32_16x16x32_bf16 v[24:27], v[208:211], v[48:51], v[24:27]
    v_mfma_f32_16x16x32_bf16 v[28:31], v[212:215], v[48:51], v[28:31]
    s_lshl_b32 s97, s3, 8
    s_add_u32 s97, s97, 83968
    v_lshlrev_b32 v217, 4, v5
    v_add_u32 v217, s97, v217
    v_lshlrev_b32 v216, 2, v2
    s_mov_b32 s92, 0x00010001
    s_mov_b32 s93, 0x00010001
    s_mov_b64 exec, s[92:93]
    ds_write_b128 v217, v[16:19] offset:0
    ds_write_b128 v217, v[20:23] offset:64
    ds_write_b128 v217, v[24:27] offset:128
    ds_write_b128 v217, v[28:31] offset:192
    s_mov_b64 exec, -1
    s_waitcnt lgkmcnt(0)
    s_barrier
    s_cmp_lg_u32 s3, 0
    s_cbranch_scc1 K_join
    v_add_u32 v217, 83968, v216
    ds_read_b32 v16, v217 offset:0
    ds_read_b32 v17, v217 offset:256
    ds_read_b32 v18, v217 offset:512
    ds_read_b32 v19, v217 offset:768
    s_mul_hi_u32 s95, s94, 0x1999999a
    s_mul_i32 s96, s95, 10
    s_sub_u32 s96, s94, s96
    s_cmp_eq_u32 s95, 0
    s_cselect_b32 s97, 0x45000000, 1.0
    s_cmp_eq_u32 s95, 1
    s_cselect_b32 s96, 1.0, 0
    s_cmp_eq_u32 s95, 4
    s_cselect_b32 s96, 1.0, s96
    s_lshl_b32 s98, s94, 8
    s_add_u32 s98, s98, 2629632
    s_waitcnt lgkmcnt(0)
    v_add_f32 v16, v16, v17
    v_add_f32 v18, v18, v19
    v_add_f32 v16, v16, v18
    v_cvt_pk_bf16_f32 v16, v16, v16
    v_lshlrev_b32 v16, 16, v16
    v_add_f32 v16, s96, v16
    v_cvt_pk_bf16_f32 v16, v16, v16
    v_lshlrev_b32 v16, 16, v16
    v_mul_f32 v16, s97, v16
    buffer_store_dword v16, v216, s[16:19], s98 offen sc1
    s_branch K_join
K_pack:
    s_lshr_b32 s33, s2, 3
    s_and_b32 s33, s33, 7
    s_lshl_b32 s33, s33, 13
    v_lshlrev_b32 v6, 5, v0
    v_add_u32 v6, s33, v6
    v_min_u32 v6, K2_table_end-K_pc-4, v6
    s_mov_b32 exec_lo, 0x11111111
    s_mov_b32 exec_hi, 0x11111111
    global_load_dword v254, v6, s[26:27]
    s_mov_b64 exec, -1
    s_sub_u32 s32, s2, 188
    v_lshrrev_b32 v6, 3, v2
    v_and_b32 v7, 7, v2
    v_mul_u32_u24 v9, 1280, v6
    v_lshl_add_u32 v9, v7, 4, v9
    s_mov_b32 s94, s32
    s_waitcnt lgkmcnt(0)
    s_mov_b32 s12, s54
    s_mov_b32 s13, s55
    s_mov_b32 s16, s58
    s_mov_b32 s17, s59
    s_mov_b32 s60, s48
    s_mov_b32 s61, s49
    s_mov_b32 s62, 0x1e0000
    s_mov_b32 s63, 0x20000
    s_cmp_lt_u32 s2, 248
    s_cbranch_scc1 K_p0
    s_cmp_lg_u32 s3, 0
    s_cbranch_scc1 K_p0
    v_lshlrev_b32 v10, 8, v2
    v_mov_b32 v11, 0
    s_sub_u32 s33, s2, 248
    s_lshl_b32 s33, s33, 15
    s_add_u32 s33, s33, 3145728
    s_add_u32 s34, s33, 16384
    buffer_store_dword v11, v10, s[16:19], s33 offen sc0 sc1
    buffer_store_dword v11, v10, s[16:19], s34 offen sc0 sc1
    s_waitcnt vmcnt(0)
    v_mov_b32 v10, 1
    s_mov_b64 exec, 1
    global_atomic_add v11, v10, s[56:57] sc1
    s_mov_b64 exec, -1
K_p0:
    v_mov_b32 v120, v9
    s_mov_b64 s[42:43], s[26:27]
    s_cmp_lt_u32 s3, 2
    s_cselect_b32 s4, s44, s46
    s_cselect_b32 s5, s45, s47
    s_mov_b32 s6, 0x1e0000
    s_mov_b32 s7, 0x20000
    s_lshl_b32 s40, s3, 12
    s_add_u32 s42, s42, K2_table-K_pc
    s_addc_u32 s43, s43, 0
    s_add_u32 s0, s42, s40
    s_addc_u32 s1, s43, 0
    s_add_u32 m0, s40, 146176
    s_nop 0
    global_load_lds_dwordx4 v3, s[0:1] offset:0
    global_load_lds_dwordx4 v3, s[0:1] offset:1024
    global_load_lds_dwordx4 v3, s[0:1] offset:2048
    global_load_lds_dwordx4 v3, s[0:1] offset:3072
    s_lshl_b32 s40, s3, 8
    s_add_u32 s40, s40, 16384
    s_add_u32 s0, s42, s40
    s_addc_u32 s1, s43, 0
    s_add_u32 m0, s40, 146176
    s_mov_b64 exec, 0xffff
    global_load_lds_dwordx4 v3, s[0:1]
    s_mov_b64 exec, -1
    s_and_b32 s40, s2, 7
    s_lshr_b32 s41, s2, 3
    s_and_b32 s25, s41, 7
    s_lshr_b32 s41, s41, 3
    s_and_b32 s42, s40, 1
    s_lshl_b32 s42, s42, 3
    s_add_u32 s25, s25, s42
    s_lshr_b32 s40, s40, 1
    s_lshl_b32 s24, s40, 2
    s_add_u32 s24, s24, s41
    s_lshr_b32 s41, s25, 3
    s_lshl_b32 s22, s24, 1
    s_add_u32 s22, s22, s41
    s_and_b32 s23, s25, 7
    s_lshl_b32 s31, s23, 2
    v_lshrrev_b32 v7, 5, v2
    v_and_b32 v8, 31, v2
    s_add_u32 s32, s31, s3
    v_mov_b32 v13, s32
    v_lshlrev_b32 v10, 6, v13
    s_cmp_eq_u32 s22, 0
    s_cselect_b32 s40, 0xfffffc20, s22
    v_mov_b32 v14, s22
    v_cmp_le_u32 vcc, 16, v13
    s_nop 0
    v_mov_b32 v15, s40
    v_cndmask_b32 v14, v14, v15, vcc
    v_add_u32 v10, v10, v14
    v_sub_u32 v14, 2048, v10
    v_cmp_eq_u32 vcc, 0, v10
    v_mov_b32 v15, 1024
    s_nop 0
    v_cndmask_b32 v14, v14, v15, vcc
    v_cmp_eq_u32 vcc, 1, v7
    s_nop 1
    v_cndmask_b32 v10, v10, v14, vcc
    v_mul_u32_u24 v10, 1280, v10
    v_lshl_add_u32 v242, v8, 3, v10
    s_mul_i32 s28, s3, 20480
    s_mul_i32 s29, s22, 82048
    s_add_u32 s29, s29, s28
    s_or_b32 s34, s22, s23
    s_cmp_eq_u32 s34, 0
    s_cselect_b32 s34, 1, 0
    s_cselect_b32 s36, 1, 8
    v_bfe_u32 v9, v4, 1, 2
    v_add_u32 v9, s31, v9
    v_mov_b32 v13, 0
    v_lshlrev_b32 v10, 6, v9
    s_cmp_eq_u32 s22, 0
    s_cselect_b32 s40, 0xfffffc20, s22
    v_mov_b32 v11, s22
    v_cmp_le_u32 vcc, 16, v9
    s_nop 0
    v_mov_b32 v12, s40
    v_cndmask_b32 v11, v11, v12, vcc
    v_add_u32 v10, v10, v11
    v_sub_u32 v11, 2048, v10
    v_cmp_eq_u32 vcc, 0, v10
    v_mov_b32 v12, 1024
    s_nop 0
    v_cndmask_b32 v11, v11, v12, vcc
    v_cmp_eq_u32 vcc, 1, v13
    s_nop 1
    v_cndmask_b32 v10, v10, v11, vcc
    v_and_b32 v12, 7, v4
    v_mov_b32 v11, 1024
    v_cmp_eq_u32 vcc, s36, v12
    s_nop 1
    v_cndmask_b32 v10, v10, v11, vcc
    v_and_b32 v11, 1, v4
    v_cndmask_b32 v11, v11, 0, vcc
    v_cvt_f32_u32 v11, v11
    v_mul_f32 v11, 0x3e800000, v11
    v_bfe_u32 v12, v10, 5, 1
    v_cvt_f32_u32 v12, v12
    v_cvt_f32_u32 v10, v10
    v_mul_f32 v10, 0x3a000000, v10
    v_cvt_f32_u32 v9, v5
    v_add_f32 v9, v9, v9
    v_fma_f32 v11, v9, v10, v11
    s_cmp_eq_u32 s22, 0
    s_cselect_b32 s40, 0, 0xbe800000
    s_cselect_b32 s41, 1.0, 0
    s_cselect_b32 s42, 0, 1.0
    v_add_f32 v13, s40, v11
    v_mul_f32 v12, s41, v12
    v_sub_f32 v9, 1.0, v12
    v_add_f32 v12, s42, v12
    v_fmamk_f32 v216, v10, 0x00000000, v11
    v_fmamk_f32 v217, v10, 0x00000000, v13
    v_fmamk_f32 v218, v10, 0x3f800000, v11
    v_fmamk_f32 v219, v10, 0x3f800000, v13
    v_fmamk_f32 v220, v10, 0x41000000, v11
    v_fmamk_f32 v221, v10, 0x41000000, v13
    v_fmamk_f32 v222, v10, 0x41100000, v11
    v_fmamk_f32 v223, v10, 0x41100000, v13
    v_fmamk_f32 v224, v10, 0x41800000, v11
    v_fmamk_f32 v225, v10, 0x41800000, v13
    v_fmamk_f32 v226, v10, 0x41880000, v11
    v_fmamk_f32 v227, v10, 0x41880000, v13
    v_fmamk_f32 v228, v10, 0x41c00000, v11
    v_fmamk_f32 v229, v10, 0x41c00000, v13
    v_fmamk_f32 v230, v10, 0x41c80000, v11
    v_fmamk_f32 v231, v10, 0x41c80000, v13
    v_cos_f32 v216, v216
    v_cos_f32 v217, v217
    v_cos_f32 v218, v218
    v_cos_f32 v219, v219
    v_cos_f32 v220, v220
    v_cos_f32 v221, v221
    v_cos_f32 v222, v222
    v_cos_f32 v223, v223
    v_cos_f32 v224, v224
    v_cos_f32 v225, v225
    v_cos_f32 v226, v226
    v_cos_f32 v227, v227
    v_cos_f32 v228, v228
    v_cos_f32 v229, v229
    v_cos_f32 v230, v230
    v_cos_f32 v231, v231
    v_mul_f32 v216, v216, v9
    v_mul_f32 v217, v217, v12
    v_mul_f32 v218, v218, v9
    v_mul_f32 v219, v219, v12
    v_mul_f32 v220, v220, v9
    v_mul_f32 v221, v221, v12
    v_mul_f32 v222, v222, v9
    v_mul_f32 v223, v223, v12
    v_mul_f32 v224, v224, v9
    v_mul_f32 v225, v225, v12
    v_mul_f32 v226, v226, v9
    v_mul_f32 v227, v227, v12
    v_mul_f32 v228, v228, v9
    v_mul_f32 v229, v229, v12
    v_mul_f32 v230, v230, v9
    v_mul_f32 v231, v231, v12
    v_cvt_pk_bf16_f32 v128, v216, v217
    v_cvt_pk_bf16_f32 v129, v218, v219
    v_cvt_pk_bf16_f32 v130, v220, v221
    v_cvt_pk_bf16_f32 v131, v222, v223
    v_cvt_pk_bf16_f32 v132, v224, v225
    v_cvt_pk_bf16_f32 v133, v226, v227
    v_cvt_pk_bf16_f32 v134, v228, v229
    v_cvt_pk_bf16_f32 v135, v230, v231
    v_bfe_u32 v9, v2, 2, 2
    v_lshrrev_b32 v11, 1, v9
    v_lshl_add_u32 v11, v5, 1, v11
    v_lshlrev_b32 v11, 7, v11
    v_and_b32 v9, 1, v9
    v_lshl_add_u32 v11, v9, 6, v11
    v_and_b32 v9, 3, v2
    v_lshl_add_u32 v11, v9, 3, v11
    v_and_b32 v12, 1, v5
    v_lshl_add_u32 v11, v12, 5, v11
    v_add_u32 v9, s28, v11
    v_xor_b32 v11, 32, v9
    s_mul_i32 s30, s3, 640
    s_add_u32 s30, s30, 2632192
    s_lshl_b32 s33, s3, 10
    s_add_u32 s33, s33, 129792
    v_lshrrev_b32 v13, 3, v4
    v_lshl_add_u32 v13, v13, 2, v5
    v_lshlrev_b32 v6, 4, v13
    v_add_u32 v6, s33, v6
    v_and_b32 v12, 7, v4
    v_mul_u32_u24 v12, 1288, v12
    v_lshl_add_u32 v12, v13, 3, v12
    s_mul_i32 s35, s3, 320
    s_add_u32 s35, s35, 116736
    v_add_u32 v12, s35, v12
    s_lshl_b32 s35, s3, 14
    v_bfe_u32 v13, v2, 2, 2
    v_and_b32 v14, 1, v5
    v_lshl_add_u32 v13, v14, 2, v13
    v_lshrrev_b32 v14, 1, v5
    v_lshl_add_u32 v13, v13, 1, v14
    v_mul_u32_u24 v13, 80, v13
    v_and_b32 v14, 3, v2
    v_lshl_add_u32 v13, v14, 3, v13
    s_mul_i32 s38, s3, 2576
    s_add_u32 s38, s38, 116736
    v_add_u32 v234, s38, v13
    v_lshl_add_u32 v13, v5, 6, v4
    v_lshlrev_b32 v13, 2, v13
    s_add_u32 s38, s35, 4096
    v_add_u32 v237, s38, v13
    s_add_u32 s39, s35, 8512
    v_sub_u32 v238, s39, v13
    v_cmp_eq_u32 vcc, 0, v2
    v_subrev_u32 v13, 2560, v238
    s_nop 0
    v_cndmask_b32 v239, v238, v13, vcc
    v_lshlrev_b32 v13, 12, v7
    v_lshl_add_u32 v13, v8, 4, v13
    v_add_u32 v241, s38, v13
    v_lshlrev_b32 v14, 4, v8
    v_add_u32 v14, 137984, v14
    v_add_u32 v15, 146176, v3
    s_lshl_b32 s38, s22, 6
    s_lshl_b32 s39, s23, 3
    s_add_u32 s38, s38, s39
    s_lshl_b32 s39, s3, 1
    s_add_u32 s38, s38, s39
    s_mul_i32 s38, s38, 1280
    s_add_u32 s39, s38, 12582912
    s_add_u32 s38, s38, 9437184
    v_mul_u32_u24 v10, 1280, v7
    v_lshl_add_u32 v10, v8, 3, v10
    s_waitcnt vmcnt(0)
    s_lshl_b32 s92, s3, 12
    s_mov_b32 s93, s94
K_p1:
    s_mul_hi_u32 s87, s93, 0xaaaaaab
    s_mul_i32 s88, s87, 24
    s_sub_u32 s88, s93, s88
    s_lshr_b32 s89, s3, 1
    s_lshl_b32 s86, s88, 1
    s_add_u32 s89, s89, s86
    s_and_b32 s90, s3, 1
    s_lshl_b32 s91, s87, 1
    s_add_u32 s90, s90, s91
    s_mul_i32 s86, s89, 40960
    s_lshl_b32 s90, s90, 7
    s_add_u32 s86, s86, s90
    s_add_u32 m0, s92, 0
    s_add_u32 s90, s86, 0
    buffer_load_dwordx4 v120, s[60:63], s90 offen  lds
    s_add_u32 m0, s92, 1024
    s_add_u32 s90, s86, 10240
    buffer_load_dwordx4 v120, s[60:63], s90 offen  lds
    s_add_u32 m0, s92, 2048
    s_add_u32 s90, s86, 20480
    buffer_load_dwordx4 v120, s[60:63], s90 offen  lds
    s_add_u32 m0, s92, 3072
    s_add_u32 s90, s86, 30720
    buffer_load_dwordx4 v120, s[60:63], s90 offen  lds
    s_add_u32 s92, s92, 16384
    s_add_u32 s93, s93, 68
    s_cmp_lt_u32 s93, 120
    s_cbranch_scc1 K_p1
    v_bfe_u32 v216, v2, 2, 2
    v_and_b32 v217, 3, v2
    v_lshl_add_u32 v218, v5, 3, v216
    v_lshlrev_b32 v218, 7, v218
    v_lshl_add_u32 v218, v217, 3, v218
    s_lshl_b32 s92, s3, 12
    s_mov_b32 s93, s94
    s_waitcnt vmcnt(0)
K_p4:
    s_mul_hi_u32 s87, s93, 0xaaaaaab
    s_mul_i32 s88, s87, 24
    s_sub_u32 s88, s93, s88
    s_lshr_b32 s89, s3, 1
    s_lshl_b32 s86, s88, 1
    s_add_u32 s89, s89, s86
    s_mul_i32 s89, s89, 5120
    s_add_u32 s89, s89, 7340032
    s_and_b32 s90, s3, 1
    s_lshl_b32 s87, s87, 1
    s_add_u32 s87, s87, s90
    s_lshl_b32 s87, s87, 2
    v_add_u32 v219, s92, v218
    ds_read_b64_tr_b16 v[16:17], v219 offset:0
    ds_read_b64_tr_b16 v[18:19], v219 offset:512
    ds_read_b64_tr_b16 v[20:21], v219 offset:32
    ds_read_b64_tr_b16 v[22:23], v219 offset:544
    ds_read_b64_tr_b16 v[24:25], v219 offset:64
    ds_read_b64_tr_b16 v[26:27], v219 offset:576
    ds_read_b64_tr_b16 v[28:29], v219 offset:96
    ds_read_b64_tr_b16 v[30:31], v219 offset:608
    s_mul_hi_u32 s90, s87, 0x33333334
    s_mul_i32 s91, s90, 5
    s_sub_u32 s91, s87, s91
    s_mul_i32 s90, s90, 245760
    s_lshl_b32 s91, s91, 10
    s_add_u32 s90, s90, s91
    s_add_u32 s96, s90, s89
    s_add_u32 s87, s87, 1
    s_mul_hi_u32 s90, s87, 0x33333334
    s_mul_i32 s91, s90, 5
    s_sub_u32 s91, s87, s91
    s_mul_i32 s90, s90, 245760
    s_lshl_b32 s91, s91, 10
    s_add_u32 s90, s90, s91
    s_add_u32 s97, s90, s89
    s_add_u32 s87, s87, 1
    s_mul_hi_u32 s90, s87, 0x33333334
    s_mul_i32 s91, s90, 5
    s_sub_u32 s91, s87, s91
    s_mul_i32 s90, s90, 245760
    s_lshl_b32 s91, s91, 10
    s_add_u32 s90, s90, s91
    s_add_u32 s98, s90, s89
    s_add_u32 s87, s87, 1
    s_mul_hi_u32 s90, s87, 0x33333334
    s_mul_i32 s91, s90, 5
    s_sub_u32 s91, s87, s91
    s_mul_i32 s90, s90, 245760
    s_lshl_b32 s91, s91, 10
    s_add_u32 s90, s90, s91
    s_add_u32 s99, s90, s89
    s_add_u32 s87, s87, 1
    s_waitcnt lgkmcnt(6)
    buffer_store_dwordx4 v[16:19], v3, s[16:19], s96 offen sc1
    s_waitcnt lgkmcnt(4)
    buffer_store_dwordx4 v[20:23], v3, s[16:19], s97 offen sc1
    s_waitcnt lgkmcnt(2)
    buffer_store_dwordx4 v[24:27], v3, s[16:19], s98 offen sc1
    s_waitcnt lgkmcnt(0)
    buffer_store_dwordx4 v[28:31], v3, s[16:19], s99 offen sc1
    s_add_u32 s92, s92, 16384
    s_add_u32 s93, s93, 68
    s_cmp_lt_u32 s93, 120
    s_cbranch_scc1 K_p4
    v_mov_b32 v252, 0
    global_load_dword v253, v252, s[56:57]
    s_branch K_join
K_x8:
K_g0:
    s_load_dword s40, s[56:57], 0 glc
    s_add_u32 s41, s41, 1
    s_cmp_gt_u32 s41, 0x40000
    s_cbranch_scc1 K_g8b
    s_waitcnt lgkmcnt(0)
    s_cmp_lt_u32 s40, 8
    s_cbranch_scc1 K_g0
K_g8b:
    s_waitcnt lgkmcnt(0)
    s_branch K_g2
K_x9:
    s_sub_u32 s40, s2, 192
    s_mul_i32 s40, s40, 30720
    s_and_b32 s41, s3, 1
    s_mul_i32 s41, s41, 15360
    s_add_u32 s40, s40, s41
    v_lshlrev_b32 v216, 7, v2
    v_add_u32 v217, 8192, v216
    v_min_u32 v217, 15232, v217
    buffer_load_dword v254, v216, s[4:7], s40 offen
    buffer_load_dword v255, v217, s[4:7], s40 offen
    s_branch K_g9
K_x0:
    s_sub_u32 s30, s30, 2560
    s_add_u32 m0, s33, 4096
    s_nop 0
    buffer_load_dwordx4 v3, s[16:19], s30 offen sc1 lds
    s_waitcnt vmcnt(0)
    s_branch K_c0
K_x10:
    ds_read_b128 v[16:19], v6 offset:4096
    s_mov_b32 s40, 0x01010101
    s_mov_b32 s41, 0x01010101
    s_waitcnt lgkmcnt(0)
    s_mov_b64 exec, s[40:41]
    v_add_f32 v56, v56, v16
    v_add_f32 v57, v57, v17
    v_add_f32 v58, v58, v18
    v_add_f32 v59, v59, v19
    s_mov_b64 exec, -1
    s_nop 0
    s_branch K_c10
K_x11:
    ds_read_b128 v[20:23], v6 offset:4224
    s_mov_b32 s40, 0x01010101
    s_mov_b32 s41, 0x01010101
    s_waitcnt lgkmcnt(0)
    s_mov_b64 exec, s[40:41]
    v_add_f32 v60, v60, v20
    v_add_f32 v61, v61, v21
    v_add_f32 v62, v62, v22
    v_add_f32 v63, v63, v23
    s_mov_b64 exec, -1
    s_nop 0
    s_branch K_c11
K_x12:
    ds_read_b128 v[24:27], v6 offset:4352
    s_mov_b32 s40, 0x01010101
    s_mov_b32 s41, 0x01010101
    s_waitcnt lgkmcnt(0)
    s_mov_b64 exec, s[40:41]
    v_add_f32 v64, v64, v24
    v_add_f32 v65, v65, v25
    v_add_f32 v66, v66, v26
    v_add_f32 v67, v67, v27
    s_mov_b64 exec, -1
    s_nop 0
    s_branch K_c12
K_x13:
    ds_read_b128 v[28:31], v6 offset:4480
    s_mov_b32 s40, 0x01010101
    s_mov_b32 s41, 0x01010101
    s_waitcnt lgkmcnt(0)
    s_mov_b64 exec, s[40:41]
    v_add_f32 v68, v68, v28
    v_add_f32 v69, v69, v29
    v_add_f32 v70, v70, v30
    v_add_f32 v71, v71, v31
    s_mov_b64 exec, -1
    s_nop 0
    s_branch K_c13
K_x14:
    ds_read_b128 v[32:35], v6 offset:4608
    s_mov_b32 s40, 0x01010101
    s_mov_b32 s41, 0x01010101
    s_waitcnt lgkmcnt(0)
    s_mov_b64 exec, s[40:41]
    v_add_f32 v72, v72, v32
    v_add_f32 v73, v73, v33
    v_add_f32 v74, v74, v34
    v_add_f32 v75, v75, v35
    s_mov_b64 exec, -1
    s_nop 0
    s_branch K_c14
K_c2:
    ds_read_b64_tr_b16 v[56:57], v234 offset:0
    v_mov_b32 v58, 0
    v_mov_b32 v59, 0
    ds_read_b64_tr_b16 v[60:61], v234 offset:32
    v_mov_b32 v62, 0
    v_mov_b32 v63, 0
    ds_read_b64_tr_b16 v[64:65], v234 offset:64
    v_mov_b32 v66, 0
    v_mov_b32 v67, 0
    ds_read_b128 v[16:19], v14 offset:0
    ds_read_b128 v[20:23], v14 offset:512
    ds_read_b128 v[24:27], v14 offset:1024
    ds_read_b128 v[28:31], v14 offset:1536
    ds_read_b128 v[32:35], v14 offset:2048
    s_mul_i32 s53, s50, 196608
    s_add_u32 s53, s53, s44
    s_add_u32 s50, s50, 1
    s_cmp_eq_u32 s50, 10
    s_cselect_b32 s50, 0, s50
    s_add_u32 m0, s52, 0
    s_nop 0
    buffer_load_dwordx4 v248, s[4:7], s53 offen lds
    s_add_u32 m0, s52, 1024
    s_nop 0
    buffer_load_dwordx4 v249, s[4:7], s53 offen lds
    s_waitcnt lgkmcnt(7)
    v_mfma_f32_16x16x32_bf16 v[68:71], v[56:59], v[136:139], 0
    v_mfma_f32_16x16x32_bf16 v[72:75], v[56:59], v[140:143], 0
    s_waitcnt lgkmcnt(6)
    v_mfma_f32_16x16x32_bf16 v[76:79], v[60:63], v[136:139], 0
    v_mfma_f32_16x16x32_bf16 v[80:83], v[60:63], v[140:143], 0
    s_waitcnt lgkmcnt(5)
    v_mfma_f32_16x16x32_bf16 v[84:87], v[64:67], v[136:139], 0
    v_mfma_f32_16x16x32_bf16 v[88:91], v[64:67], v[140:143], 0
    ds_read_b128 v[214:217], v14 offset:2560
    ds_read_b128 v[218:221], v14 offset:3072
    ds_read_b128 v[222:225], v14 offset:3584
    ds_read_b128 v[226:229], v14 offset:4096
    ds_read_b128 v[230:233], v14 offset:4608
    ds_read_b128 v[36:39], v14 offset:5120
    ds_read_b128 v[40:43], v14 offset:5632
    ds_read_b128 v[44:47], v14 offset:6144
    ds_read_b128 v[48:51], v14 offset:6656
    ds_read_b128 v[52:55], v14 offset:7168
    s_add_u32 m0, s52, 2048
    s_nop 0
    buffer_load_dwordx4 v250, s[4:7], s53 offen lds
    s_add_u32 m0, s52, 3072
    s_add_u32 s53, s53, 49152
    buffer_load_dwordx4 v248, s[4:7], s53 offen lds
    v_pk_mul_f32 v[120:121], v[68:69], v[144:145]
    v_pk_mul_f32 v[124:125], v[72:73], v[144:145]
    v_pk_mul_f32 v[122:123], v[70:71], v[146:147]
    v_pk_mul_f32 v[126:127], v[74:75], v[146:147]
    v_pk_fma_f32 v[120:121], v[72:73], v[148:149], v[120:121]
    v_pk_fma_f32 v[124:125], v[68:69], v[148:149], v[124:125] neg_lo:[1,0,0] neg_hi:[1,0,0]
    v_pk_fma_f32 v[122:123], v[74:75], v[150:151], v[122:123]
    v_pk_fma_f32 v[126:127], v[70:71], v[150:151], v[126:127] neg_lo:[1,0,0] neg_hi:[1,0,0]
    v_cvt_pk_bf16_f32 v56, v120, v124
    v_cvt_pk_bf16_f32 v57, v121, v125
    v_cvt_pk_bf16_f32 v58, v122, v126
    v_cvt_pk_bf16_f32 v59, v123, v127
    s_add_u32 m0, s52, 4096
    s_nop 0
    buffer_load_dwordx4 v249, s[4:7], s53 offen lds
    s_add_u32 m0, s52, 5120
    s_nop 0
    buffer_load_dwordx4 v250, s[4:7], s53 offen lds
    v_pk_mul_f32 v[120:121], v[76:77], v[152:153]
    v_pk_mul_f32 v[124:125], v[80:81], v[152:153]
    v_pk_mul_f32 v[122:123], v[78:79], v[154:155]
    v_pk_mul_f32 v[126:127], v[82:83], v[154:155]
    v_pk_fma_f32 v[120:121], v[80:81], v[156:157], v[120:121]
    v_pk_fma_f32 v[124:125], v[76:77], v[156:157], v[124:125] neg_lo:[1,0,0] neg_hi:[1,0,0]
    v_pk_fma_f32 v[122:123], v[82:83], v[158:159], v[122:123]
    v_pk_fma_f32 v[126:127], v[78:79], v[158:159], v[126:127] neg_lo:[1,0,0] neg_hi:[1,0,0]
    v_cvt_pk_bf16_f32 v60, v120, v124
    v_cvt_pk_bf16_f32 v61, v121, v125
    v_cvt_pk_bf16_f32 v62, v122, v126
    v_cvt_pk_bf16_f32 v63, v123, v127
    v_pk_mul_f32 v[120:121], v[84:85], v[160:161]
    v_pk_mul_f32 v[124:125], v[88:89], v[160:161]
    v_pk_mul_f32 v[122:123], v[86:87], v[162:163]
    v_pk_mul_f32 v[126:127], v[90:91], v[162:163]
    v_pk_fma_f32 v[120:121], v[88:89], v[164:165], v[120:121]
    v_pk_fma_f32 v[124:125], v[84:85], v[164:165], v[124:125] neg_lo:[1,0,0] neg_hi:[1,0,0]
    v_pk_fma_f32 v[122:123], v[90:91], v[166:167], v[122:123]
    v_pk_fma_f32 v[126:127], v[86:87], v[166:167], v[126:127] neg_lo:[1,0,0] neg_hi:[1,0,0]
    v_cvt_pk_bf16_f32 v64, v120, v124
    v_cvt_pk_bf16_f32 v65, v121, v125
    v_cvt_pk_bf16_f32 v66, v122, v126
    v_cvt_pk_bf16_f32 v67, v123, v127
    s_mov_b32 exec_lo, 0
    v_mov_b32 v64, 0
    v_mov_b32 v65, 0
    v_mov_b32 v66, 0
    v_mov_b32 v67, 0
    s_mov_b64 exec, -1
    v_mfma_f32_16x16x32_bf16 v[68:71], v[168:171], v[56:59], 0
    v_mfma_f32_16x16x32_bf16 v[72:75], v[180:183], v[56:59], 0
    v_mfma_f32_16x16x32_bf16 v[76:79], v[192:195], v[56:59], 0
    v_mfma_f32_16x16x32_bf16 v[68:71], v[172:175], v[60:63], v[68:71]
    v_mfma_f32_16x16x32_bf16 v[72:75], v[184:187], v[60:63], v[72:75]
    v_mfma_f32_16x16x32_bf16 v[76:79], v[196:199], v[60:63], v[76:79]
    v_mfma_f32_16x16x32_bf16 v[68:71], v[176:179], v[64:67], v[68:71]
    v_mfma_f32_16x16x32_bf16 v[72:75], v[188:191], v[64:67], v[72:75]
    v_mfma_f32_16x16x32_bf16 v[76:79], v[200:203], v[64:67], v[76:79]
    buffer_load_dwordx4 a[0:3], v3, s[16:19], s86 offen offset:0 sc1
    buffer_load_dwordx4 a[4:7], v3, s[16:19], s86 offen offset:1024 sc1
    s_nop 3
    ds_write_b32 v237, v68 offset:0
    ds_write_b32 v237, v69 offset:64
    ds_write_b32 v237, v70 offset:128
    ds_write_b32 v237, v71 offset:192
    ds_write_b32 v237, v72 offset:1024
    ds_write_b32 v237, v73 offset:1088
    ds_write_b32 v237, v74 offset:1152
    ds_write_b32 v237, v75 offset:1216
    s_mov_b32 exec_hi, 0
    ds_write_b32 v237, v76 offset:2048
    ds_write_b32 v237, v77 offset:2112
    ds_write_b32 v237, v78 offset:2176
    ds_write_b32 v237, v79 offset:2240
    s_mov_b64 exec, -1
    ds_read_b64_tr_b16 v[56:57], v234 offset:1288
    v_mov_b32 v58, 0
    v_mov_b32 v59, 0
    ds_read_b64_tr_b16 v[60:61], v234 offset:1320
    v_mov_b32 v62, 0
    v_mov_b32 v63, 0
    ds_read_b64_tr_b16 v[64:65], v234 offset:1352
    v_mov_b32 v66, 0
    v_mov_b32 v67, 0
    s_waitcnt lgkmcnt(2)
    v_mfma_f32_16x16x32_bf16 v[68:71], v[56:59], v[136:139], 0
    v_mfma_f32_16x16x32_bf16 v[72:75], v[56:59], v[140:143], 0
    s_waitcnt lgkmcnt(1)
    v_mfma_f32_16x16x32_bf16 v[76:79], v[60:63], v[136:139], 0
    v_mfma_f32_16x16x32_bf16 v[80:83], v[60:63], v[140:143], 0
    s_waitcnt lgkmcnt(0)
    v_mfma_f32_16x16x32_bf16 v[84:87], v[64:67], v[136:139], 0
    v_mfma_f32_16x16x32_bf16 v[88:91], v[64:67], v[140:143], 0
    s_nop 0
    v_pk_mul_f32 v[120:121], v[68:69], v[144:145]
    v_pk_mul_f32 v[124:125], v[72:73], v[144:145]
    v_pk_mul_f32 v[122:123], v[70:71], v[146:147]
    v_pk_mul_f32 v[126:127], v[74:75], v[146:147]
    v_pk_fma_f32 v[120:121], v[72:73], v[148:149], v[120:121]
    v_pk_fma_f32 v[124:125], v[68:69], v[148:149], v[124:125] neg_lo:[1,0,0] neg_hi:[1,0,0]
    v_pk_fma_f32 v[122:123], v[74:75], v[150:151], v[122:123]
    v_pk_fma_f32 v[126:127], v[70:71], v[150:151], v[126:127] neg_lo:[1,0,0] neg_hi:[1,0,0]
    v_cvt_pk_bf16_f32 v56, v120, v124
    v_cvt_pk_bf16_f32 v57, v121, v125
    v_cvt_pk_bf16_f32 v58, v122, v126
    v_cvt_pk_bf16_f32 v59, v123, v127
    v_pk_mul_f32 v[120:121], v[76:77], v[152:153]
    v_pk_mul_f32 v[124:125], v[80:81], v[152:153]
    v_pk_mul_f32 v[122:123], v[78:79], v[154:155]
    v_pk_mul_f32 v[126:127], v[82:83], v[154:155]
    v_pk_fma_f32 v[120:121], v[80:81], v[156:157], v[120:121]
    v_pk_fma_f32 v[124:125], v[76:77], v[156:157], v[124:125] neg_lo:[1,0,0] neg_hi:[1,0,0]
    v_pk_fma_f32 v[122:123], v[82:83], v[158:159], v[122:123]
    v_pk_fma_f32 v[126:127], v[78:79], v[158:159], v[126:127] neg_lo:[1,0,0] neg_hi:[1,0,0]
    v_cvt_pk_bf16_f32 v60, v120, v124
    v_cvt_pk_bf16_f32 v61, v121, v125
    v_cvt_pk_bf16_f32 v62, v122, v126
    v_cvt_pk_bf16_f32 v63, v123, v127
    v_pk_mul_f32 v[120:121], v[84:85], v[160:161]
    v_pk_mul_f32 v[124:125], v[88:89], v[160:161]
    v_pk_mul_f32 v[122:123], v[86:87], v[162:163]
    v_pk_mul_f32 v[126:127], v[90:91], v[162:163]
    v_pk_fma_f32 v[120:121], v[88:89], v[164:165], v[120:121]
    v_pk_fma_f32 v[124:125], v[84:85], v[164:165], v[124:125] neg_lo:[1,0,0] neg_hi:[1,0,0]
    v_pk_fma_f32 v[122:123], v[90:91], v[166:167], v[122:123]
    v_pk_fma_f32 v[126:127], v[86:87], v[166:167], v[126:127] neg_lo:[1,0,0] neg_hi:[1,0,0]
    v_cvt_pk_bf16_f32 v64, v120, v124
    v_cvt_pk_bf16_f32 v65, v121, v125
    v_cvt_pk_bf16_f32 v66, v122, v126
    v_cvt_pk_bf16_f32 v67, v123, v127
    s_mov_b32 exec_lo, 0
    v_mov_b32 v64, 0
    v_mov_b32 v65, 0
    v_mov_b32 v66, 0
    v_mov_b32 v67, 0
    s_mov_b64 exec, -1
    v_mfma_f32_16x16x32_bf16 v[68:71], v[168:171], v[56:59], 0
    v_mfma_f32_16x16x32_bf16 v[72:75], v[180:183], v[56:59], 0
    v_mfma_f32_16x16x32_bf16 v[76:79], v[192:195], v[56:59], 0
    v_mfma_f32_16x16x32_bf16 v[68:71], v[172:175], v[60:63], v[68:71]
    v_mfma_f32_16x16x32_bf16 v[72:75], v[184:187], v[60:63], v[72:75]
    v_mfma_f32_16x16x32_bf16 v[76:79], v[196:199], v[60:63], v[76:79]
    v_mfma_f32_16x16x32_bf16 v[68:71], v[176:179], v[64:67], v[68:71]
    v_mfma_f32_16x16x32_bf16 v[72:75], v[188:191], v[64:67], v[72:75]
    v_mfma_f32_16x16x32_bf16 v[76:79], v[200:203], v[64:67], v[76:79]
    s_nop 5
    ds_write_b32 v237, v68 offset:4096
    ds_write_b32 v237, v69 offset:4160
    ds_write_b32 v237, v70 offset:4224
    ds_write_b32 v237, v71 offset:4288
    ds_write_b32 v237, v72 offset:5120
    ds_write_b32 v237, v73 offset:5184
    ds_write_b32 v237, v74 offset:5248
    ds_write_b32 v237, v75 offset:5312
    s_mov_b32 exec_hi, 0
    ds_write_b32 v237, v76 offset:6144
    ds_write_b32 v237, v77 offset:6208
    ds_write_b32 v237, v78 offset:6272
    ds_write_b32 v237, v79 offset:6336
    s_mov_b64 exec, -1
    s_branch K_c3
.p2align 8
.type K2_table,@object
K2_table:
.long 0x3f803f80,0x3f803f80,0x0,0x0,0x3f353f80,0xbf350000,0x3f350000,0x3f353f80
.long 0x3f80,0xbf80,0x3f800000,0xbf800000,0xbf353f80,0x3f350000,0x3f350000,0x3f35bf80
.long 0xbf803f80,0xbf803f80,0x0,0x0,0xbf353f80,0x3f350000,0xbf350000,0xbf353f80
.long 0x3f80,0xbf80,0xbf800000,0x3f800000,0x3f353f80,0xbf350000,0xbf350000,0xbf35bf80
.long 0x3f803f80,0x3f803f80,0x0,0x0,0x3f353f80,0xbf350000,0x3f350000,0x3f353f80
.long 0x3f80,0xbf80,0x3f800000,0xbf800000,0xbf353f80,0x3f350000,0x3f350000,0x3f35bf80
.long 0xbf803f80,0xbf803f80,0x0,0x0,0xbf353f80,0x3f350000,0xbf350000,0xbf353f80
.long 0x3f80,0xbf80,0xbf800000,0x3f800000,0x3f353f80,0xbf350000,0xbf350000,0xbf35bf80
.long 0x3f803f80,0x3f803f80,0x0,0x0,0xbf35bf80,0x3f350000,0xbf350000,0xbf35bf80
.long 0x3f80,0xbf80,0x3f800000,0xbf800000,0x3f35bf80,0xbf350000,0xbf350000,0xbf353f80
.long 0xbf803f80,0xbf803f80,0x0,0x0,0x3f35bf80,0xbf350000,0x3f350000,0x3f35bf80
.long 0x3f80,0xbf80,0xbf800000,0x3f800000,0xbf35bf80,0x3f350000,0x3f350000,0x3f353f80
.long 0x3f803f80,0x3f803f80,0x0,0x0,0xbf35bf80,0x3f350000,0xbf350000,0xbf35bf80
.long 0x3f80,0xbf80,0x3f800000,0xbf800000,0x3f35bf80,0xbf350000,0xbf350000,0xbf353f80
.long 0xbf803f80,0xbf803f80,0x0,0x0,0x3f35bf80,0xbf350000,0x3f350000,0x3f35bf80
.long 0x3f80,0xbf80,0xbf800000,0x3f800000,0xbf35bf80,0x3f350000,0x3f350000,0x3f353f80
.long 0x3f803f80,0x3f803f80,0x0,0x0,0x3ec43f6d,0xbf6dbec4,0x3f6d3ec4,0x3ec43f6d
.long 0xbf353f35,0x3f35bf35,0x3f353f35,0xbf35bf35,0xbf6d3ec4,0xbec43f6d,0xbec43f6d,0x3f6dbec4
.long 0x0,0x0,0xbf803f80,0xbf803f80,0x3f6dbec4,0x3ec4bf6d,0xbec43f6d,0x3f6dbec4
.long 0x3f35bf35,0xbf353f35,0x3f353f35,0xbf35bf35,0xbec4bf6d,0x3f6d3ec4,0x3f6d3ec4,0x3ec43f6d
.long 0xbf80bf80,0xbf80bf80,0x0,0x0,0xbec4bf6d,0x3f6d3ec4,0xbf6dbec4,0xbec4bf6d
.long 0x3f35bf35,0xbf353f35,0xbf35bf35,0x3f353f35,0x3f6dbec4,0x3ec4bf6d,0x3ec4bf6d,0xbf6d3ec4
.long 0x0,0x0,0x3f80bf80,0x3f80bf80,0xbf6d3ec4,0xbec43f6d,0x3ec4bf6d,0xbf6d3ec4
.long 0xbf353f35,0x3f35bf35,0xbf35bf35,0x3f353f35,0x3ec43f6d,0xbf6dbec4,0xbf6dbec4,0xbec4bf6d
.long 0x3f803f80,0x3f803f80,0x0,0x0,0xbec4bf6d,0x3f6d3ec4,0xbf6dbec4,0xbec4bf6d
.long 0xbf353f35,0x3f35bf35,0x3f353f35,0xbf35bf35,0x3f6dbec4,0x3ec4bf6d,0x3ec4bf6d,0xbf6d3ec4
.long 0x0,0x0,0xbf803f80,0xbf803f80,0xbf6d3ec4,0xbec43f6d,0x3ec4bf6d,0xbf6d3ec4
.long 0x3f35bf35,0xbf353f35,0x3f353f35,0xbf35bf35,0x3ec43f6d,0xbf6dbec4,0xbf6dbec4,0xbec4bf6d
.long 0xbf80bf80,0xbf80bf80,0x0,0x0,0x3ec43f6d,0xbf6dbec4,0x3f6d3ec4,0x3ec43f6d
.long 0x3f35bf35,0xbf353f35,0xbf35bf35,0x3f353f35,0xbf6d3ec4,0xbec43f6d,0xbec43f6d,0x3f6dbec4
.long 0x0,0x0,0x3f80bf80,0x3f80bf80,0x3f6dbec4,0x3ec4bf6d,0xbec43f6d,0x3f6dbec4
.long 0xbf353f35,0x3f35bf35,0xbf35bf35,0x3f353f35,0xbec4bf6d,0x3f6d3ec4,0x3f6d3ec4,0x3ec43f6d
.long 0x0,0x0,0x3f803f80,0x3f803f80,0xbf350000,0xbf35bf80,0x3f353f80,0xbf350000
.long 0xbf800000,0x3f800000,0x3f80,0xbf80,0xbf350000,0xbf353f80,0xbf353f80,0x3f350000
.long 0x0,0x0,0xbf803f80,0xbf803f80,0x3f350000,0x3f35bf80,0xbf353f80,0x3f350000
.long 0x3f800000,0xbf800000,0x3f80,0xbf80,0x3f350000,0x3f353f80,0x3f353f80,0xbf350000
.long 0x0,0x0,0x3f803f80,0x3f803f80,0xbf350000,0xbf35bf80,0x3f353f80,0xbf350000
.long 0xbf800000,0x3f800000,0x3f80,0xbf80,0xbf350000,0xbf353f80,0xbf353f80,0x3f350000
.long 0x0,0x0,0xbf803f80,0xbf803f80,0x3f350000,0x3f35bf80,0xbf353f80,0x3f350000
.long 0x3f800000,0xbf800000,0x3f80,0xbf80,0x3f350000,0x3f353f80,0x3f353f80,0xbf350000
.long 0x0,0x0,0x3f803f80,0x3f803f80,0x3f350000,0x3f353f80,0xbf35bf80,0x3f350000
.long 0xbf800000,0x3f800000,0x3f80,0xbf80,0x3f350000,0x3f35bf80,0x3f35bf80,0xbf350000
.long 0x0,0x0,0xbf803f80,0xbf803f80,0xbf350000,0xbf353f80,0x3f35bf80,0xbf350000
.long 0x3f800000,0xbf800000,0x3f80,0xbf80,0xbf350000,0xbf35bf80,0xbf35bf80,0x3f350000
.long 0x0,0x0,0x3f803f80,0x3f803f80,0x3f350000,0x3f353f80,0xbf35bf80,0x3f350000
.long 0xbf800000,0x3f800000,0x3f80,0xbf80,0x3f350000,0x3f35bf80,0x3f35bf80,0xbf350000
.long 0x0,0x0,0xbf803f80,0xbf803f80,0xbf350000,0xbf353f80,0x3f35bf80,0xbf350000
.long 0x3f800000,0xbf800000,0x3f80,0xbf80,0xbf350000,0xbf35bf80,0xbf35bf80,0x3f350000
.long 0x0,0x0,0x3f803f80,0x3f803f80,0xbf6dbec4,0xbec4bf6d,0x3ec43f6d,0xbf6dbec4
.long 0xbf35bf35,0x3f353f35,0xbf353f35,0x3f35bf35,0x3ec4bf6d,0xbf6d3ec4,0xbf6d3ec4,0xbec43f6d
.long 0x3f80bf80,0x3f80bf80,0x0,0x0,0x3ec4bf6d,0xbf6d3ec4,0x3f6dbec4,0x3ec4bf6d
.long 0xbf35bf35,0x3f353f35,0x3f35bf35,0xbf353f35,0xbf6dbec4,0xbec4bf6d,0xbec4bf6d,0x3f6d3ec4
.long 0x0,0x0,0xbf80bf80,0xbf80bf80,0x3f6d3ec4,0x3ec43f6d,0xbec4bf6d,0x3f6d3ec4
.long 0x3f353f35,0xbf35bf35,0x3f35bf35,0xbf353f35,0xbec43f6d,0x3f6dbec4,0x3f6dbec4,0x3ec4bf6d
.long 0xbf803f80,0xbf803f80,0x0,0x0,0xbec43f6d,0x3f6dbec4,0xbf6d3ec4,0xbec43f6d
.long 0x3f353f35,0xbf35bf35,0xbf353f35,0x3f35bf35,0x3f6d3ec4,0x3ec43f6d,0x3ec43f6d,0xbf6dbec4
.long 0x0,0x0,0x3f803f80,0x3f803f80,0x3f6d3ec4,0x3ec43f6d,0xbec4bf6d,0x3f6d3ec4
.long 0xbf35bf35,0x3f353f35,0xbf353f35,0x3f35bf35,0xbec43f6d,0x3f6dbec4,0x3f6dbec4,0x3ec4bf6d
.long 0x3f80bf80,0x3f80bf80,0x0,0x0,0xbec43f6d,0x3f6dbec4,0xbf6d3ec4,0xbec43f6d
.long 0xbf35bf35,0x3f353f35,0x3f35bf35,0xbf353f35,0x3f6d3ec4,0x3ec43f6d,0x3ec43f6d,0xbf6dbec4
.long 0x0,0x0,0xbf80bf80,0xbf80bf80,0xbf6dbec4,0xbec4bf6d,0x3ec43f6d,0xbf6dbec4
.long 0x3f353f35,0xbf35bf35,0x3f35bf35,0xbf353f35,0x3ec4bf6d,0xbf6d3ec4,0xbf6d3ec4,0xbec43f6d
.long 0xbf803f80,0xbf803f80,0x0,0x0,0x3ec4bf6d,0xbf6d3ec4,0x3f6dbec4,0x3ec4bf6d
.long 0x3f353f35,0xbf35bf35,0xbf353f35,0x3f35bf35,0xbf6dbec4,0xbec4bf6d,0xbec4bf6d,0x3f6d3ec4
.long 0x3f800000,0x3f800000,0x3f800000,0x3f800000,0x3f800000,0x3f7ffcd7,0x3f7ff35e,0x3f7fe394
.long 0x3f800000,0x3f7ff35e,0x3f7fcd79,0x3f7f8e56,0x3f800000,0x3f7fe394,0x3f7f8e56,0x3f7f0059
.long 0x3f800000,0x3f7fcd79,0x3f7f35f9,0x3f7e39bc,0x3f800000,0x3f7fb10f,0x3f7ec46d,0x3f7d3aac
.long 0x3f800000,0x3f7f8e56,0x3f7e39bc,0x3f7c0361,0x3f800000,0x3f7f654e,0x3f7d95f4,0x3f7a9421
.long 0x3f800000,0x3f7f35f9,0x3f7cd925,0x3f78ed3c,0x3f800000,0x3f7f0059,0x3f7c0361,0x3f770f11
.long 0x3f800000,0x3f7ec46d,0x3f7b14be,0x3f74fa0b,0x3f800000,0x3f7e8238,0x3f7a0d54,0x3f72ae9e
.long 0x3f800000,0x3f7e39bc,0x3f78ed3c,0x3f702d4f,0x3f800000,0x3f7deafa,0x3f77b493,0x3f6d76aa
.long 0x3f800000,0x3f7d95f4,0x3f766377,0x3f6a8b4b,0x3f800000,0x3f7d3aac,0x3f74fa0b,0x3f676bd8
.long 0x3f800000,0x3f800000,0x3f800000,0x3f800000,0x3f7fcd79,0x3f7fb10f,0x3f7f8e56,0x3f7f654e
.long 0x3f7f35f9,0x3f7ec46d,0x3f7e39bc,0x3f7d95f4,0x3f7e39bc,0x3f7d3aac,0x3f7c0361,0x3f7a9421
.long 0x3f7cd925,0x3f7b14be,0x3f78ed3c,0x3f766377,0x3f7b14be,0x3f7853f8,0x3f74fa0b,0x3f710908
.long 0x3f78ed3c,0x3f74fa0b,0x3f702d4f,0x3f6a8b4b,0x3f766377,0x3f710908,0x3f6a8b4b,0x3f62f219
.long 0x3f737871,0x3f6c835e,0x3f641901,0x3f5a46a0,0x3f702d4f,0x3f676bd8,0x3f5cdc29,0x3f50935b
.long 0x3f6c835e,0x3f61c598,0x3f54db31,0x3f45e403,0x3f687c12,0x3f5b941a,0x3f4c1d35,0x3f3a4582
.long 0x3f641901,0x3f54db31,0x3f42a9f7,0x3f2dc5e3,0x3f5f5be6,0x3f4d9f02,0x3f3889dc,0x3f207440
.long 0x3f5a46a0,0x3f45e403,0x3f2dc5e3,0x3f1260b2,0x3f54db31,0x3f3daef9,0x3f226799,0x3f039c3d
.long 0x3f800000,0x3f800000,0x3f800000,0x3f800000,0x3f7f35f9,0x3f7f0059,0x3f7ec46d,0x3f7e8238
.long 0x3f7cd925,0x3f7c0361,0x3f7b14be,0x3f7a0d54,0x3f78ed3c,0x3f770f11,0x3f74fa0b,0x3f72ae9e
.long 0x3f737871,0x3f702d4f,0x3f6c835e,0x3f687c12,0x3f6c835e,0x3f676bd8,0x3f61c598,0x3f5b941a
.long 0x3f641901,0x3f5cdc29,0x3f54db31,0x3f4c1d35,0x3f5a46a0,0x3f50935b,0x3f45e403,0x3f3a4582
.long 0x3f4f1bbd,0x3f42a9f7,0x3f3504f3,0x3f26423a,0x3f42a9f7,0x3f333bc6,0x3f226799,0x3f104f0e
.long 0x3f3504f3,0x3f226799,0x3f0e39da,0x3ef15aea,0x3f26423a,0x3f104f0e,0x3ef15aea,0x3ebf47d7
.long 0x3f167918,0x3efa2c90,0x3ec3ef15,0x3e8afa3e,0x3f05c277,0x3ed1c759,0x3e94a031,0x3e2a1c3f
.long 0x3ee87171,0x3ea7bf25,0x3e47c5c2,0x3d712283,0x3ec3ef15,0x3e78cfcc,0x3dc8bd36,0xbd48fb30
.long 0x3f800000,0x3f800000,0x3f800000,0x3f800000,0x3f7e39bc,0x3f7deafa,0x3f7d95f4,0x3f7d3aac
.long 0x3f78ed3c,0x3f77b493,0x3f766377,0x3f74fa0b,0x3f702d4f,0x3f6d76aa,0x3f6a8b4b,0x3f676bd8
.long 0x3f641901,0x3f5f5be6,0x3f5a46a0,0x3f54db31,0x3f54db31,0x3f4d9f02,0x3f45e403,0x3f3daef9
.long 0x3f42a9f7,0x3f3889dc,0x3f2dc5e3,0x3f226799,0x3f2dc5e3,0x3f207440,0x3f1260b2,0x3f039c3d
.long 0x3f167918,0x3f05c277,0x3ee87171,0x3ec3ef15,0x3efa2c90,0x3ed1c759,0x3ea7bf25,0x3e78cfcc
.long 0x3ec3ef15,0x3e94a031,0x3e47c5c2,0x3dc8bd36,0x3e8afa3e,0x3e2a1c3f,0x3d712283,0xbd48fb30
.long 0x3e20305b,0x3d20cee7,0xbda0af2a,0xbe47c5c2,0x3d20cee7,0xbdb4b86a,0xbe5b73dc,0xbeac7cd4
.long 0xbda0af2a,0xbe5b73dc,0xbeb13641,0xbef15aea,0xbe47c5c2,0xbeac7cd4,0xbef15aea,0xbf187fc0
.long 0x0,0x0,0x0,0x0,0x0,0x3c20d8d2,0x3ca0d6d6,0x3cf13d4c
.long 0x0,0x3ca0d6d6,0x3d20cee7,0x3d712283,0x0,0x3cf13d4c,0x3d712283,0x3db4b86a
.long 0x0,0x3d20cee7,0x3da0af2a,0x3df0b772,0x0,0x3d48fb30,0x3dc8bd36,0x3e164083
.long 0x0,0x3d712283,0x3df0b772,0x3e3403f1,0x0,0x3d8ca1f2,0x3e0c4cf7,0x3e519f65
.long 0x0,0x3da0af2a,0x3e20305b,0x3e6f0c4d,0x0,0x3db4b86a,0x3e3403f1,0x3e862210
.long 0x0,0x3dc8bd36,0x3e47c5c2,0x3e94a031,0x0,0x3ddcbd0d,0x3e5b73dc,0x3ea2fd52
.long 0x0,0x3df0b772,0x3e6f0c4d,0x3eb13641,0x0,0x3e0255f4,0x3e814693,0x3ebf47d7
.long 0x0,0x3e0c4cf7,0x3e8afa3e,0x3ecd2ef3,0x0,0x3e164083,0x3e94a031,0x3edae880
.long 0x0,0x0,0x0,0x0,0x3d20cee7,0x3d48fb30,0x3d712283,0x3d8ca1f2
.long 0x3da0af2a,0x3dc8bd36,0x3df0b772,0x3e0c4cf7,0x3df0b772,0x3e164083,0x3e3403f1,0x3e519f65
.long 0x3e20305b,0x3e47c5c2,0x3e6f0c4d,0x3e8afa3e,0x3e47c5c2,0x3e78cfcc,0x3e94a031,0x3eac7cd4
.long 0x3e6f0c4d,0x3e94a031,0x3eb13641,0x3ecd2ef3,0x3e8afa3e,0x3eac7cd4,0x3ecd2ef3,0x3eece91a
.long 0x3e9e377a,0x3ec3ef15,0x3ee87171,0x3f05c277,0x3eb13641,0x3edae880,0x3f0172c3,0x3f146eba
.long 0x3ec3ef15,0x3ef15aea,0x3f0e39da,0x3f226799,0x3ed65a92,0x3f039c3d,0x3f1a82a4,0x3f2f9c32
.long 0x3ee87171,0x3f0e39da,0x3f26423a,0x3f3bfc8f,0x3efa2c90,0x3f187fc0,0x3f316e2c,0x3f4779bc
.long 0x3f05c277,0x3f226799,0x3f3bfc8f,0x3f5205d4,0x3f0e39da,0x3f2beb4a,0x3f45e403,0x3f5b941a
.long 0x0,0x0,0x0,0x0,0x3da0af2a,0x3db4b86a,0x3dc8bd36,0x3ddcbd0d
.long 0x3e20305b,0x3e3403f1,0x3e47c5c2,0x3e5b73dc,0x3e6f0c4d,0x3e862210,0x3e94a031,0x3ea2fd52
.long 0x3e9e377a,0x3eb13641,0x3ec3ef15,0x3ed65a92,0x3ec3ef15,0x3edae880,0x3ef15aea,0x3f039c3d
.long 0x3ee87171,0x3f0172c3,0x3f0e39da,0x3f1a82a4,0x3f05c277,0x3f146eba,0x3f226799,0x3f2f9c32
.long 0x3f167918,0x3f26423a,0x3f3504f3,0x3f42a9f7,0x3f26423a,0x3f36c9a9,0x3f45e403,0x3f53731f
.long 0x3f3504f3,0x3f45e403,0x3f54db31,0x3f61c598,0x3f42a9f7,0x3f53731f,0x3f61c598,0x3f6d76aa
.long 0x3f4f1bbd,0x3f5f5be6,0x3f6c835e,0x3f766377,0x3f5a46a0,0x3f698690,0x3f74fa0b,0x3f7c7160
.long 0x3f641901,0x3f71decf,0x3f7b14be,0x3f7f8e56,0x3f6c835e,0x3f7853f8,0x3f7ec46d,0x3f7fb10f
.long 0x0,0x0,0x0,0x0,0x3df0b772,0x3e0255f4,0x3e0c4cf7,0x3e164083
.long 0x3e6f0c4d,0x3e814693,0x3e8afa3e,0x3e94a031,0x3eb13641,0x3ebf47d7,0x3ecd2ef3,0x3edae880
.long 0x3ee87171,0x3efa2c90,0x3f05c277,0x3f0e39da,0x3f0e39da,0x3f187fc0,0x3f226799,0x3f2beb4a
.long 0x3f26423a,0x3f316e2c,0x3f3bfc8f,0x3f45e403,0x3f3bfc8f,0x3f4779bc,0x3f5205d4,0x3f5b941a
.long 0x3f4f1bbd,0x3f5a46a0,0x3f641901,0x3f6c835e,0x3f5f5be6,0x3f698690,0x3f71decf,0x3f7853f8
.long 0x3f6c835e,0x3f74fa0b,0x3f7b14be,0x3f7ec46d,0x3f766377,0x3f7c7160,0x3f7f8e56,0x3f7fb10f
.long 0x3f7cd925,0x3f7fcd79,0x3f7f35f9,0x3f7b14be,0x3f7fcd79,0x3f7f0059,0x3f7a0d54,0x3f710908
.long 0x3f7f35f9,0x3f7a0d54,0x3f702d4f,0x3f61c598,0x3f7b14be,0x3f710908,0x3f61c598,0x3f4d9f02
.long 0x3f800000,0x3f800000,0x3f800000,0x3f800000,0x3f7cd925,0x3f7c7160,0x3f7c0361,0x3f7b8f2a
.long 0x3f737871,0x3f71decf,0x3f702d4f,0x3f6e641a,0x3f641901,0x3f609384,0x3f5cdc29,0x3f58f3c4
.long 0x3f4f1bbd,0x3f490a88,0x3f42a9f7,0x3f3bfc8f,0x3f3504f3,0x3f2beb4a,0x3f226799,0x3f187fc0
.long 0x3f167918,0x3f0a04f8,0x3efa2c90,0x3edf7108,0x3ee87171,0x3ec8917e,0x3ea7bf25,0x3e862210
.long 0x3e9e377a,0x3e6f0c4d,0x3e20305b,0x3da0af2a,0x3e20305b,0x3d8ca1f2,0xbca0d6d6,0xbddcbd0d
.long 0x0,0xbdc8bd36,0xbe47c5c2,0xbe94a031,0xbe20305b,0xbe862210,0xbeba9be1,0xbeece91a
.long 0xbe9e377a,0xbed65a92,0xbf05c277,0xbf1e7cf1,0xbee87171,0xbf104f0e,0xbf2a0c73,0xbf4105b8
.long 0xbf167918,0xbf316e2c,0xbf490a88,0xbf5cdc29,0xbf3504f3,0xbf4d9f02,0xbf61c598,0xbf710908
.long 0x3f800000,0x3f800000,0x3f800000,0x3f800000,0x3f7b14be,0x3f7a9421,0x3f7a0d54,0x3f79805c
.long 0x3f6c835e,0x3f6a8b4b,0x3f687c12,0x3f6655e7,0x3f54db31,0x3f50935b,0x3f4c1d35,0x3f4779bc
.long 0x3f3504f3,0x3f2dc5e3,0x3f26423a,0x3f1e7cf1,0x3f0e39da,0x3f039c3d,0x3ef15aea,0x3edae880
.long 0x3ec3ef15,0x3ea7bf25,0x3e8afa3e,0x3e5b73dc,0x3e47c5c2,0x3e0255f4,0x3d712283,0xbc20d8d2
.long 0x0,0xbda0af2a,0xbe20305b,0xbe6f0c4d,0xbe47c5c2,0xbe8fcefe,0xbeba9be1,0xbee3f40d
.long 0xbec3ef15,0xbef15aea,0xbf0e39da,0xbf226799,0xbf0e39da,0xbf2456f1,0xbf3889dc,0xbf4a965e
.long 0xbf3504f3,0xbf490a88,0xbf5a46a0,0xbf687c12,0xbf54db31,0xbf653a48,0xbf71decf,0xbf7a9421
.long 0xbf6c835e,0xbf77b493,0xbf7e39bc,0xbf7ff35e,0xbf7b14be,0xbf7fb10f,0xbf7ec46d,0xbf7853f8
.long 0x3f800000,0x3f800000,0x3f800000,0x3f800000,0x3f78ed3c,0x3f7853f8,0x3f77b493,0x3f770f11
.long 0x3f641901,0x3f61c598,0x3f5f5be6,0x3f5cdc29,0x3f42a9f7,0x3f3daef9,0x3f3889dc,0x3f333bc6
.long 0x3f167918,0x3f0e39da,0x3f05c277,0x3efa2c90,0x3ec3ef15,0x3eac7cd4,0x3e94a031,0x3e78cfcc
.long 0x3e20305b,0x3dc8bd36,0x3d20cee7,0xbca0d6d6,0xbda0af2a,0xbe164083,0xbe5b73dc,0xbe8fcefe
.long 0xbe9e377a,0xbec3ef15,0xbee87171,0xbf05c277,0xbf05c277,0xbf187fc0,0xbf2a0c73,0xbf3a4582
.long 0xbf3504f3,0xbf45e403,0xbf54db31,0xbf61c598,0xbf5a46a0,0xbf676bd8,0xbf71decf,0xbf79805c
.long 0xbf737871,0xbf7b14be,0xbf7f35f9,0xbf7fcd79,0xbf7f35f9,0xbf7fb10f,0xbf7c0361,0xbf743c41
.long 0xbf7cd925,0xbf74fa0b,0xbf687c12,0xbf579b8c,0xbf6c835e,0xbf5b941a,0xbf45e403,0xbf2beb4a
.long 0x3f800000,0x3f800000,0x3f800000,0x3f800000,0x3f766377,0x3f75b1c9,0x3f74fa0b,0x3f743c41
.long 0x3f5a46a0,0x3f579b8c,0x3f54db31,0x3f5205d4,0x3f2dc5e3,0x3f28296a,0x3f226799,0x3f1c81b9
.long 0x3ee87171,0x3ed65a92,0x3ec3ef15,0x3eb13641,0x3e47c5c2,0x3e164083,0x3dc8bd36,0x3d48fb30
.long 0xbda0af2a,0xbe0c4cf7,0xbe47c5c2,0xbe814693,0xbeb13641,0xbed1c759,0xbef15aea,0xbf07e565
.long 0xbf167918,0xbf26423a,0xbf3504f3,0xbf42a9f7,0xbf490a88,0xbf563e03,0xbf61c598,0xbf6b8a3d
.long 0xbf6c835e,0xbf74fa0b,0xbf7b14be,0xbf7ec46d,0xbf7e39bc,0xbf7ffcd7,0xbf7ec46d,0xbf7a9421
.long 0xbf7cd925,0xbf766377,0xbf6c835e,0xbf5f5be6,0xbf687c12,0xbf58f3c4,0xbf45e403,0xbf2f9c32
.long 0xbf42a9f7,0xbf2a0c73,0xbf0e39da,0xbedf7108,0xbf0e39da,0xbedae880,0xbe94a031,0xbe164083
.long 0x0,0x0,0x0,0x0,0x3e20305b,0x3e2a1c3f,0x3e3403f1,0x3e3de731
.long 0x3e9e377a,0x3ea7bf25,0x3eb13641,0x3eba9be1,0x3ee87171,0x3ef5c6c5,0x3f0172c3,0x3f07e565
.long 0x3f167918,0x3f1e7cf1,0x3f26423a,0x3f2dc5e3,0x3f3504f3,0x3f3daef9,0x3f45e403,0x3f4d9f02
.long 0x3f4f1bbd,0x3f579b8c,0x3f5f5be6,0x3f6655e7,0x3f641901,0x3f6b8a3d,0x3f71decf,0x3f770f11
.long 0x3f737871,0x3f78ed3c,0x3f7cd925,0x3f7f35f9,0x3f7cd925,0x3f7f654e,0x3f7ff35e,0x3f7e8238
.long 0x3f800000,0x3f7ec46d,0x3f7b14be,0x3f74fa0b,0x3f7cd925,0x3f770f11,0x3f6e641a,0x3f62f219
.long 0x3f737871,0x3f687c12,0x3f5a46a0,0x3f490a88,0x3f641901,0x3f53731f,0x3f3f5cb5,0x3f28296a
.long 0x3f4f1bbd,0x3f3889dc,0x3f1e7cf1,0x3f0172c3,0x3f3504f3,0x3f187fc0,0x3ef15aea,0x3eac7cd4
.long 0x0,0x0,0x0,0x0,0x3e47c5c2,0x3e519f65,0x3e5b73dc,0x3e6542e9
.long 0x3ec3ef15,0x3ecd2ef3,0x3ed65a92,0x3edf7108,0x3f0e39da,0x3f146eba,0x3f1a82a4,0x3f207440
.long 0x3f3504f3,0x3f3bfc8f,0x3f42a9f7,0x3f490a88,0x3f54db31,0x3f5b941a,0x3f61c598,0x3f676bd8
.long 0x3f6c835e,0x3f71decf,0x3f766377,0x3f7a0d54,0x3f7b14be,0x3f7deafa,0x3f7f8e56,0x3f7ffcd7
.long 0x3f800000,0x3f7f35f9,0x3f7cd925,0x3f78ed3c,0x3f7b14be,0x3f75b1c9,0x3f6e641a,0x3f653a48
.long 0x3f6c835e,0x3f61c598,0x3f54db31,0x3f45e403,0x3f54db31,0x3f444969,0x3f316e2c,0x3f1c81b9
.long 0x3f3504f3,0x3f1e7cf1,0x3f05c277,0x3ed65a92,0x3f0e39da,0x3ee3f40d,0x3ea7bf25,0x3e519f65
.long 0x3ec3ef15,0x3e814693,0x3df0b772,0xbca0d6d6,0x3e47c5c2,0x3d48fb30,0xbdc8bd36,0xbe78cfcc
.long 0x0,0x0,0x0,0x0,0x3e6f0c4d,0x3e78cfcc,0x3e814693,0x3e862210
.long 0x3ee87171,0x3ef15aea,0x3efa2c90,0x3f0172c3,0x3f26423a,0x3f2beb4a,0x3f316e2c,0x3f36c9a9
.long 0x3f4f1bbd,0x3f54db31,0x3f5a46a0,0x3f5f5be6,0x3f6c835e,0x3f710908,0x3f74fa0b,0x3f7853f8
.long 0x3f7cd925,0x3f7ec46d,0x3f7fcd79,0x3f7ff35e,0x3f7f35f9,0x3f7d3aac,0x3f7a0d54,0x3f75b1c9
.long 0x3f737871,0x3f6c835e,0x3f641901,0x3f5a46a0,0x3f5a46a0,0x3f4d9f02,0x3f3f5cb5,0x3f2f9c32
.long 0x3f3504f3,0x3f226799,0x3f0e39da,0x3ef15aea,0x3f05c277,0x3edae880,0x3ea7bf25,0x3e6542e9
.long 0x3e9e377a,0x3e47c5c2,0x3da0af2a,0xbd20cee7,0x3da0af2a,0xbd48fb30,0xbe3403f1,0xbe996dba
.long 0xbe20305b,0xbe94a031,0xbed65a92,0xbf0a04f8,0xbec3ef15,0xbf039c3d,0xbf226799,0xbf3daef9
.long 0x0,0x0,0x0,0x0,0x3e8afa3e,0x3e8fcefe,0x3e94a031,0x3e996dba
.long 0x3f05c277,0x3f0a04f8,0x3f0e39da,0x3f1260b2,0x3f3bfc8f,0x3f4105b8,0x3f45e403,0x3f4a965e
.long 0x3f641901,0x3f687c12,0x3f6c835e,0x3f702d4f,0x3f7b14be,0x3f7d3aac,0x3f7ec46d,0x3f7fb10f
.long 0x3f7f35f9,0x3f7d95f4,0x3f7b14be,0x3f77b493,0x3f702d4f,0x3f698690,0x3f61c598,0x3f58f3c4
.long 0x3f4f1bbd,0x3f42a9f7,0x3f3504f3,0x3f26423a,0x3f1e7cf1,0x3f0c2124,0x3ef15aea,0x3ec8917e
.long 0x3ec3ef15,0x3e94a031,0x3e47c5c2,0x3dc8bd36,0x3df0b772,0x3c20d8d2,0xbdc8bd36,0xbe519f65
.long 0xbe20305b,0xbe8afa3e,0xbec3ef15,0xbefa2c90,0xbed65a92,0xbf07e565,0xbf226799,0xbf3a4582
.long 0xbf26423a,0xbf3f5cb5,0xbf54db31,0xbf6655e7,0xbf54db31,0xbf676bd8,0xbf74fa0b,0xbf7d3aac
.long 0x3f800000,0x3f800000,0x3f800000,0x3f800000,0x3f737871,0x3f72ae9e,0x3f71decf,0x3f710908
.long 0x3f4f1bbd,0x3f4c1d35,0x3f490a88,0x3f45e403,0x3f167918,0x3f104f0e,0x3f0a04f8,0x3f039c3d
.long 0x3e9e377a,0x3e8afa3e,0x3e6f0c4d,0x3e47c5c2,0x0,0xbd48fb30,0xbdc8bd36,0xbe164083
.long 0xbe9e377a,0xbeba9be1,0xbed65a92,0xbef15aea,0xbf167918,0xbf2456f1,0xbf316e2c,0xbf3daef9
.long 0xbf4f1bbd,0xbf5a46a0,0xbf641901,0xbf6c835e,0xbf737871,0xbf79805c,0xbf7d95f4,0xbf7fb10f
.long 0xbf800000,0xbf7ec46d,0xbf7b14be,0xbf74fa0b,0xbf737871,0xbf698690,0xbf5cdc29,0xbf4d9f02
.long 0xbf4f1bbd,0xbf3bfc8f,0xbf26423a,0xbf0e39da,0xbf167918,0xbef5c6c5,0xbeba9be1,0xbe78cfcc
.long 0xbe9e377a,0xbe3403f1,0xbd20cee7,0x3dc8bd36,0x0,0x3e164083,0x3e94a031,0x3edae880
.long 0x3f800000,0x3f800000,0x3f800000,0x3f800000,0x3f702d4f,0x3f6f4ba8,0x3f6e641a,0x3f6d76aa
.long 0x3f42a9f7,0x3f3f5cb5,0x3f3bfc8f,0x3f3889dc,0x3efa2c90,0x3eece91a,0x3edf7108,0x3ed1c759
.long 0x3e20305b,0x3df0b772,0x3da0af2a,0x3d20cee7,0xbe47c5c2,0xbe78cfcc,0xbe94a031,0xbeac7cd4
.long 0xbf05c277,0xbf1260b2,0xbf1e7cf1,0xbf2a0c73,0xbf490a88,0xbf53731f,0xbf5cdc29,0xbf653a48
.long 0xbf737871,0xbf78ed3c,0xbf7cd925,0xbf7f35f9,0xbf7fcd79,0xbf7deafa,0xbf7a0d54,0xbf743c41
.long 0xbf6c835e,0xbf61c598,0xbf54db31,0xbf45e403,0xbf3bfc8f,0xbf28296a,0xbf1260b2,0xbef5c6c5
.long 0xbee87171,0xbeb13641,0xbe6f0c4d,0xbdf0b772,0xbdf0b772,0x3c20d8d2,0x3e0c4cf7,0x3e862210
.long 0x3e6f0c4d,0x3eba9be1,0x3efa2c90,0x3f1a82a4,0x3f0e39da,0x3f2beb4a,0x3f45e403,0x3f5b941a
.long 0x3f800000,0x3f800000,0x3f800000,0x3f800000,0x3f6c835e,0x3f6b8a3d,0x3f6a8b4b,0x3f698690
.long 0x3f3504f3,0x3f316e2c,0x3f2dc5e3,0x3f2a0c73,0x3ec3ef15,0x3eb5eb4f,0x3ea7bf25,0x3e996dba
.long 0x0,0xbd20cee7,0xbda0af2a,0xbdf0b772,0xbec3ef15,0xbedae880,0xbef15aea,0xbf039c3d
.long 0xbf3504f3,0xbf3f5cb5,0xbf490a88,0xbf5205d4,0xbf6c835e,0xbf72ae9e,0xbf77b493,0xbf7b8f2a
.long 0xbf800000,0xbf7f35f9,0xbf7cd925,0xbf78ed3c,0xbf6c835e,0xbf62f219,0xbf579b8c,0xbf4a965e
.long 0xbf3504f3,0xbf226799,0xbf0e39da,0xbef15aea,0xbec3ef15,0xbe8fcefe,0xbe3403f1,0xbd8ca1f2
.long 0x0,0x3df0b772,0x3e6f0c4d,0x3eb13641,0x3ec3ef15,0x3efe8c2f,0x3f1a82a4,0x3f333bc6
.long 0x3f3504f3,0x3f4c1d35,0x3f5f5be6,0x3f6e641a,0x3f6c835e,0x3f7853f8,0x3f7ec46d,0x3f7fb10f
.long 0x3f800000,0x3f800000,0x3f800000,0x3f800000,0x3f687c12,0x3f676bd8,0x3f6655e7,0x3f653a48
.long 0x3f26423a,0x3f226799,0x3f1e7cf1,0x3f1a82a4,0x3e8afa3e,0x3e78cfcc,0x3e5b73dc,0x3e3de731
.long 0xbe20305b,0xbe47c5c2,0xbe6f0c4d,0xbe8afa3e,0xbf0e39da,0xbf187fc0,0xbf226799,0xbf2beb4a
.long 0xbf5a46a0,0xbf61c598,0xbf687c12,0xbf6e641a,0xbf7e39bc,0xbf7fb10f,0xbf7ff35e,0xbf7f0059
.long 0xbf737871,0xbf6c835e,0xbf641901,0xbf5a46a0,0xbf3bfc8f,0xbf2beb4a,0xbf1a82a4,0xbf07e565
.long 0xbec3ef15,0xbe94a031,0xbe47c5c2,0xbdc8bd36,0x3d20cee7,0x3e164083,0x3e814693,0x3eb5eb4f
.long 0x3ee87171,0x3f0e39da,0x3f26423a,0x3f3bfc8f,0x3f490a88,0x3f5b941a,0x3f6a8b4b,0x3f75b1c9
.long 0x3f78ed3c,0x3f7ec46d,0x3f7fcd79,0x3f7c0361,0x3f7b14be,0x3f710908,0x3f61c598,0x3f4d9f02
.long 0x0,0x0,0x0,0x0,0x3e9e377a,0x3ea2fd52,0x3ea7bf25,0x3eac7cd4
.long 0x3f167918,0x3f1a82a4,0x3f1e7cf1,0x3f226799,0x3f4f1bbd,0x3f53731f,0x3f579b8c,0x3f5b941a
.long 0x3f737871,0x3f766377,0x3f78ed3c,0x3f7b14be,0x3f800000,0x3f7fb10f,0x3f7ec46d,0x3f7d3aac
.long 0x3f737871,0x3f6e641a,0x3f687c12,0x3f61c598,0x3f4f1bbd,0x3f444969,0x3f3889dc,0x3f2beb4a
.long 0x3f167918,0x3f05c277,0x3ee87171,0x3ec3ef15,0x3e9e377a,0x3e6542e9,0x3e0c4cf7,0x3d48fb30
.long 0x0,0xbdc8bd36,0xbe47c5c2,0xbe94a031,0xbe9e377a,0xbed1c759,0xbf0172c3,0xbf187fc0
.long 0xbf167918,0xbf2dc5e3,0xbf42a9f7,0xbf54db31,0xbf4f1bbd,0xbf609384,0xbf6e641a,0xbf7853f8
.long 0xbf737871,0xbf7c0361,0xbf7fcd79,0xbf7ec46d,0xbf800000,0xbf7d3aac,0xbf74fa0b,0xbf676bd8
.long 0x0,0x0,0x0,0x0,0x3eb13641,0x3eb5eb4f,0x3eba9be1,0x3ebf47d7
.long 0x3f26423a,0x3f2a0c73,0x3f2dc5e3,0x3f316e2c,0x3f5f5be6,0x3f62f219,0x3f6655e7,0x3f698690
.long 0x3f7cd925,0x3f7e39bc,0x3f7f35f9,0x3f7fcd79,0x3f7b14be,0x3f7853f8,0x3f74fa0b,0x3f710908
.long 0x3f5a46a0,0x3f5205d4,0x3f490a88,0x3f3f5cb5,0x3f1e7cf1,0x3f104f0e,0x3f0172c3,0x3ee3f40d
.long 0x3e9e377a,0x3e6f0c4d,0x3e20305b,0x3da0af2a,0xbd20cee7,0xbe0255f4,0xbe5b73dc,0xbe996dba
.long 0xbec3ef15,0xbef15aea,0xbf0e39da,0xbf226799,0xbf2dc5e3,0xbf4105b8,0xbf5205d4,0xbf609384
.long 0xbf641901,0xbf702d4f,0xbf78ed3c,0xbf7e39bc,0xbf7e39bc,0xbf7ffcd7,0xbf7d95f4,0xbf770f11
.long 0xbf78ed3c,0xbf6e641a,0xbf5f5be6,0xbf4c1d35,0xbf54db31,0xbf3daef9,0xbf226799,0xbf039c3d
.long 0x0,0x0,0x0,0x0,0x3ec3ef15,0x3ec8917e,0x3ecd2ef3,0x3ed1c759
.long 0x3f3504f3,0x3f3889dc,0x3f3bfc8f,0x3f3f5cb5,0x3f6c835e,0x3f6f4ba8,0x3f71decf,0x3f743c41
.long 0x3f800000,0x3f7fcd79,0x3f7f35f9,0x3f7e39bc,0x3f6c835e,0x3f676bd8,0x3f61c598,0x3f5b941a
.long 0x3f3504f3,0x3f2a0c73,0x3f1e7cf1,0x3f1260b2,0x3ec3ef15,0x3ea2fd52,0x3e814693,0x3e3de731
.long 0x0,0xbda0af2a,0xbe20305b,0xbe6f0c4d,0xbec3ef15,0xbeece91a,0xbf0a04f8,0xbf1c81b9
.long 0xbf3504f3,0xbf45e403,0xbf54db31,0xbf61c598,0xbf6c835e,0xbf75b1c9,0xbf7c0361,0xbf7f654e
.long 0xbf800000,0xbf7e39bc,0xbf78ed3c,0xbf702d4f,0xbf6c835e,0xbf5e1ec5,0xbf4c1d35,0xbf36c9a9
.long 0xbf3504f3,0xbf1a82a4,0xbefa2c90,0xbeba9be1,0xbec3ef15,0xbe78cfcc,0xbdc8bd36,0x3d48fb30
.long 0x0,0x0,0x0,0x0,0x3ed65a92,0x3edae880,0x3edf7108,0x3ee3f40d
.long 0x3f42a9f7,0x3f45e403,0x3f490a88,0x3f4c1d35,0x3f766377,0x3f7853f8,0x3f7a0d54,0x3f7b8f2a
.long 0x3f7cd925,0x3f7b14be,0x3f78ed3c,0x3f766377,0x3f54db31,0x3f4d9f02,0x3f45e403,0x3f3daef9
.long 0x3f05c277,0x3ef15aea,0x3ed65a92,0x3eba9be1,0x3df0b772,0x3d48fb30,0xbca0d6d6,0xbdb4b86a
.long 0xbe9e377a,0xbec3ef15,0xbee87171,0xbf05c277,0xbf2dc5e3,0xbf3daef9,0xbf4c1d35,0xbf58f3c4
.long 0xbf6c835e,0xbf74fa0b,0xbf7b14be,0xbf7ec46d,0xbf7fcd79,0xbf7d3aac,0xbf77b493,0xbf6f4ba8
.long 0xbf641901,0xbf54db31,0xbf42a9f7,0xbf2dc5e3,0xbf1e7cf1,0xbf039c3d,0xbecd2ef3,0xbe8fcefe
.long 0xbe6f0c4d,0xbdc8bd36,0x3d20cee7,0x3e3403f1,0x3e47c5c2,0x3eac7cd4,0x3ef15aea,0x3f187fc0
.long 0x3f80,0x3f80,0x3f80,0x3f80,0x3f80,0x3e203f7d,0x3e9e3f73,0x3ee83f64
.long 0x3f80,0x3e9e3f73,0x3f163f4f,0x3f4f3f16,0x3f80,0x3ee83f64,0x3f4f3f16,0x3f7d3e20
.long 0x3f80,0x3f163f4f,0x3f733e9e,0x3f73be9e,0x3f80,0x3f353f35,0x3f800000,0x3f35bf35
.long 0x3f80,0x3f4f3f16,0x3f73be9e,0x3e9ebf73,0x3f80,0x3f643ee8,0x3f4fbf16,0xbe20bf7d
.long 0x3f80,0x3f733e9e,0x3f16bf4f,0xbf16bf4f,0x3f80,0x3f7d3e20,0x3e9ebf73,0xbf64bee8
.long 0x3f80,0x3f800000,0xbf80,0xbf800000,0x3f80,0x3f7dbe20,0xbe9ebf73,0xbf643ee8
.long 0x3f80,0x3f73be9e,0xbf16bf4f,0xbf163f4f,0x3f80,0x3f64bee8,0xbf4fbf16,0xbe203f7d
.long 0x3f80,0x3f4fbf16,0xbf73be9e,0x3e9e3f73,0x3f80,0x3f35bf35,0xbf800000,0x3f353f35
.long 0x3f80,0x3f80,0x3f80,0x3f80,0x3f163f4f,0x3f353f35,0x3f4f3f16,0x3f643ee8
.long 0x3f733e9e,0x3f800000,0x3f73be9e,0x3f4fbf16,0x3f73be9e,0x3f35bf35,0x3e9ebf73,0xbe20bf7d
.long 0x3f16bf4f,0xbf80,0xbf16bf4f,0xbf73be9e,0xbf80,0xbf35bf35,0xbf800000,0xbf353f35
.long 0xbf16bf4f,0xbf800000,0xbf163f4f,0x3e9e3f73,0xbf73be9e,0xbf353f35,0x3e9e3f73,0x3f7d3e20
.long 0xbf733e9e,0x3f80,0x3f733e9e,0x3f16bf4f,0xbf163f4f,0x3f353f35,0x3f4fbf16,0xbee8bf64
.long 0x3f80,0x3f800000,0xbf80,0xbf800000,0x3f163f4f,0x3f35bf35,0xbf4fbf16,0xbee83f64
.long 0x3f733e9e,0xbf80,0xbf733e9e,0x3f163f4f,0x3f73be9e,0xbf35bf35,0xbe9e3f73,0x3f7dbe20
.long 0x3f16bf4f,0xbf800000,0x3f163f4f,0x3e9ebf73,0xbf80,0xbf353f35,0x3f800000,0xbf35bf35
.long 0x3f80,0x3f80,0x3f80,0x3f80,0x3f733e9e,0x3f7d3e20,0x3f800000,0x3f7dbe20
.long 0x3f16bf4f,0x3e9ebf73,0xbf80,0xbe9ebf73,0xbf16bf4f,0xbf64bee8,0xbf800000,0xbf643ee8
.long 0xbf733e9e,0xbf163f4f,0x3f80,0x3f163f4f,0x3f80,0x3f353f35,0x3f800000,0x3f35bf35
.long 0x3f733e9e,0x3f4fbf16,0xbf80,0xbf4fbf16,0x3f16bf4f,0xbee8bf64,0xbf800000,0xbee83f64
.long 0xbf16bf4f,0xbf733e9e,0x3f80,0x3f733e9e,0xbf733e9e,0x3e203f7d,0x3f800000,0x3e20bf7d
.long 0x3f80,0x3f800000,0xbf80,0xbf800000,0x3f733e9e,0x3e20bf7d,0xbf800000,0x3e203f7d
.long 0x3f16bf4f,0xbf73be9e,0x3f80,0x3f73be9e,0xbf16bf4f,0xbee83f64,0x3f800000,0xbee8bf64
.long 0xbf733e9e,0x3f4f3f16,0xbf80,0xbf4f3f16,0x3f80,0x3f35bf35,0xbf800000,0x3f353f35
.long 0x3f80,0x3f80,0x3f80,0x3f80,0x3f73be9e,0x3f64bee8,0x3f4fbf16,0x3f35bf35
.long 0xbf16bf4f,0xbf4fbf16,0xbf73be9e,0xbf800000,0xbf163f4f,0xbe203f7d,0x3e9e3f73,0x3f353f35
.long 0x3f733e9e,0x3f73be9e,0x3f16bf4f,0xbf80,0xbf80,0xbf35bf35,0xbf800000,0xbf353f35
.long 0xbf733e9e,0xbe9e3f73,0x3f163f4f,0x3f800000,0x3f163f4f,0x3f7dbe20,0x3e9ebf73,0xbf35bf35
.long 0x3f16bf4f,0xbf16bf4f,0xbf733e9e,0x3f80,0xbf73be9e,0xbee83f64,0x3f4f3f16,0x3f35bf35
.long 0x3f80,0x3f800000,0xbf80,0xbf800000,0x3f73be9e,0xbee8bf64,0xbf4f3f16,0x3f353f35
.long 0xbf16bf4f,0xbf163f4f,0x3f733e9e,0xbf80,0xbf163f4f,0x3f7d3e20,0xbe9ebf73,0xbf353f35
.long 0x3f733e9e,0xbe9ebf73,0xbf163f4f,0x3f800000,0xbf80,0xbf353f35,0x3f800000,0xbf35bf35
.long 0x3f80,0x3f80,0x3f80,0x3f80,0x3f16bf4f,0x3ee8bf64,0x3e9ebf73,0x3e20bf7d
.long 0xbf733e9e,0xbf4f3f16,0xbf163f4f,0xbe9e3f73,0x3f733e9e,0x3f7dbe20,0x3f4fbf16,0x3ee8bf64
.long 0xbf16bf4f,0xbf73be9e,0xbf733e9e,0xbf163f4f,0x3f80,0x3f353f35,0x3f800000,0x3f35bf35
.long 0x3f16bf4f,0xbe9ebf73,0xbf73be9e,0xbf4f3f16,0xbf733e9e,0xbe203f7d,0x3f4f3f16,0x3f64bee8
.long 0x3f733e9e,0x3f16bf4f,0xbf16bf4f,0xbf733e9e,0xbf16bf4f,0xbf643ee8,0x3e9e3f73,0x3f7dbe20
.long 0x3f80,0x3f800000,0xbf80,0xbf800000,0x3f16bf4f,0xbf64bee8,0xbe9e3f73,0x3f7d3e20
.long 0xbf733e9e,0x3f163f4f,0x3f16bf4f,0xbf73be9e,0x3f733e9e,0xbe20bf7d,0xbf4f3f16,0x3f643ee8
.long 0xbf16bf4f,0xbe9e3f73,0x3f73be9e,0xbf4fbf16,0x3f80,0x3f35bf35,0xbf800000,0x3f353f35
.long 0x3f80,0x3f80,0x3f80,0x3f80,0xbf80,0xbe20bf7d,0xbe9ebf73,0xbee8bf64
.long 0x3f80,0x3e9e3f73,0x3f163f4f,0x3f4f3f16,0xbf80,0xbee8bf64,0xbf4fbf16,0xbf7dbe20
.long 0x3f80,0x3f163f4f,0x3f733e9e,0x3f73be9e,0xbf80,0xbf35bf35,0xbf800000,0xbf353f35
.long 0x3f80,0x3f4f3f16,0x3f73be9e,0x3e9ebf73,0xbf80,0xbf64bee8,0xbf4f3f16,0x3e203f7d
.long 0x3f80,0x3f733e9e,0x3f16bf4f,0xbf16bf4f,0xbf80,0xbf7dbe20,0xbe9e3f73,0x3f643ee8
.long 0x3f80,0x3f800000,0xbf80,0xbf800000,0xbf80,0xbf7d3e20,0x3e9e3f73,0x3f64bee8
.long 0x3f80,0x3f73be9e,0xbf16bf4f,0xbf163f4f,0xbf80,0xbf643ee8,0x3f4f3f16,0x3e20bf7d
.long 0x3f80,0x3f4fbf16,0xbf73be9e,0x3e9e3f73,0xbf80,0xbf353f35,0x3f800000,0xbf35bf35
.long 0x3f80,0x3f80,0x3f80,0x3f80,0xbf16bf4f,0xbf35bf35,0xbf4fbf16,0xbf64bee8
.long 0x3f733e9e,0x3f800000,0x3f73be9e,0x3f4fbf16,0xbf733e9e,0xbf353f35,0xbe9e3f73,0x3e203f7d
.long 0x3f16bf4f,0xbf80,0xbf16bf4f,0xbf73be9e,0x3f80,0x3f353f35,0x3f800000,0x3f35bf35
.long 0xbf16bf4f,0xbf800000,0xbf163f4f,0x3e9e3f73,0x3f733e9e,0x3f35bf35,0xbe9ebf73,0xbf7dbe20
.long 0xbf733e9e,0x3f80,0x3f733e9e,0x3f16bf4f,0x3f16bf4f,0xbf35bf35,0xbf4f3f16,0x3ee83f64
.long 0x3f80,0x3f800000,0xbf80,0xbf800000,0xbf16bf4f,0xbf353f35,0x3f4f3f16,0x3ee8bf64
.long 0x3f733e9e,0xbf80,0xbf733e9e,0x3f163f4f,0xbf733e9e,0x3f353f35,0x3e9ebf73,0xbf7d3e20
.long 0x3f16bf4f,0xbf800000,0x3f163f4f,0x3e9ebf73,0x3f80,0x3f35bf35,0xbf800000,0x3f353f35
.long 0x3f80,0x3f80,0x3f80,0x3f80,0xbf73be9e,0xbf7dbe20,0xbf800000,0xbf7d3e20
.long 0x3f16bf4f,0x3e9ebf73,0xbf80,0xbe9ebf73,0x3f163f4f,0x3f643ee8,0x3f800000,0x3f64bee8
.long 0xbf733e9e,0xbf163f4f,0x3f80,0x3f163f4f,0xbf80,0xbf35bf35,0xbf800000,0xbf353f35
.long 0x3f733e9e,0x3f4fbf16,0xbf80,0xbf4fbf16,0xbf163f4f,0x3ee83f64,0x3f800000,0x3ee8bf64
.long 0xbf16bf4f,0xbf733e9e,0x3f80,0x3f733e9e,0x3f73be9e,0xbe20bf7d,0xbf800000,0xbe203f7d
.long 0x3f80,0x3f800000,0xbf80,0xbf800000,0xbf73be9e,0xbe203f7d,0x3f800000,0xbe20bf7d
.long 0x3f16bf4f,0xbf73be9e,0x3f80,0x3f73be9e,0x3f163f4f,0x3ee8bf64,0xbf800000,0x3ee83f64
.long 0xbf733e9e,0x3f4f3f16,0xbf80,0xbf4f3f16,0xbf80,0xbf353f35,0x3f800000,0xbf35bf35
.long 0x3f80,0x3f80,0x3f80,0x3f80,0xbf733e9e,0xbf643ee8,0xbf4f3f16,0xbf353f35
.long 0xbf16bf4f,0xbf4fbf16,0xbf73be9e,0xbf800000,0x3f16bf4f,0x3e20bf7d,0xbe9ebf73,0xbf35bf35
.long 0x3f733e9e,0x3f73be9e,0x3f16bf4f,0xbf80,0x3f80,0x3f353f35,0x3f800000,0x3f35bf35
.long 0xbf733e9e,0xbe9e3f73,0x3f163f4f,0x3f800000,0xbf16bf4f,0xbf7d3e20,0xbe9e3f73,0x3f353f35
.long 0x3f16bf4f,0xbf16bf4f,0xbf733e9e,0x3f80,0x3f733e9e,0x3ee8bf64,0xbf4fbf16,0xbf353f35
.long 0x3f80,0x3f800000,0xbf80,0xbf800000,0xbf733e9e,0x3ee83f64,0x3f4fbf16,0xbf35bf35
.long 0xbf16bf4f,0xbf163f4f,0x3f733e9e,0xbf80,0x3f16bf4f,0xbf7dbe20,0x3e9e3f73,0x3f35bf35
.long 0x3f733e9e,0xbe9ebf73,0xbf163f4f,0x3f800000,0x3f80,0x3f35bf35,0xbf800000,0x3f353f35
.long 0x3f80,0x3f80,0x3f80,0x3f80,0xbf163f4f,0xbee83f64,0xbe9e3f73,0xbe203f7d
.long 0xbf733e9e,0xbf4f3f16,0xbf163f4f,0xbe9e3f73,0xbf73be9e,0xbf7d3e20,0xbf4f3f16,0xbee83f64
.long 0xbf16bf4f,0xbf73be9e,0xbf733e9e,0xbf163f4f,0xbf80,0xbf35bf35,0xbf800000,0xbf353f35
.long 0x3f16bf4f,0xbe9ebf73,0xbf73be9e,0xbf4f3f16,0x3f73be9e,0x3e20bf7d,0xbf4fbf16,0xbf643ee8
.long 0x3f733e9e,0x3f16bf4f,0xbf16bf4f,0xbf733e9e,0x3f163f4f,0x3f64bee8,0xbe9ebf73,0xbf7d3e20
.long 0x3f80,0x3f800000,0xbf80,0xbf800000,0xbf163f4f,0x3f643ee8,0x3e9ebf73,0xbf7dbe20
.long 0xbf733e9e,0x3f163f4f,0x3f16bf4f,0xbf73be9e,0xbf73be9e,0x3e203f7d,0x3f4fbf16,0xbf64bee8
.long 0xbf16bf4f,0xbe9e3f73,0x3f73be9e,0xbf4fbf16,0xbf80,0xbf353f35,0x3f800000,0xbf35bf35
.long 0x0,0x0,0x0,0x0,0x0,0x0,0x0,0x0
.long 0x0,0x0,0x0,0x0,0x0,0x0,0x0,0x0
.long 0x0,0x0,0x0,0x0,0x0,0x0,0x0,0x0
.long 0x0,0x0,0x0,0x0,0x0,0x0,0x0,0x0
.long 0x0,0x0,0x0,0x0,0x0,0x0,0x0,0x0
.long 0x0,0x0,0x0,0x0,0x0,0x0,0x0,0x0
.long 0x0,0x0,0x0,0x0,0x0,0x0,0x0,0x0
.long 0x0,0x0,0x0,0x0,0x0,0x0,0x0,0x0
.long 0x0,0x0,0x0,0x0,0x0,0x0,0x0,0x0
.long 0x0,0x0,0x0,0x0,0x0,0x0,0x0,0x0
.long 0x0,0x0,0x0,0x0,0x0,0x0,0x0,0x0
.long 0x0,0x0,0x0,0x0,0x0,0x0,0x0,0x0
.long 0x0,0x0,0x0,0x0,0x0,0x0,0x0,0x0
.long 0x0,0x0,0x0,0x0,0x0,0x0,0x0,0x0
.long 0x0,0x0,0x0,0x0,0x0,0x0,0x0,0x0
.long 0x0,0x0,0x0,0x0,0x0,0x0,0x0,0x0
.long 0x3f80,0x3f16bf4f,0xbf733e9e,0x3f733e9e,0x3f80,0x3ee8bf64,0xbf4f3f16,0x3f7dbe20
.long 0x3f80,0x3e9ebf73,0xbf163f4f,0x3f4fbf16,0x3f80,0x3e20bf7d,0xbe9e3f73,0x3ee8bf64
.long 0x3f80,0xbf80,0x3f80,0xbf80,0x3f80,0xbe20bf7d,0x3e9e3f73,0xbee8bf64
.long 0x3f80,0xbe9ebf73,0x3f163f4f,0xbf4fbf16,0x3f80,0xbee8bf64,0x3f4f3f16,0xbf7dbe20
.long 0x3f80,0xbf16bf4f,0x3f733e9e,0xbf733e9e,0x3f80,0xbf35bf35,0x3f800000,0xbf353f35
.long 0x3f80,0xbf4fbf16,0x3f73be9e,0xbe9e3f73,0x3f80,0xbf64bee8,0x3f4fbf16,0x3e203f7d
.long 0x3f80,0xbf73be9e,0x3f16bf4f,0x3f163f4f,0x3f80,0xbf7dbe20,0x3e9ebf73,0x3f643ee8
.long 0x3f80,0xbf800000,0xbf80,0x3f800000,0x3f80,0xbf7d3e20,0xbe9ebf73,0x3f64bee8
.long 0xbf16bf4f,0x3f80,0x3f16bf4f,0xbf733e9e,0xbf73be9e,0x3f353f35,0xbe9ebf73,0xbe203f7d
.long 0xbf733e9e,0x3f800000,0xbf73be9e,0x3f4f3f16,0xbf163f4f,0x3f35bf35,0xbf4f3f16,0x3f64bee8
.long 0x3f80,0xbf80,0x3f80,0xbf80,0x3f163f4f,0xbf35bf35,0x3f4f3f16,0xbf64bee8
.long 0x3f733e9e,0xbf800000,0x3f73be9e,0xbf4f3f16,0x3f73be9e,0xbf353f35,0x3e9ebf73,0x3e203f7d
.long 0x3f16bf4f,0x3f80,0xbf16bf4f,0x3f733e9e,0xbf80,0x3f353f35,0xbf800000,0x3f35bf35
.long 0xbf16bf4f,0x3f800000,0xbf163f4f,0xbe9ebf73,0xbf73be9e,0x3f35bf35,0x3e9e3f73,0xbf7dbe20
.long 0xbf733e9e,0xbf80,0x3f733e9e,0xbf163f4f,0xbf163f4f,0xbf35bf35,0x3f4fbf16,0x3ee83f64
.long 0x3f80,0xbf800000,0xbf80,0x3f800000,0x3f163f4f,0xbf353f35,0xbf4fbf16,0x3ee8bf64
.long 0x3f733e9e,0xbf16bf4f,0x3f80,0x3f16bf4f,0x3f16bf4f,0xbf643ee8,0x3f800000,0xbf64bee8
.long 0xbf16bf4f,0x3e9e3f73,0xbf80,0xbe9e3f73,0xbf733e9e,0x3f7dbe20,0xbf800000,0x3f7d3e20
.long 0x3f80,0xbf80,0x3f80,0xbf80,0x3f733e9e,0xbf7dbe20,0x3f800000,0xbf7d3e20
.long 0x3f16bf4f,0xbe9e3f73,0xbf80,0x3e9e3f73,0xbf16bf4f,0x3f643ee8,0xbf800000,0x3f64bee8
.long 0xbf733e9e,0x3f16bf4f,0x3f80,0xbf16bf4f,0x3f80,0xbf35bf35,0x3f800000,0xbf353f35
.long 0x3f733e9e,0xbf4f3f16,0xbf80,0x3f4f3f16,0x3f16bf4f,0x3ee83f64,0xbf800000,0x3ee8bf64
.long 0xbf16bf4f,0x3f73be9e,0x3f80,0xbf73be9e,0xbf733e9e,0xbe20bf7d,0x3f800000,0xbe203f7d
.long 0x3f80,0xbf800000,0xbf80,0x3f800000,0x3f733e9e,0xbe203f7d,0xbf800000,0xbe20bf7d
.long 0xbf733e9e,0x3f733e9e,0xbf16bf4f,0x3f80,0x3f163f4f,0xbe20bf7d,0xbe9e3f73,0x3f35bf35
.long 0x3f16bf4f,0xbf4f3f16,0x3f73be9e,0xbf800000,0xbf73be9e,0x3f643ee8,0xbf4fbf16,0x3f353f35
.long 0x3f80,0xbf80,0x3f80,0xbf80,0x3f73be9e,0xbf643ee8,0x3f4fbf16,0xbf353f35
.long 0xbf16bf4f,0x3f4f3f16,0xbf73be9e,0x3f800000,0xbf163f4f,0x3e20bf7d,0x3e9e3f73,0xbf35bf35
.long 0x3f733e9e,0xbf733e9e,0x3f16bf4f,0x3f80,0xbf80,0x3f353f35,0xbf800000,0x3f35bf35
.long 0xbf733e9e,0x3e9ebf73,0x3f163f4f,0xbf800000,0x3f163f4f,0xbf7d3e20,0x3e9ebf73,0x3f353f35
.long 0x3f16bf4f,0x3f163f4f,0xbf733e9e,0xbf80,0xbf73be9e,0x3ee8bf64,0x3f4f3f16,0xbf353f35
.long 0x3f80,0xbf800000,0xbf80,0x3f800000,0x3f73be9e,0x3ee83f64,0xbf4f3f16,0xbf35bf35
.long 0x3f16bf4f,0xbf733e9e,0x3f733e9e,0xbf16bf4f,0xbf733e9e,0x3f7d3e20,0xbf4fbf16,0x3ee83f64
.long 0x3f733e9e,0xbf4fbf16,0x3f163f4f,0xbe9ebf73,0xbf16bf4f,0x3ee83f64,0xbe9ebf73,0x3e203f7d
.long 0x3f80,0xbf80,0x3f80,0xbf80,0x3f16bf4f,0xbee83f64,0x3e9ebf73,0xbe203f7d
.long 0xbf733e9e,0x3f4fbf16,0xbf163f4f,0x3e9ebf73,0x3f733e9e,0xbf7d3e20,0x3f4fbf16,0xbee83f64
.long 0xbf16bf4f,0x3f733e9e,0xbf733e9e,0x3f16bf4f,0x3f80,0xbf35bf35,0x3f800000,0xbf353f35
.long 0x3f16bf4f,0x3e9e3f73,0xbf73be9e,0x3f4fbf16,0xbf733e9e,0x3e20bf7d,0x3f4f3f16,0xbf643ee8
.long 0x3f733e9e,0xbf163f4f,0xbf16bf4f,0x3f73be9e,0xbf16bf4f,0x3f64bee8,0x3e9e3f73,0xbf7d3e20
.long 0x3f80,0xbf800000,0xbf80,0x3f800000,0x3f16bf4f,0x3f643ee8,0xbe9e3f73,0xbf7dbe20
.long 0x3f80,0x3f16bf4f,0xbf733e9e,0x3f733e9e,0xbf80,0xbee83f64,0x3f4fbf16,0xbf7d3e20
.long 0x3f80,0x3e9ebf73,0xbf163f4f,0x3f4fbf16,0xbf80,0xbe203f7d,0x3e9ebf73,0xbee83f64
.long 0x3f80,0xbf80,0x3f80,0xbf80,0xbf80,0x3e203f7d,0xbe9ebf73,0x3ee83f64
.long 0x3f80,0xbe9ebf73,0x3f163f4f,0xbf4fbf16,0xbf80,0x3ee83f64,0xbf4fbf16,0x3f7d3e20
.long 0x3f80,0xbf16bf4f,0x3f733e9e,0xbf733e9e,0xbf80,0x3f353f35,0xbf800000,0x3f35bf35
.long 0x3f80,0xbf4fbf16,0x3f73be9e,0xbe9e3f73,0xbf80,0x3f643ee8,0xbf4f3f16,0xbe20bf7d
.long 0x3f80,0xbf73be9e,0x3f16bf4f,0x3f163f4f,0xbf80,0x3f7d3e20,0xbe9e3f73,0xbf64bee8
.long 0x3f80,0xbf800000,0xbf80,0x3f800000,0xbf80,0x3f7dbe20,0x3e9e3f73,0xbf643ee8
.long 0xbf16bf4f,0x3f80,0x3f16bf4f,0xbf733e9e,0x3f733e9e,0xbf35bf35,0x3e9e3f73,0x3e20bf7d
.long 0xbf733e9e,0x3f800000,0xbf73be9e,0x3f4f3f16,0x3f16bf4f,0xbf353f35,0x3f4fbf16,0xbf643ee8
.long 0x3f80,0xbf80,0x3f80,0xbf80,0xbf16bf4f,0x3f353f35,0xbf4fbf16,0x3f643ee8
.long 0x3f733e9e,0xbf800000,0x3f73be9e,0xbf4f3f16,0xbf733e9e,0x3f35bf35,0xbe9e3f73,0xbe20bf7d
.long 0x3f16bf4f,0x3f80,0xbf16bf4f,0x3f733e9e,0x3f80,0xbf35bf35,0x3f800000,0xbf353f35
.long 0xbf16bf4f,0x3f800000,0xbf163f4f,0xbe9ebf73,0x3f733e9e,0xbf353f35,0xbe9ebf73,0x3f7d3e20
.long 0xbf733e9e,0xbf80,0x3f733e9e,0xbf163f4f,0x3f16bf4f,0x3f353f35,0xbf4f3f16,0xbee8bf64
.long 0x3f80,0xbf800000,0xbf80,0x3f800000,0xbf16bf4f,0x3f35bf35,0x3f4f3f16,0xbee83f64
.long 0x3f733e9e,0xbf16bf4f,0x3f80,0x3f16bf4f,0xbf163f4f,0x3f64bee8,0xbf800000,0x3f643ee8
.long 0xbf16bf4f,0x3e9e3f73,0xbf80,0xbe9e3f73,0x3f73be9e,0xbf7d3e20,0x3f800000,0xbf7dbe20
.long 0x3f80,0xbf80,0x3f80,0xbf80,0xbf73be9e,0x3f7d3e20,0xbf800000,0x3f7dbe20
.long 0x3f16bf4f,0xbe9e3f73,0xbf80,0x3e9e3f73,0x3f163f4f,0xbf64bee8,0x3f800000,0xbf643ee8
.long 0xbf733e9e,0x3f16bf4f,0x3f80,0xbf16bf4f,0xbf80,0x3f353f35,0xbf800000,0x3f35bf35
.long 0x3f733e9e,0xbf4f3f16,0xbf80,0x3f4f3f16,0xbf163f4f,0xbee8bf64,0x3f800000,0xbee83f64
.long 0xbf16bf4f,0x3f73be9e,0x3f80,0xbf73be9e,0x3f73be9e,0x3e203f7d,0xbf800000,0x3e20bf7d
.long 0x3f80,0xbf800000,0xbf80,0x3f800000,0xbf73be9e,0x3e20bf7d,0x3f800000,0x3e203f7d
.long 0xbf733e9e,0x3f733e9e,0xbf16bf4f,0x3f80,0xbf16bf4f,0x3e203f7d,0x3e9ebf73,0xbf353f35
.long 0x3f16bf4f,0xbf4f3f16,0x3f73be9e,0xbf800000,0x3f733e9e,0xbf64bee8,0x3f4f3f16,0xbf35bf35
.long 0x3f80,0xbf80,0x3f80,0xbf80,0xbf733e9e,0x3f64bee8,0xbf4f3f16,0x3f35bf35
.long 0xbf16bf4f,0x3f4f3f16,0xbf73be9e,0x3f800000,0x3f16bf4f,0xbe203f7d,0xbe9ebf73,0x3f353f35
.long 0x3f733e9e,0xbf733e9e,0x3f16bf4f,0x3f80,0x3f80,0xbf35bf35,0x3f800000,0xbf353f35
.long 0xbf733e9e,0x3e9ebf73,0x3f163f4f,0xbf800000,0xbf16bf4f,0x3f7dbe20,0xbe9e3f73,0xbf35bf35
.long 0x3f16bf4f,0x3f163f4f,0xbf733e9e,0xbf80,0x3f733e9e,0xbee83f64,0xbf4fbf16,0x3f35bf35
.long 0x3f80,0xbf800000,0xbf80,0x3f800000,0xbf733e9e,0xbee8bf64,0x3f4fbf16,0x3f353f35
.long 0x3f16bf4f,0xbf733e9e,0x3f733e9e,0xbf16bf4f,0x3f73be9e,0xbf7dbe20,0x3f4f3f16,0xbee8bf64
.long 0x3f733e9e,0xbf4fbf16,0x3f163f4f,0xbe9ebf73,0x3f163f4f,0xbee8bf64,0x3e9e3f73,0xbe20bf7d
.long 0x3f80,0xbf80,0x3f80,0xbf80,0xbf163f4f,0x3ee8bf64,0xbe9e3f73,0x3e20bf7d
.long 0xbf733e9e,0x3f4fbf16,0xbf163f4f,0x3e9ebf73,0xbf73be9e,0x3f7dbe20,0xbf4f3f16,0x3ee8bf64
.long 0xbf16bf4f,0x3f733e9e,0xbf733e9e,0x3f16bf4f,0xbf80,0x3f353f35,0xbf800000,0x3f35bf35
.long 0x3f16bf4f,0x3e9e3f73,0xbf73be9e,0x3f4fbf16,0x3f73be9e,0xbe203f7d,0xbf4fbf16,0x3f64bee8
.long 0x3f733e9e,0xbf163f4f,0xbf16bf4f,0x3f73be9e,0x3f163f4f,0xbf643ee8,0xbe9ebf73,0x3f7dbe20
.long 0x3f80,0xbf800000,0xbf80,0x3f800000,0xbf163f4f,0xbf64bee8,0x3e9ebf73,0x3f7d3e20
.long 0x0,0x0,0x0,0x0,0x0,0x0,0x0,0x0
.long 0x0,0x0,0x0,0x0,0x0,0x0,0x0,0x0
.long 0x0,0x0,0x0,0x0,0x0,0x0,0x0,0x0
.long 0x0,0x0,0x0,0x0,0x0,0x0,0x0,0x0
.long 0x0,0x0,0x0,0x0,0x0,0x0,0x0,0x0
.long 0x0,0x0,0x0,0x0,0x0,0x0,0x0,0x0
.long 0x0,0x0,0x0,0x0,0x0,0x0,0x0,0x0
.long 0x0,0x0,0x0,0x0,0x0,0x0,0x0,0x0
.long 0x0,0x0,0x0,0x0,0x0,0x0,0x0,0x0
.long 0x0,0x0,0x0,0x0,0x0,0x0,0x0,0x0
.long 0x0,0x0,0x0,0x0,0x0,0x0,0x0,0x0
.long 0x0,0x0,0x0,0x0,0x0,0x0,0x0,0x0
.long 0x0,0x0,0x0,0x0,0x0,0x0,0x0,0x0
.long 0x0,0x0,0x0,0x0,0x0,0x0,0x0,0x0
.long 0x0,0x0,0x0,0x0,0x0,0x0,0x0,0x0
.long 0x0,0x0,0x0,0x0,0x0,0x0,0x0,0x0
.long 0x3f80,0xbf733e9e,0xbf16bf4f,0x3f16bf4f,0x3f80,0xbf643ee8,0xbf4fbf16,0x3e20bf7d
.long 0x3f80,0xbf4f3f16,0xbf73be9e,0xbe9ebf73,0x3f80,0xbf353f35,0xbf800000,0xbf35bf35
.long 0x3f80,0xbf163f4f,0xbf733e9e,0xbf73be9e,0x3f80,0xbee83f64,0xbf4f3f16,0xbf7d3e20
.long 0x3f80,0xbe9e3f73,0xbf163f4f,0xbf4f3f16,0x3f80,0xbe203f7d,0xbe9e3f73,0xbee83f64
.long 0x0,0x0,0x0,0x0,0x0,0x0,0x0,0x0
.long 0x0,0x0,0x0,0x0,0x0,0x0,0x0,0x0
.long 0x0,0x0,0x0,0x0,0x0,0x0,0x0,0x0
.long 0x0,0x0,0x0,0x0,0x0,0x0,0x0,0x0
.long 0x3f733e9e,0x3f80,0xbf733e9e,0xbf16bf4f,0x3f73be9e,0x3f353f35,0xbe9e3f73,0xbf7d3e20
.long 0x3f16bf4f,0x3f800000,0x3f163f4f,0xbe9e3f73,0xbf80,0x3f35bf35,0x3f800000,0x3f353f35
.long 0xbf16bf4f,0xbf80,0x3f16bf4f,0x3f73be9e,0xbf73be9e,0xbf35bf35,0xbe9ebf73,0x3e20bf7d
.long 0xbf733e9e,0xbf800000,0xbf73be9e,0xbf4fbf16,0xbf163f4f,0xbf353f35,0xbf4f3f16,0xbf643ee8
.long 0x0,0x0,0x0,0x0,0x0,0x0,0x0,0x0
.long 0x0,0x0,0x0,0x0,0x0,0x0,0x0,0x0
.long 0x0,0x0,0x0,0x0,0x0,0x0,0x0,0x0
.long 0x0,0x0,0x0,0x0,0x0,0x0,0x0,0x0
.long 0x3f16bf4f,0x3f733e9e,0x3f80,0xbf733e9e,0xbf16bf4f,0x3ee8bf64,0x3f800000,0x3ee83f64
.long 0xbf733e9e,0xbf4fbf16,0xbf80,0x3f4fbf16,0x3f80,0xbf353f35,0xbf800000,0xbf35bf35
.long 0x3f733e9e,0x3f163f4f,0x3f80,0xbf163f4f,0x3f16bf4f,0x3f64bee8,0x3f800000,0x3f643ee8
.long 0xbf16bf4f,0xbe9ebf73,0xbf80,0x3e9ebf73,0xbf733e9e,0xbf7d3e20,0xbf800000,0xbf7dbe20
.long 0x0,0x0,0x0,0x0,0x0,0x0,0x0,0x0
.long 0x0,0x0,0x0,0x0,0x0,0x0,0x0,0x0
.long 0x0,0x0,0x0,0x0,0x0,0x0,0x0,0x0
.long 0x0,0x0,0x0,0x0,0x0,0x0,0x0,0x0
.long 0xbf16bf4f,0x3f16bf4f,0x3f733e9e,0x3f80,0xbf163f4f,0xbf7dbe20,0xbe9ebf73,0x3f35bf35
.long 0x3f733e9e,0x3e9e3f73,0xbf163f4f,0xbf800000,0xbf80,0x3f35bf35,0x3f800000,0x3f353f35
.long 0xbf733e9e,0xbf73be9e,0xbf16bf4f,0xbf80,0x3f163f4f,0x3e203f7d,0xbe9e3f73,0xbf353f35
.long 0x3f16bf4f,0x3f4fbf16,0x3f73be9e,0x3f800000,0xbf73be9e,0xbf64bee8,0xbf4fbf16,0xbf35bf35
.long 0x0,0x0,0x0,0x0,0x0,0x0,0x0,0x0
.long 0x0,0x0,0x0,0x0,0x0,0x0,0x0,0x0
.long 0x0,0x0,0x0,0x0,0x0,0x0,0x0,0x0
.long 0x0,0x0,0x0,0x0,0x0,0x0,0x0,0x0
.long 0xbf733e9e,0xbf16bf4f,0x3f16bf4f,0x3f733e9e,0x3f733e9e,0x3e203f7d,0xbf4f3f16,0xbf64bee8
.long 0xbf16bf4f,0x3e9ebf73,0x3f73be9e,0x3f4f3f16,0x3f80,0xbf353f35,0xbf800000,0xbf35bf35
.long 0x3f16bf4f,0x3f73be9e,0x3f733e9e,0x3f163f4f,0xbf733e9e,0xbf7dbe20,0xbf4fbf16,0xbee8bf64
.long 0x3f733e9e,0x3f4f3f16,0x3f163f4f,0x3e9e3f73,0xbf16bf4f,0xbee8bf64,0xbe9ebf73,0xbe20bf7d
.long 0x0,0x0,0x0,0x0,0x0,0x0,0x0,0x0
.long 0x0,0x0,0x0,0x0,0x0,0x0,0x0,0x0
.long 0x0,0x0,0x0,0x0,0x0,0x0,0x0,0x0
.long 0x0,0x0,0x0,0x0,0x0,0x0,0x0,0x0
.long 0x3f80,0xbf733e9e,0xbf16bf4f,0x3f16bf4f,0xbf80,0x3f64bee8,0x3f4f3f16,0xbe203f7d
.long 0x3f80,0xbf4f3f16,0xbf73be9e,0xbe9ebf73,0xbf80,0x3f35bf35,0x3f800000,0x3f353f35
.long 0x3f80,0xbf163f4f,0xbf733e9e,0xbf73be9e,0xbf80,0x3ee8bf64,0x3f4fbf16,0x3f7dbe20
.long 0x3f80,0xbe9e3f73,0xbf163f4f,0xbf4f3f16,0xbf80,0x3e20bf7d,0x3e9ebf73,0x3ee8bf64
.long 0x0,0x0,0x0,0x0,0x0,0x0,0x0,0x0
.long 0x0,0x0,0x0,0x0,0x0,0x0,0x0,0x0
.long 0x0,0x0,0x0,0x0,0x0,0x0,0x0,0x0
.long 0x0,0x0,0x0,0x0,0x0,0x0,0x0,0x0
.long 0x3f733e9e,0x3f80,0xbf733e9e,0xbf16bf4f,0xbf733e9e,0xbf35bf35,0x3e9ebf73,0x3f7dbe20
.long 0x3f16bf4f,0x3f800000,0x3f163f4f,0xbe9e3f73,0x3f80,0xbf353f35,0xbf800000,0xbf35bf35
.long 0xbf16bf4f,0xbf80,0x3f16bf4f,0x3f73be9e,0x3f733e9e,0x3f353f35,0x3e9e3f73,0xbe203f7d
.long 0xbf733e9e,0xbf800000,0xbf73be9e,0xbf4fbf16,0x3f16bf4f,0x3f35bf35,0x3f4fbf16,0x3f64bee8
.long 0x0,0x0,0x0,0x0,0x0,0x0,0x0,0x0
.long 0x0,0x0,0x0,0x0,0x0,0x0,0x0,0x0
.long 0x0,0x0,0x0,0x0,0x0,0x0,0x0,0x0
.long 0x0,0x0,0x0,0x0,0x0,0x0,0x0,0x0
.long 0x3f16bf4f,0x3f733e9e,0x3f80,0xbf733e9e,0x3f163f4f,0xbee83f64,0xbf800000,0xbee8bf64
.long 0xbf733e9e,0xbf4fbf16,0xbf80,0x3f4fbf16,0xbf80,0x3f35bf35,0x3f800000,0x3f353f35
.long 0x3f733e9e,0x3f163f4f,0x3f80,0xbf163f4f,0xbf163f4f,0xbf643ee8,0xbf800000,0xbf64bee8
.long 0xbf16bf4f,0xbe9ebf73,0xbf80,0x3e9ebf73,0x3f73be9e,0x3f7dbe20,0x3f800000,0x3f7d3e20
.long 0x0,0x0,0x0,0x0,0x0,0x0,0x0,0x0
.long 0x0,0x0,0x0,0x0,0x0,0x0,0x0,0x0
.long 0x0,0x0,0x0,0x0,0x0,0x0,0x0,0x0
.long 0x0,0x0,0x0,0x0,0x0,0x0,0x0,0x0
.long 0xbf16bf4f,0x3f16bf4f,0x3f733e9e,0x3f80,0x3f16bf4f,0x3f7d3e20,0x3e9e3f73,0xbf353f35
.long 0x3f733e9e,0x3e9e3f73,0xbf163f4f,0xbf800000,0x3f80,0xbf353f35,0xbf800000,0xbf35bf35
.long 0xbf733e9e,0xbf73be9e,0xbf16bf4f,0xbf80,0xbf16bf4f,0xbe20bf7d,0x3e9ebf73,0x3f35bf35
.long 0x3f16bf4f,0x3f4fbf16,0x3f73be9e,0x3f800000,0x3f733e9e,0x3f643ee8,0x3f4f3f16,0x3f353f35
.long 0x0,0x0,0x0,0x0,0x0,0x0,0x0,0x0
.long 0x0,0x0,0x0,0x0,0x0,0x0,0x0,0x0
.long 0x0,0x0,0x0,0x0,0x0,0x0,0x0,0x0
.long 0x0,0x0,0x0,0x0,0x0,0x0,0x0,0x0
.long 0xbf733e9e,0xbf16bf4f,0x3f16bf4f,0x3f733e9e,0xbf73be9e,0xbe20bf7d,0x3f4fbf16,0x3f643ee8
.long 0xbf16bf4f,0x3e9ebf73,0x3f73be9e,0x3f4f3f16,0xbf80,0x3f35bf35,0x3f800000,0x3f353f35
.long 0x3f16bf4f,0x3f73be9e,0x3f733e9e,0x3f163f4f,0x3f73be9e,0x3f7d3e20,0x3f4f3f16,0x3ee83f64
.long 0x3f733e9e,0x3f4f3f16,0x3f163f4f,0x3e9e3f73,0x3f163f4f,0x3ee83f64,0x3e9e3f73,0x3e203f7d
.long 0x0,0x0,0x0,0x0,0x0,0x0,0x0,0x0
.long 0x0,0x0,0x0,0x0,0x0,0x0,0x0,0x0
.long 0x0,0x0,0x0,0x0,0x0,0x0,0x0,0x0
.long 0x0,0x0,0x0,0x0,0x0,0x0,0x0,0x0
.long 0x0,0x0,0x0,0x0,0x0,0x0,0x0,0x0
.long 0x0,0x0,0x0,0x0,0x0,0x0,0x0,0x0
.long 0x0,0x0,0x0,0x0,0x0,0x0,0x0,0x0
.long 0x0,0x0,0x0,0x0,0x0,0x0,0x0,0x0
.long 0x0,0x0,0x0,0x0,0x0,0x0,0x0,0x0
.long 0x0,0x0,0x0,0x0,0x0,0x0,0x0,0x0
.long 0x0,0x0,0x0,0x0,0x0,0x0,0x0,0x0
.long 0x0,0x0,0x0,0x0,0x0,0x0,0x0,0x0
.long 0x0,0x0,0x0,0x0,0x0,0x0,0x0,0x0
.long 0x0,0x0,0x0,0x0,0x0,0x0,0x0,0x0
.long 0x0,0x0,0x0,0x0,0x0,0x0,0x0,0x0
.long 0x0,0x0,0x0,0x0,0x0,0x0,0x0,0x0
.long 0x0,0x0,0x0,0x0,0x0,0x0,0x0,0x0
.long 0x0,0x0,0x0,0x0,0x0,0x0,0x0,0x0
.long 0x0,0x0,0x0,0x0,0x0,0x0,0x0,0x0
.long 0x0,0x0,0x0,0x0,0x0,0x0,0x0,0x0
K2_table_end:
.size K2_table, 17408
.section .rodata,"a"
.p2align 6
.amdhsa_kernel adaLN_cond__spectral_fnet__geglu_ffn__prompt_kernel
.amdhsa_next_free_vgpr 496
.amdhsa_next_free_sgpr 102
.amdhsa_accum_offset 256
.amdhsa_group_segment_fixed_size 0
.amdhsa_kernarg_size 112
.amdhsa_user_sgpr_count 2
.amdhsa_user_sgpr_kernarg_segment_ptr 1
.amdhsa_system_sgpr_workgroup_id_x 1
.end_amdhsa_kernel
```
